```python
import torch

def _softmax(x, axis=-1):
    return torch.softmax(x, dim=axis)
def _gelu(x):
    return torch.nn.functional.gelu(x, approximate="tanh")
def _silu(x):
    return torch.nn.functional.silu(x)
def _sigmoid(x):
    return torch.sigmoid(x)
def _layernorm(x, axis=-1, eps=1e-5):
    m = x.mean(dim=axis, keepdim=True)
    v = x.var(dim=axis, keepdim=True, unbiased=False)
    return (x - m) / torch.sqrt(v + eps)
def _scatter_add(tgt, idx, src, axis=0):
    return tgt.clone().index_add_(axis, idx, src)
def _segment_sum(src, seg, n):
    out = torch.zeros((n,) + src.shape[1:], dtype=src.dtype)
    return out.index_add_(0, seg, src)
def _pad(x, pw):
    flat = tuple(v for pair in reversed(pw) for v in pair)
    return torch.nn.functional.pad(x, flat)

kernel_name = 'gated_mix__ssm_conv_s4__glu_gated_swiglu__prompt'

def setup_inputs():

    _w = (lambda a: (lambda t: t.to(torch.bfloat16) if t.is_floating_point() else t)(torch.as_tensor(a)))
    def _A_setup():
        B, L, D, N = 1, 2048, 576, 128
        A_re = -(lambda _x: torch.exp(torch.as_tensor(_x)))((lambda *s: torch.randn(*s, dtype=torch.bfloat16) * 3.2)(D, N))
        A_im = torch.pi * (lambda *s: torch.randn(*s, dtype=torch.bfloat16) * 0.05)(D, N)
        B_re = (lambda *s: torch.randn(*s, dtype=torch.bfloat16) * 0.1)(D, N)
        B_im = (lambda *s: torch.randn(*s, dtype=torch.bfloat16) * 0.1)(D, N)
        C_re = (lambda *s: torch.randn(*s, dtype=torch.bfloat16) * 0.1)(D, N)
        C_im = (lambda *s: torch.randn(*s, dtype=torch.bfloat16) * 0.1)(D, N)
        log_dt = (lambda *s: torch.randn(*s, dtype=torch.bfloat16) * 0.05)(D) * 0.5 - 4.0
        Dskip = (lambda *s: torch.randn(*s, dtype=torch.bfloat16) * 0.05)(D)
        return {
            "u": _w((lambda *s: torch.randn(*s, dtype=torch.bfloat16) * 0.05)(B, L, D)),
            "A_re": _w(A_re),
            "A_im": _w(A_im),
            "B_re": _w(B_re),
            "B_im": _w(B_im),
            "C_re": _w(C_re),
            "C_im": _w(C_im),
            "log_dt": _w(log_dt),
            "Dskip": _w(Dskip),
        }
    _A_in = _A_setup()

    def _B_setup():
        B, S, D, F = 1, 2048, 576, 4608
        return {
            "x": _w((lambda *s: torch.randn(*s, dtype=torch.bfloat16) * 0.05)(B, S, D)),
            "w1": _w((lambda *s: torch.randn(*s, dtype=torch.bfloat16) * 0.8)(D, F) * (2.0 / D) ** 0.5),
            "w3": _w((lambda *s: torch.randn(*s, dtype=torch.bfloat16) * 0.8)(D, F) * (2.0 / D) ** 0.5),
            "w2": _w((lambda *s: torch.randn(*s, dtype=torch.bfloat16) * 0.8)(F, D) * (2.0 / F) ** 0.5),
        }
    _B_in = _B_setup()

    return {
        "A_u": _A_in["u"],
        "A_A_re": _A_in["A_re"],
        "A_A_im": _A_in["A_im"],
        "A_B_re": _A_in["B_re"],
        "A_B_im": _A_in["B_im"],
        "A_C_re": _A_in["C_re"],
        "A_C_im": _A_in["C_im"],
        "A_log_dt": _A_in["log_dt"],
        "A_Dskip": _A_in["Dskip"],
        "B_x": _B_in["x"],
        "B_w1": _B_in["w1"],
        "B_w3": _B_in["w3"],
        "B_w2": _B_in["w2"],
        "gate_w": _w((lambda *s: torch.randn(*s, dtype=torch.bfloat16) * 0.05)(576) * 16.0),
    }

def reference(A_u, A_A_re, A_A_im, A_B_re, A_B_im, A_C_re, A_C_im, A_log_dt, A_Dskip, B_x, B_w1, B_w3, B_w2, gate_w):
    def _A_ref(u, A_re, A_im, B_re, B_im, C_re, C_im, log_dt, Dskip):
        Bsz, L, D = u.shape
        dt = torch.exp(log_dt)[:, None]
        A = A_re + 1j * A_im
        Bc = B_re + 1j * B_im
        Cc = C_re + 1j * C_im
        logdA = dt * A
        dB = dt * Bc
        l = (lambda x, dt: x.to(dt))(torch.arange(L), A_re.dtype)
        P = torch.exp(logdA[:, :, None] * l[None, None, :])
        K = torch.einsum("dn,dnl,dn->dl", Cc, P, dB).real
        L2 = 2 * L
        Kp = _pad(K, ((0, 0), (0, L)))
        up = (lambda x, *d: x.permute(*d))(u, 0, 2, 1)
        up = _pad(up, ((0, 0), (0, 0), (0, L)))
        Kf = (lambda x, axes=(-2,-1): torch.fft.rfft2(x.float(), dim=axes))(Kp[:, None, :], axes=(-2, -1))
        Uf = (lambda x, axes=(-2,-1): torch.fft.rfft2(x.float(), dim=axes))(up[:, :, None, :], axes=(-2, -1))
        Yf = Uf * Kf[None, :, :, :]
        y = (lambda x, s, axes=(-2,-1): torch.fft.irfft2(x, s=s, dim=axes).to(torch.bfloat16))(Yf, (1, L2), axes=(-2, -1))[:, :, 0, :L]
        y = (lambda x, *d: x.permute(*d))(y, 0, 2, 1) + u * Dskip[None, None, :]
        return y

    def _B_ref(x, w1, w3, w2):
        gate = torch.einsum("bsd,df->bsf", x, w1)
        up = torch.einsum("bsd,df->bsf", x, w3)
        h = _silu(gate) * up
        out = torch.einsum("bsf,fd->bsd", h, w2)
        return out

    x = A_u
    g = _sigmoid((x * gate_w).sum(-1, keepdims=True))
    a = _A_ref(x, A_A_re, A_A_im, A_B_re, A_B_im, A_C_re, A_C_im, A_log_dt, A_Dskip)
    b = _B_ref(x, B_w1, B_w3, B_w2)
    return g * a + (1 - g) * b
```

```asm
; @launch grid=(256,1,1) block=(256,1,1) lds=163840
.amdgcn_target "amdgcn-amd-amdhsa--gfx950"
.text
.globl gated_mix__ssm_conv_s4__glu_gated_swiglu__prompt_kernel
.p2align 8
.type gated_mix__ssm_conv_s4__glu_gated_swiglu__prompt_kernel,@function
gated_mix__ssm_conv_s4__glu_gated_swiglu__prompt_kernel:
    s_cmp_ge_u32 s2, 256
    s_cbranch_scc1 END
    s_load_dwordx16 s[32:47], s[0:1], 8
    s_load_dwordx2 s[4:5], s[0:1], 0
    s_load_dwordx2 s[8:9], s[0:1], 80
    s_load_dwordx2 s[12:13], s[0:1], 88
    s_load_dwordx2 s[16:17], s[0:1], 96
    s_load_dwordx2 s[48:49], s[0:1], 104
    s_load_dwordx2 s[20:21], s[0:1], 112
    s_load_dwordx2 s[28:29], s[0:1], 120
    s_load_dwordx2 s[24:25], s[0:1], 128
    s_getpc_b64 s[80:81]
    v_lshrrev_b32 v202, 6, v0
    v_and_b32 v1, 63, v0
    s_and_b32 s51, s2, 7
    s_lshr_b32 s52, s2, 3
    s_and_b32 s53, s52, 1
    s_lshr_b32 s54, s52, 1
    v_readfirstlane_b32 s50, v202
    s_mov_b32 s6, 0x240000
    s_mov_b32 s7, 0x20000
    s_mov_b32 s10, 0x510000
    s_mov_b32 s11, 0x20000
    s_mov_b32 s14, 0x510000
    s_mov_b32 s15, 0x20000
    s_lshl2_add_u32 s55, s52, s50
    s_mul_i32 s55, s55, 4
    v_add_u32 v217, s55, v1
    v_min_u32 v217, 493, v217
    v_lshlrev_b32 v217, 7, v217
    s_mov_b64 exec, 15
    global_load_dword v46, v217, s[80:81]
    s_mov_b64 exec, -1
    v_lshrrev_b32 v204, 3, v1
    v_and_b32 v205, 7, v1
    v_lshrrev_b32 v206, 4, v1
    s_mul_i32 s101, s54, 147456
    s_lshl_b32 s55, s50, 5
    s_movk_i32 s57, 1152
    v_add_u32 v213, s55, v204
    v_mul_lo_u32 v213, v213, s57
    v_xor_b32 v214, v205, v206
    v_lshl_add_u32 v228, v214, 4, v213
    v_xor_b32 v214, 4, v214
    v_lshl_add_u32 v229, v214, 4, v213
    v_add_u32 v229, 8192, v229
    v_add_u32 v230, 16384, v228
    v_add_u32 v231, 16384, v229
    s_lshl_b32 s63, s50, 14
    s_add_u32 s63, s63, 0x18000
    s_mul_i32 s55, s51, 1152
    s_mul_i32 s56, s53, 640
    s_add_u32 s58, s56, s55
    s_mul_i32 s61, s50, 3072
    s_movk_i32 s57, 9216
    s_mul_i32 s55, s50, 24
    v_add_u32 v213, s55, v204
    v_mul_lo_u32 v213, v213, s57
    v_and_b32 v207, 1, v206
    v_lshlrev_b32 v214, 1, v207
    v_xor_b32 v214, v205, v214
    s_and_b32 s55, s50, 1
    s_lshl_b32 s55, s55, 2
    v_xor_b32 v214, s55, v214
    v_lshl_add_u32 v2, v214, 4, v213
    v_xor_b32 v214, 4, v214
    v_lshl_add_u32 v3, v214, 4, v213
    v_add_u32 v3, 0x11c00, v3
    v_add_u32 v4, 0x23800, v2
    s_min_u32 s55, s52, 17
    s_mul_i32 s76, s51, 18
    s_add_u32 s76, s76, s55
    s_lshl2_add_u32 s77, s76, s50
    s_sub_u32 s75, s52, 18
    s_lshl2_add_u32 s79, s75, s50
    s_mul_i32 s55, s51, 56
    s_add_u32 s78, s79, s55
    s_lshl_b32 s55, s78, 8
    v_lshl_add_u32 v215, v1, 2, s55
    s_lshl_b32 s55, s78, 1
    v_mov_b32 v216, s55
    s_cmp_lt_u32 s75, 14
    s_waitcnt lgkmcnt(0)
    s_cbranch_scc1 PATHB
    s_add_u32 m0, s63, 0x0
    s_nop 0
    buffer_load_dwordx4 v228, s[4:7], s101 offen offset:0 lds
    buffer_load_dwordx4 v229, s[4:7], s101 offen offset:1024 lds
    buffer_load_dwordx4 v230, s[4:7], s101 offen offset:2048 lds
    buffer_load_dwordx4 v231, s[4:7], s101 offen offset:3072 lds
    s_add_u32 m0, s63, 0xf80
    s_mov_b32 s30, 0x100
    buffer_load_dwordx4 v228, s[4:7], s101 offen offset:128 lds
    buffer_load_dwordx4 v229, s[4:7], s101 offen offset:1152 lds
    buffer_load_dwordx4 v230, s[4:7], s101 offen offset:2176 lds
    buffer_load_dwordx4 v231, s[4:7], s101 offen offset:3200 lds
    s_mov_b32 s31, 0x20000
    s_mov_b32 s23, 0x20000
    s_mov_b32 s22, 0x240000
    s_add_u32 s60, s58, 0x0
    s_mov_b32 s26, 0x3100000
    s_mov_b32 s27, 0x20000
    s_mov_b32 s18, 0x510000
    s_mov_b32 s19, 0x20000
    s_or_b32 s55, s2, s50
    s_cmp_lg_u32 s55, 0
    s_cbranch_scc1 NONONCE
    s_memrealtime s[56:57]
    s_waitcnt lgkmcnt(0)
    s_or_b32 s56, s56, 1
    v_mov_b32 v43, s56
    buffer_store_dword v43, off, s[28:31], 0 sc1
NONONCE:
    s_mov_b32 s43, s77
    s_add_u32 m0, s61, 0x0
    s_lshl_b32 s56, s78, 6
    v_and_b32 v209, 3, v1
    v_lshlrev_b32 v212, 3, v209
    v_lshrrev_b32 v210, 2, v1
    s_mov_b32 s33, 0x40000000
    s_add_u32 s56, s56, 0x2d60000
    s_cmp_lt_u32 s75, 14
    s_cselect_b32 s32, s56, 0x40000000
    s_lshl_b32 s56, s76, 6
    s_add_u32 s56, s56, 0x2d40000
    s_mul_i32 s55, s50, 6144
    s_cmp_lt_u32 s2, 144
    buffer_load_dwordx4 v2, s[8:11], s60 offen offset:0 lds
    buffer_load_dwordx4 v3, s[8:11], s60 offen offset:1024 lds
    s_cselect_b32 s42, s56, 0x40000000
    s_add_u32 s55, s55, 0x12000
    v_and_b32 v211, 15, v1
    s_add_u32 s56, s63, 12384
    v_lshl_add_u32 v109, v1, 3, s56
    s_sub_u32 s56, s56, 5984
    v_cmp_gt_u32 vcc, 11, v211
    v_mov_b32 v217, s55
    v_mov_b32 v218, s56
    v_cndmask_b32 v217, v218, v217, vcc
    v_and_b32 v208, 3, v210
    v_lshl_add_u32 v108, v1, 3, s55
    v_lshrrev_b32 v219, 1, v208
    s_movk_i32 s57, 544
    s_mov_b32 s81, 8192
    s_mov_b32 s80, 4096
    buffer_load_dwordx4 v4, s[8:11], s60 offen offset:2048 lds
    v_lshl_add_u32 v217, v206, 4, v217
    v_mad_u32_u24 v110, v211, s57, v217
    v_lshrrev_b32 v217, 1, v211
    v_xor_b32 v217, v206, v217
    v_lshlrev_b32 v217, 4, v217
    v_lshl_add_u32 v217, v211, 7, v217
    v_lshl_add_u32 v219, v207, 1, v219
    v_xor_b32 v218, 64, v217
    v_add_u32 v232, s63, v217
    v_lshl_add_u32 v217, v206, 3, v208
    s_mov_b32 s82, 12288
    s_mov_b32 s83, 16384
    v_add_u32 v233, s63, v218
    v_xor_b32 v198, 0, v219
    s_mov_b32 s68, 0xbfb8aa3b
    v_lshl_add_u32 v218, v217, 7, v212
    v_lshl_add_u32 v8, v198, 5, v218
    v_xor_b32 v198, 1, v219
    v_lshl_add_u32 v9, v198, 5, v218
    v_xor_b32 v198, 2, v219
    v_lshl_add_u32 v10, v198, 5, v218
    s_mul_i32 s55, s51, 1152
    s_movk_i32 s57, 9216
    v_xor_b32 v198, 3, v219
    s_add_u32 m0, s61, 0x3000
    s_nop 0
    buffer_load_dwordx4 v2, s[12:15], s60 offen offset:0 lds
    buffer_load_dwordx4 v3, s[12:15], s60 offen offset:1024 lds
    v_add_u32 v14, 0xc000, v10
    v_lshrrev_b32 v219, 5, v1
    v_lshl_add_u32 v11, v198, 5, v218
    v_lshlrev_b32 v219, 1, v219
    v_add_u32 v12, 0xc000, v8
    v_add_u32 v13, 0xc000, v9
    s_lshl_b32 s56, s53, 6
    v_lshl_add_u32 v218, v217, 6, v212
    s_add_u32 s56, s56, s55
    v_xor_b32 v219, v209, v219
    v_add_u32 v15, 0xc000, v11
    v_xor_b32 v198, 0, v207
    s_mul_i32 s55, s50, 48
    v_lshl_add_u32 v16, v198, 5, v218
    v_xor_b32 v198, 1, v207
    v_lshl_add_u32 v17, v198, 5, v218
    v_add_u32 v218, s55, v210
    v_mul_lo_u32 v218, v218, s57
    s_add_u32 s59, s56, 512
    v_lshl_add_u32 v5, v219, 4, v218
    v_add_u32 v19, 0xc000, v17
    s_lshr_b32 s55, s76, 4
    v_add_u32 v18, 0xc000, v16
    s_and_b32 s57, s76, 15
    s_lshl_b32 s100, s55, 7
    s_mul_i32 s56, s57, 147456
    s_add_u32 s56, s56, s100
    s_cmp_lt_u32 s2, 144
    buffer_load_dwordx4 v4, s[12:15], s60 offen offset:2048 lds
    v_add_u32 v7, 0x47800, v5
    v_and_b32 v198, 1, v209
    s_cselect_b32 s3, s56, 0x40000000
    s_lshl_b32 s56, s43, 6
    s_add_u32 s56, s56, 0x2d44000
    s_cmp_lt_u32 s2, 144
    s_cselect_b32 s41, s56, 0x40000000
    s_lshl2_add_u32 s57, s57, s50
    s_mul_i32 s57, s57, 36864
    s_add_u32 m0, s63, 0x1f00
    v_add_u32 v6, 0x23c00, v5
    s_lshl_b32 s56, s55, 12
    v_lshlrev_b32 v218, 4, v206
    v_lshrrev_b32 v219, 1, v209
    s_sub_u32 s56, s56, s57
    s_add_u32 s56, s56, 0x2cb7030
    buffer_load_dwordx4 v228, s[4:7], s101 offen offset:256 lds
    s_cmp_lt_u32 s2, 144
    s_cselect_b32 s56, s56, 0x40000000
    v_sub_u32 v218, s56, v218
    v_lshl_add_u32 v47, v211, 6, v218
    v_lshlrev_b32 v218, 3, v206
    v_sub_u32 v218, v218, v208
    v_add_u32 v199, 7, v218
    v_bfe_u32 v200, v199, 1, 3
    v_xor_b32 v200, v219, v200
    v_lshl_add_u32 v198, v198, 3, s63
    v_lshl_add_u32 v199, v199, 7, v198
    v_lshlrev_b32 v200, 4, v200
    v_xor_b32 v201, 0, v200
    v_add_u32 v220, v201, v199
    v_xor_b32 v201, 32, v200
    s_mul_i32 s100, s78, 5120
    buffer_load_dwordx4 v229, s[4:7], s101 offen offset:1280 lds
    buffer_load_dwordx4 v230, s[4:7], s101 offen offset:2304 lds
    v_add_u32 v222, v201, v199
    v_xor_b32 v201, 64, v200
    v_add_u32 v224, v201, v199
    v_xor_b32 v201, 96, v200
    v_add_u32 v226, v201, v199
    v_add_u32 v199, 3, v218
    v_bfe_u32 v200, v199, 1, 3
    v_xor_b32 v200, v219, v200
    v_lshlrev_b32 v200, 4, v200
    v_xor_b32 v201, 0, v200
    v_lshl_add_u32 v199, v199, 7, v198
    v_add_u32 v221, v201, v199
    v_xor_b32 v201, 32, v200
    v_add_u32 v223, v201, v199
    v_xor_b32 v201, 64, v200
    v_add_u32 v225, v201, v199
    v_xor_b32 v201, 96, v200
    s_lshr_b32 s55, s43, 6
    s_lshl_b32 s55, s55, 12
    s_mov_b32 s57, 36864
    buffer_load_dwordx4 v231, s[4:7], s101 offen offset:3328 lds
    s_add_u32 s55, s55, 0x2d44000
    v_lshl_add_u32 v246, v1, 6, s55
    v_add_u32 v227, v201, v199
    s_lshl_b32 s55, s43, 6
    s_add_u32 s55, s55, 0x2a80000
    v_lshlrev_b32 v203, 4, v206
    s_add_u32 s100, s100, 0x2e00000
    v_lshl_add_u32 v218, v209, 4, s55
    v_mad_u32_u24 v247, v210, s57, v218
    s_movk_i32 s57, 1152
    s_add_u32 s60, s58, 0xd8000
    v_lshlrev_b32 v218, 1, v206
    v_xor_b32 v218, v205, v218
    v_lshlrev_b32 v218, 4, v218
    v_mad_u32_u24 v20, v204, s57, v218
    v_lshlrev_b32 v218, 1, v207
    v_xor_b32 v218, v209, v218
    v_add_u32 v21, 8192, v20
    v_lshlrev_b32 v218, 4, v218
    v_bfe_u32 v219, v1, 3, 2
    v_mad_u32_u24 v24, v210, s57, v218
    v_add_u32 v26, 34816, v24
    s_add_u32 m0, s61, 0x6000
    v_add_u32 v23, 24576, v20
    s_andn2_b32 s55, 1, s51
    buffer_load_dwordx4 v2, s[8:11], s60 offen offset:0 lds
    s_lshl_b32 s55, s55, 1
    v_xor_b32 v219, s55, v219
    v_lshl_add_u32 v218, v210, 7, v212
    v_add_u32 v27, 52224, v24
    v_xor_b32 v198, 0, v219
    v_lshl_add_u32 v28, v198, 5, v218
    v_xor_b32 v198, 1, v219
    v_add_u32 v25, 17408, v24
    v_add_u32 v22, 16384, v20
    v_lshl_add_u32 v29, v198, 5, v218
    v_xor_b32 v198, 2, v219
    v_lshl_add_u32 v30, v198, 5, v218
    v_xor_b32 v198, 3, v219
    v_lshl_add_u32 v31, v198, 5, v218
    s_mul_i32 s55, s51, 663552
    s_mul_i32 s56, s53, 368640
    s_mul_i32 s57, s53, 640
    buffer_load_dwordx4 v3, s[8:11], s60 offen offset:1024 lds
    buffer_load_dwordx4 v4, s[8:11], s60 offen offset:2048 lds
    v_add_u32 v33, 0xc000, v29
    v_add_u32 v32, 0xc000, v28
    v_add_u32 v34, 0xc000, v30
    s_add_u32 s55, s55, s57
    s_add_u32 s44, s55, s56
    v_lshl_add_u32 v218, v210, 6, v212
    v_xor_b32 v198, 0, v207
    v_lshl_add_u32 v36, v198, 5, v218
    s_sub_u32 s45, s55, s56
    v_xor_b32 v198, 1, v207
    v_lshl_add_u32 v37, v198, 5, v218
    v_add_u32 v38, 0xc000, v36
    s_add_u32 s45, s45, 368640
    s_add_u32 s55, s55, 294912
    s_mul_i32 s56, s53, 36864
    s_add_u32 s46, s55, s56
    v_add_u32 v35, 0xc000, v31
    s_sub_u32 s47, s55, s56
    s_mul_i32 s55, s50, 36864
    s_mul_i32 s56, s50, 18432
    s_add_u32 s47, s47, 36864
    v_add_u32 v39, 0xc000, v37
    s_add_u32 m0, s61, 0x9000
    s_add_u32 s57, s56, 147456
    s_add_u32 s64, s44, s55
    s_add_u32 s65, s44, s57
    s_add_u32 s66, s45, s55
    s_add_u32 s67, s45, s57
    s_mul_i32 s57, s53, 576
    s_sub_u32 s79, s45, 73728
    s_sub_u32 s76, s47, 36864
    s_cmp_lt_u32 s50, 2
    s_cselect_b32 s76, s46, s76
    s_cselect_b32 s79, s44, s79
    buffer_load_dwordx4 v2, s[12:15], s60 offen offset:0 lds
    buffer_load_dwordx4 v3, s[12:15], s60 offen offset:1024 lds
    s_add_u32 s79, s79, s55
    s_add_u32 s69, s79, 221184
    s_mul_i32 s55, s50, 110592
    s_add_u32 s70, s76, s56
    s_sub_u32 s57, 512, s57
    s_add_u32 s72, s69, s57
    s_add_u32 s73, s70, s57
    s_sub_u32 s79, s45, 221184
    s_cmp_lt_u32 s50, 2
    s_mul_i32 s56, s2, 73728
    s_cselect_b32 s79, s44, s79
    s_add_u32 s79, s79, s55
    s_add_u32 s71, s79, s57
    s_lshl_b32 s74, s50, 12
    s_mul_i32 s55, s50, 18432
    s_lshl_b32 s77, s50, 11
    s_add_u32 s75, s77, 16384
    s_lshl_b32 s78, s50, 10
    s_add_u32 s78, s78, 8192
    s_add_u32 s56, s56, s55
    v_mov_b32 v218, 0x40000000
    v_lshl_add_u32 v40, v1, 4, s56
    s_xor_b32 s57, s2, 8
    s_mul_i32 s56, s57, 73728
    s_mul_i32 s76, s50, 6144
    s_add_u32 s56, s56, s55
    s_lshl2_add_u32 s57, s57, s50
    s_lshl_b32 s57, s57, 6
    s_add_u32 s39, s57, 0x2d00000
    v_lshl_add_u32 v41, v1, 4, s56
    s_lshl2_add_u32 s57, s2, s50
    s_lshl_b32 s57, s57, 6
    buffer_load_dwordx4 v4, s[12:15], s60 offen offset:2048 lds
    s_add_u32 s38, s57, 0x2d00000
    s_lshl_b32 s55, s52, 8
    s_lshl2_add_u32 s56, s51, s50
    v_cmp_gt_u32 vcc, 16, v1
    s_add_u32 s55, s55, s56
    v_lshlrev_b32 v219, 2, v1
    s_lshl_b32 s55, s55, 11
    s_add_u32 s55, s55, 0x1400000
    v_lshl_add_u32 v44, v1, 4, s55
    v_cndmask_b32 v42, v218, v219, vcc
    s_lshl2_add_u32 s55, s52, s50
    v_lshrrev_b32 v219, 5, v1
    s_lshl4_add_u32 s55, s55, s51
    s_lshl_b32 s55, s55, 6
    s_mov_b32 s57, 73728
    s_add_u32 s40, s55, 0x2d20000
    s_lshl_b32 s55, s43, 7
    s_add_u32 s55, s55, 0x2800000
    s_cmp_lt_u32 s2, 144
    s_cselect_b32 s55, s55, 0x40000000
    v_lshl_add_u32 v219, v219, 4, s55
    s_lshl_b32 s55, s43, 6
    s_mov_b32 s46, s100
    s_add_u32 s44, s55, 0x2d60000
    s_mul_i32 s55, s43, 5120
    s_add_u32 s55, s55, 0x2e00000
    v_bfe_u32 v218, v1, 2, 3
    v_lshl_add_u32 v219, v209, 5, v219
    s_cmp_lt_u32 s2, 144
    v_mad_u32_u24 v45, v218, s57, v219
    s_cselect_b32 s45, s55, 0x40000000
    s_waitcnt vmcnt(20)
    ds_read_b128 a[0:3], v232 offset:0
    ds_read_b128 a[4:7], v232 offset:2048
    ds_read_b128 a[8:11], v233 offset:0
    ds_read_b128 a[12:15], v233 offset:2048
    s_waitcnt vmcnt(16)
    ds_read_b128 a[16:19], v232 offset:4096
    ds_read_b128 a[20:23], v232 offset:6144
    ds_read_b128 a[24:27], v233 offset:4096
    ds_read_b128 a[28:31], v233 offset:6144
    s_waitcnt lgkmcnt(4)
    s_add_u32 m0, s63, 0xfffffe80
    s_nop 0
    buffer_load_dwordx4 v228, s[4:7], s101 offen offset:384 lds
    buffer_load_dwordx4 v229, s[4:7], s101 offen offset:1408 lds
    buffer_load_dwordx4 v230, s[4:7], s101 offen offset:2432 lds
    buffer_load_dwordx4 v231, s[4:7], s101 offen offset:3456 lds
    s_waitcnt lgkmcnt(0)
    s_add_u32 m0, s63, 0xe00
    s_add_u32 s60, s58, 0x1b0000
    buffer_load_dwordx4 v228, s[4:7], s101 offen offset:512 lds
    buffer_load_dwordx4 v229, s[4:7], s101 offen offset:1536 lds
    buffer_load_dwordx4 v230, s[4:7], s101 offen offset:2560 lds
    buffer_load_dwordx4 v231, s[4:7], s101 offen offset:3584 lds
    s_add_u32 m0, s61, 0xc000
    s_nop 0
    buffer_load_dwordx4 v2, s[8:11], s60 offen offset:0 lds
    buffer_load_dwordx4 v3, s[8:11], s60 offen offset:1024 lds
    buffer_load_dwordx4 v4, s[8:11], s60 offen offset:2048 lds
    s_add_u32 m0, s61, 0xf000
    s_nop 0
    buffer_load_dwordx4 v2, s[12:15], s60 offen offset:0 lds
    buffer_load_dwordx4 v3, s[12:15], s60 offen offset:1024 lds
    buffer_load_dwordx4 v4, s[12:15], s60 offen offset:2048 lds
    s_waitcnt vmcnt(24)
MERGE:
    s_barrier
    ds_read_b64_tr_b16 a[144:145], v8 offset:0
    ds_read_b64_tr_b16 a[146:147], v8 offset:512
    ds_read_b64_tr_b16 a[148:149], v8 offset:12288
    ds_read_b64_tr_b16 a[150:151], v8 offset:12800
    ds_read_b64_tr_b16 a[152:153], v9 offset:0
    ds_read_b64_tr_b16 a[154:155], v9 offset:512
    ds_read_b64_tr_b16 a[156:157], v9 offset:12288
    ds_read_b64_tr_b16 a[158:159], v9 offset:12800
    ds_read_b64_tr_b16 a[160:161], v10 offset:0
    s_waitcnt lgkmcnt(1)
    ds_read_b64_tr_b16 a[162:163], v10 offset:512
    v_mfma_f32_16x16x32_bf16 v[112:115], a[144:147], a[0:3], 0
    ds_read_b64_tr_b16 a[164:165], v10 offset:12288
    ds_read_b64_tr_b16 a[166:167], v10 offset:12800
    v_mfma_f32_16x16x32_bf16 v[116:119], a[144:147], a[4:7], 0
    ds_read_b64_tr_b16 a[168:169], v11 offset:0
    ds_read_b64_tr_b16 a[170:171], v11 offset:512
    ds_read_b64_tr_b16 a[172:173], v11 offset:12288
    ds_read_b64_tr_b16 a[174:175], v11 offset:12800
    v_mfma_f32_16x16x32_bf16 v[124:127], a[148:151], a[4:7], 0
    ds_read_b64_tr_b16 a[176:177], v8 offset:4096
    ds_read_b64_tr_b16 a[178:179], v8 offset:4608
    v_mfma_f32_16x16x32_bf16 v[120:123], a[148:151], a[0:3], 0
    ds_read_b64_tr_b16 a[180:181], v8 offset:16384
    ds_read_b64_tr_b16 a[182:183], v8 offset:16896
    v_mfma_f32_16x16x32_bf16 v[128:131], a[152:155], a[0:3], 0
    ds_read_b64_tr_b16 a[184:185], v9 offset:4096
    v_mfma_f32_16x16x32_bf16 v[132:135], a[152:155], a[4:7], 0
    ds_read_b64_tr_b16 a[186:187], v9 offset:4608
    v_mfma_f32_16x16x32_bf16 v[140:143], a[156:159], a[4:7], 0
    ds_read_b64_tr_b16 a[188:189], v9 offset:16384
    v_mfma_f32_16x16x32_bf16 v[136:139], a[156:159], a[0:3], 0
    s_waitcnt lgkmcnt(7)
    ds_read_b64_tr_b16 a[190:191], v9 offset:16896
    v_mfma_f32_16x16x32_bf16 v[144:147], a[160:163], a[0:3], 0
    ds_read_b64_tr_b16 a[144:145], v10 offset:4096
    v_mfma_f32_16x16x32_bf16 v[148:151], a[160:163], a[4:7], 0
    ds_read_b64_tr_b16 a[146:147], v10 offset:4608
    v_mfma_f32_16x16x32_bf16 v[156:159], a[164:167], a[4:7], 0
    ds_read_b64_tr_b16 a[148:149], v10 offset:16384
    v_mfma_f32_16x16x32_bf16 v[152:155], a[164:167], a[0:3], 0
    ds_read_b64_tr_b16 a[150:151], v10 offset:16896
    v_mfma_f32_16x16x32_bf16 v[160:163], a[168:171], a[0:3], 0
    ds_read_b64_tr_b16 a[152:153], v11 offset:4096
    v_mfma_f32_16x16x32_bf16 v[164:167], a[168:171], a[4:7], 0
    ds_read_b64_tr_b16 a[154:155], v11 offset:4608
    v_mfma_f32_16x16x32_bf16 v[172:175], a[172:175], a[4:7], 0
    ds_read_b64_tr_b16 a[156:157], v11 offset:16384
    v_mfma_f32_16x16x32_bf16 v[168:171], a[172:175], a[0:3], 0
    ds_read_b64_tr_b16 a[158:159], v11 offset:16896
    s_waitcnt lgkmcnt(8)
    v_mfma_f32_16x16x32_bf16 v[112:115], a[176:179], a[8:11], v[112:115]
    s_waitcnt vmcnt(14)
    s_barrier
    v_mfma_f32_16x16x32_bf16 v[116:119], a[176:179], a[12:15], v[116:119]
    ds_read_b64_tr_b16 a[160:161], v8 offset:8192
    v_mfma_f32_16x16x32_bf16 v[124:127], a[180:183], a[12:15], v[124:127]
    ds_read_b64_tr_b16 a[162:163], v8 offset:8704
    ds_read_b64_tr_b16 a[164:165], v8 offset:20480
    v_mfma_f32_16x16x32_bf16 v[120:123], a[180:183], a[8:11], v[120:123]
    ds_read_b64_tr_b16 a[166:167], v8 offset:20992
    ds_read_b64_tr_b16 a[168:169], v9 offset:8192
    v_mfma_f32_16x16x32_bf16 v[128:131], a[184:187], a[8:11], v[128:131]
    ds_read_b128 a[32:35], v232 offset:8192
    v_mfma_f32_16x16x32_bf16 v[132:135], a[184:187], a[12:15], v[132:135]
    ds_read_b64_tr_b16 a[170:171], v9 offset:8704
    ds_read_b64_tr_b16 a[172:173], v9 offset:20480
    v_mfma_f32_16x16x32_bf16 v[140:143], a[188:191], a[12:15], v[140:143]
    ds_read_b128 a[36:39], v232 offset:10240
    v_mfma_f32_16x16x32_bf16 v[136:139], a[188:191], a[8:11], v[136:139]
    s_waitcnt lgkmcnt(9)
    ds_read_b64_tr_b16 a[174:175], v9 offset:20992
    ds_read_b64_tr_b16 a[176:177], v10 offset:8192
    v_mfma_f32_16x16x32_bf16 v[144:147], a[144:147], a[8:11], v[144:147]
    buffer_load_dword v43, off, s[28:31], 0 sc1
    ds_read_b128 a[40:43], v233 offset:8192
    v_mfma_f32_16x16x32_bf16 v[148:151], a[144:147], a[12:15], v[148:151]
    ds_read_b64_tr_b16 a[178:179], v10 offset:8704
    v_mfma_f32_16x16x32_bf16 v[156:159], a[148:151], a[12:15], v[156:159]
    ds_read_b64_tr_b16 a[180:181], v10 offset:20480
    ds_read_b64_tr_b16 a[182:183], v10 offset:20992
    v_mfma_f32_16x16x32_bf16 v[152:155], a[148:151], a[8:11], v[152:155]
    ds_read_b128 a[44:47], v233 offset:10240
    v_mfma_f32_16x16x32_bf16 v[160:163], a[152:155], a[8:11], v[160:163]
    ds_read_b64_tr_b16 a[184:185], v11 offset:8192
    v_mfma_f32_16x16x32_bf16 v[164:167], a[152:155], a[12:15], v[164:167]
    s_waitcnt lgkmcnt(1)
    s_add_u32 m0, s63, 0x1d80
    ds_read_b64_tr_b16 a[186:187], v11 offset:8704
    v_mfma_f32_16x16x32_bf16 v[172:175], a[156:159], a[12:15], v[172:175]
    ds_read_b64_tr_b16 a[188:189], v11 offset:20480
    v_mfma_f32_16x16x32_bf16 v[168:171], a[156:159], a[8:11], v[168:171]
    buffer_load_dwordx4 v228, s[4:7], s101 offen offset:640 lds
    v_mfma_f32_16x16x32_bf16 v[112:115], a[160:163], a[16:19], v[112:115]
    ds_read_b64_tr_b16 a[190:191], v11 offset:20992
    ds_read_b64_tr_b16 a[144:145], v8 offset:24576
    v_mfma_f32_16x16x32_bf16 v[116:119], a[160:163], a[20:23], v[116:119]
    ds_read_b64_tr_b16 a[146:147], v8 offset:25088
    ds_read_b64_tr_b16 a[148:149], v8 offset:36864
    v_mfma_f32_16x16x32_bf16 v[124:127], a[164:167], a[20:23], v[124:127]
    buffer_load_dwordx4 v229, s[4:7], s101 offen offset:1664 lds
    v_mfma_f32_16x16x32_bf16 v[120:123], a[164:167], a[16:19], v[120:123]
    ds_read_b64_tr_b16 a[150:151], v8 offset:37376
    ds_read_b64_tr_b16 a[152:153], v9 offset:24576
    v_mfma_f32_16x16x32_bf16 v[128:131], a[168:171], a[16:19], v[128:131]
    buffer_load_dwordx4 v230, s[4:7], s101 offen offset:2688 lds
    v_mfma_f32_16x16x32_bf16 v[132:135], a[168:171], a[20:23], v[132:135]
    ds_read_b64_tr_b16 a[154:155], v9 offset:25088
    ds_read_b64_tr_b16 a[156:157], v9 offset:36864
    v_mfma_f32_16x16x32_bf16 v[140:143], a[172:175], a[20:23], v[140:143]
    buffer_load_dwordx4 v231, s[4:7], s101 offen offset:3712 lds
    v_mfma_f32_16x16x32_bf16 v[136:139], a[172:175], a[16:19], v[136:139]
    ds_read_b64_tr_b16 a[158:159], v9 offset:37376
    s_waitcnt lgkmcnt(8)
    v_mfma_f32_16x16x32_bf16 v[144:147], a[176:179], a[16:19], v[144:147]
    ds_read_b64_tr_b16 a[160:161], v10 offset:24576
    v_mfma_f32_16x16x32_bf16 v[148:151], a[176:179], a[20:23], v[148:151]
    ds_read_b64_tr_b16 a[162:163], v10 offset:25088
    v_mfma_f32_16x16x32_bf16 v[156:159], a[180:183], a[20:23], v[156:159]
    s_add_u32 s60, s58, 0x288000
    s_add_u32 m0, s61, 0x12000
    ds_read_b64_tr_b16 a[164:165], v10 offset:36864
    v_mfma_f32_16x16x32_bf16 v[152:155], a[180:183], a[16:19], v[152:155]
    ds_read_b64_tr_b16 a[166:167], v10 offset:37376
    v_mfma_f32_16x16x32_bf16 v[160:163], a[184:187], a[16:19], v[160:163]
    ds_read_b64_tr_b16 a[168:169], v11 offset:24576
    ds_read_b64_tr_b16 a[170:171], v11 offset:25088
    v_mfma_f32_16x16x32_bf16 v[164:167], a[184:187], a[20:23], v[164:167]
    buffer_load_dwordx4 v2, s[8:11], s60 offen offset:0 lds
    v_mfma_f32_16x16x32_bf16 v[172:175], a[188:191], a[20:23], v[172:175]
    ds_read_b64_tr_b16 a[172:173], v11 offset:36864
    v_mfma_f32_16x16x32_bf16 v[168:171], a[188:191], a[16:19], v[168:171]
    s_waitcnt lgkmcnt(7)
    ds_read_b64_tr_b16 a[174:175], v11 offset:37376
    ds_read_b64_tr_b16 a[176:177], v8 offset:28672
    v_mfma_f32_16x16x32_bf16 v[112:115], a[144:147], a[24:27], v[112:115]
    buffer_load_dwordx4 v3, s[8:11], s60 offen offset:1024 lds
    v_mfma_f32_16x16x32_bf16 v[116:119], a[144:147], a[28:31], v[116:119]
    ds_read_b64_tr_b16 a[178:179], v8 offset:29184
    ds_read_b64_tr_b16 a[180:181], v8 offset:40960
    v_mfma_f32_16x16x32_bf16 v[124:127], a[148:151], a[28:31], v[124:127]
    buffer_load_dwordx4 v4, s[8:11], s60 offen offset:2048 lds
    v_mfma_f32_16x16x32_bf16 v[120:123], a[148:151], a[24:27], v[120:123]
    s_add_u32 m0, s61, 0x15000
    ds_read_b64_tr_b16 a[182:183], v8 offset:41472
    ds_read_b64_tr_b16 a[184:185], v9 offset:28672
    v_mfma_f32_16x16x32_bf16 v[128:131], a[152:155], a[24:27], v[128:131]
    ds_read_b64_tr_b16 a[186:187], v9 offset:29184
    v_mfma_f32_16x16x32_bf16 v[132:135], a[152:155], a[28:31], v[132:135]
    ds_read_b64_tr_b16 a[188:189], v9 offset:40960
    v_mfma_f32_16x16x32_bf16 v[140:143], a[156:159], a[28:31], v[140:143]
    ds_read_b64_tr_b16 a[190:191], v9 offset:41472
    v_mfma_f32_16x16x32_bf16 v[136:139], a[156:159], a[24:27], v[136:139]
    s_waitcnt lgkmcnt(8)
    buffer_load_dwordx4 v2, s[12:15], s60 offen offset:0 lds
    v_mfma_f32_16x16x32_bf16 v[144:147], a[160:163], a[24:27], v[144:147]
    ds_read_b64_tr_b16 a[144:145], v10 offset:28672
    v_mfma_f32_16x16x32_bf16 v[148:151], a[160:163], a[28:31], v[148:151]
    buffer_load_dwordx4 v3, s[12:15], s60 offen offset:1024 lds
    v_mfma_f32_16x16x32_bf16 v[156:159], a[164:167], a[28:31], v[156:159]
    ds_read_b64_tr_b16 a[146:147], v10 offset:29184
    v_mfma_f32_16x16x32_bf16 v[152:155], a[164:167], a[24:27], v[152:155]
    buffer_load_dwordx4 v4, s[12:15], s60 offen offset:2048 lds
    v_mfma_f32_16x16x32_bf16 v[160:163], a[168:171], a[24:27], v[160:163]
    ds_read_b64_tr_b16 a[148:149], v10 offset:40960
    v_mfma_f32_16x16x32_bf16 v[164:167], a[168:171], a[28:31], v[164:167]
    ds_read_b64_tr_b16 a[150:151], v10 offset:41472
    ds_read_b64_tr_b16 a[152:153], v11 offset:28672
    v_mfma_f32_16x16x32_bf16 v[172:175], a[172:175], a[28:31], v[172:175]
    ds_read_b64_tr_b16 a[154:155], v11 offset:29184
    ds_read_b64_tr_b16 a[156:157], v11 offset:40960
    v_mfma_f32_16x16x32_bf16 v[168:171], a[172:175], a[24:27], v[168:171]
    ds_read_b64_tr_b16 a[158:159], v11 offset:41472
    s_waitcnt lgkmcnt(8)
    v_mfma_f32_16x16x32_bf16 v[112:115], a[176:179], a[32:35], v[112:115]
    s_waitcnt vmcnt(11)
    s_barrier
    v_mfma_f32_16x16x32_bf16 v[116:119], a[176:179], a[36:39], v[116:119]
    ds_read_b64_tr_b16 a[160:161], v8 offset:32768
    ds_read_b64_tr_b16 a[162:163], v8 offset:33280
    v_mfma_f32_16x16x32_bf16 v[124:127], a[180:183], a[36:39], v[124:127]
    ds_read_b64_tr_b16 a[164:165], v8 offset:45056
    ds_read_b64_tr_b16 a[166:167], v8 offset:45568
    v_mfma_f32_16x16x32_bf16 v[120:123], a[180:183], a[32:35], v[120:123]
    ds_read_b128 a[48:51], v232 offset:0
    v_mfma_f32_16x16x32_bf16 v[128:131], a[184:187], a[32:35], v[128:131]
    ds_read_b64_tr_b16 a[168:169], v9 offset:32768
    ds_read_b64_tr_b16 a[170:171], v9 offset:33280
    v_mfma_f32_16x16x32_bf16 v[132:135], a[184:187], a[36:39], v[132:135]
    ds_read_b128 a[52:55], v232 offset:2048
    ds_read_b64_tr_b16 a[172:173], v9 offset:45056
    v_mfma_f32_16x16x32_bf16 v[140:143], a[188:191], a[36:39], v[140:143]
    ds_read_b128 a[56:59], v233 offset:0
    v_mfma_f32_16x16x32_bf16 v[136:139], a[188:191], a[32:35], v[136:139]
    s_waitcnt lgkmcnt(10)
    ds_read_b64_tr_b16 a[174:175], v9 offset:45568
    ds_read_b64_tr_b16 a[176:177], v10 offset:32768
    v_mfma_f32_16x16x32_bf16 v[144:147], a[144:147], a[32:35], v[144:147]
    ds_read_b128 a[60:63], v233 offset:2048
    v_mfma_f32_16x16x32_bf16 v[148:151], a[144:147], a[36:39], v[148:151]
    s_waitcnt lgkmcnt(0)
    s_add_u32 m0, s63, 0xfffffd00
    ds_read_b64_tr_b16 a[178:179], v10 offset:33280
    v_mfma_f32_16x16x32_bf16 v[156:159], a[148:151], a[36:39], v[156:159]
    ds_read_b64_tr_b16 a[180:181], v10 offset:45056
    ds_read_b64_tr_b16 a[182:183], v10 offset:45568
    v_mfma_f32_16x16x32_bf16 v[152:155], a[148:151], a[32:35], v[152:155]
    buffer_load_dwordx4 v228, s[4:7], s101 offen offset:768 lds
    v_mfma_f32_16x16x32_bf16 v[160:163], a[152:155], a[32:35], v[160:163]
    buffer_load_dwordx4 v229, s[4:7], s101 offen offset:1792 lds
    v_mfma_f32_16x16x32_bf16 v[164:167], a[152:155], a[36:39], v[164:167]
    ds_read_b64_tr_b16 a[184:185], v11 offset:32768
    ds_read_b64_tr_b16 a[186:187], v11 offset:33280
    v_mfma_f32_16x16x32_bf16 v[172:175], a[156:159], a[36:39], v[172:175]
    buffer_load_dwordx4 v230, s[4:7], s101 offen offset:2816 lds
    v_mfma_f32_16x16x32_bf16 v[168:171], a[156:159], a[32:35], v[168:171]
    buffer_load_dwordx4 v231, s[4:7], s101 offen offset:3840 lds
    ds_read_b64_tr_b16 a[188:189], v11 offset:45056
    v_mfma_f32_16x16x32_bf16 v[112:115], a[160:163], a[40:43], v[112:115]
    ds_read_b64_tr_b16 a[190:191], v11 offset:45568
    ds_read_b64_tr_b16 a[144:145], v12 offset:0
    v_mfma_f32_16x16x32_bf16 v[116:119], a[160:163], a[44:47], v[116:119]
    ds_read_b64_tr_b16 a[146:147], v12 offset:512
    ds_read_b64_tr_b16 a[148:149], v12 offset:12288
    v_mfma_f32_16x16x32_bf16 v[124:127], a[164:167], a[44:47], v[124:127]
    ds_read_b128 a[64:67], v232 offset:4096
    v_mfma_f32_16x16x32_bf16 v[120:123], a[164:167], a[40:43], v[120:123]
    ds_read_b64_tr_b16 a[150:151], v12 offset:12800
    ds_read_b64_tr_b16 a[152:153], v13 offset:0
    v_mfma_f32_16x16x32_bf16 v[128:131], a[168:171], a[40:43], v[128:131]
    ds_read_b128 a[68:71], v232 offset:6144
    ds_read_b64_tr_b16 a[154:155], v13 offset:512
    v_mfma_f32_16x16x32_bf16 v[132:135], a[168:171], a[44:47], v[132:135]
    ds_read_b128 a[72:75], v233 offset:4096
    v_mfma_f32_16x16x32_bf16 v[140:143], a[172:175], a[44:47], v[140:143]
    ds_read_b64_tr_b16 a[156:157], v13 offset:12288
    ds_read_b64_tr_b16 a[158:159], v13 offset:12800
    v_mfma_f32_16x16x32_bf16 v[136:139], a[172:175], a[40:43], v[136:139]
    s_waitcnt lgkmcnt(11)
    ds_read_b128 a[76:79], v233 offset:6144
    v_mfma_f32_16x16x32_bf16 v[144:147], a[176:179], a[40:43], v[144:147]
    s_waitcnt lgkmcnt(0)
    ds_read_b64_tr_b16 a[160:161], v14 offset:0
    s_add_u32 m0, s63, 0xc80
    v_mfma_f32_16x16x32_bf16 v[148:151], a[176:179], a[44:47], v[148:151]
    ds_read_b64_tr_b16 a[162:163], v14 offset:512
    ds_read_b64_tr_b16 a[164:165], v14 offset:12288
    v_mfma_f32_16x16x32_bf16 v[156:159], a[180:183], a[44:47], v[156:159]
    buffer_load_dwordx4 v228, s[4:7], s101 offen offset:896 lds
    v_mfma_f32_16x16x32_bf16 v[152:155], a[180:183], a[40:43], v[152:155]
    buffer_load_dwordx4 v229, s[4:7], s101 offen offset:1920 lds
    v_mfma_f32_16x16x32_bf16 v[160:163], a[184:187], a[40:43], v[160:163]
    ds_read_b64_tr_b16 a[166:167], v14 offset:12800
    ds_read_b64_tr_b16 a[168:169], v15 offset:0
    v_mfma_f32_16x16x32_bf16 v[164:167], a[184:187], a[44:47], v[164:167]
    buffer_load_dwordx4 v230, s[4:7], s101 offen offset:2944 lds
    v_mfma_f32_16x16x32_bf16 v[172:175], a[188:191], a[44:47], v[172:175]
    ds_read_b64_tr_b16 a[170:171], v15 offset:512
    buffer_load_dwordx4 v231, s[4:7], s101 offen offset:3968 lds
    v_mfma_f32_16x16x32_bf16 v[168:171], a[188:191], a[40:43], v[168:171]
    ds_read_b64_tr_b16 a[172:173], v15 offset:12288
    ds_read_b64_tr_b16 a[174:175], v15 offset:12800
    v_mfma_f32_16x16x32_bf16 v[112:115], a[144:147], a[48:51], v[112:115]
    s_add_u32 s60, s58, 0x360000
    s_add_u32 m0, s61, 0x0
    ds_read_b64_tr_b16 a[176:177], v12 offset:4096
    v_mfma_f32_16x16x32_bf16 v[116:119], a[144:147], a[52:55], v[116:119]
    ds_read_b64_tr_b16 a[178:179], v12 offset:4608
    ds_read_b64_tr_b16 a[180:181], v12 offset:16384
    v_mfma_f32_16x16x32_bf16 v[124:127], a[148:151], a[52:55], v[124:127]
    ds_read_b64_tr_b16 a[182:183], v12 offset:16896
    v_mfma_f32_16x16x32_bf16 v[120:123], a[148:151], a[48:51], v[120:123]
    buffer_load_dwordx4 v2, s[8:11], s60 offen offset:0 lds
    v_mfma_f32_16x16x32_bf16 v[128:131], a[152:155], a[48:51], v[128:131]
    s_waitcnt vmcnt(19)
    v_cmp_eq_u32 vcc, 0, v43
    ds_read_b64_tr_b16 a[184:185], v13 offset:4096
    buffer_load_dwordx4 v3, s[8:11], s60 offen offset:1024 lds
    ds_read_b64_tr_b16 a[186:187], v13 offset:4608
    v_mfma_f32_16x16x32_bf16 v[132:135], a[152:155], a[52:55], v[132:135]
    s_cbranch_vccnz SLOW0
BACK0:
    v_mfma_f32_16x16x32_bf16 v[140:143], a[156:159], a[52:55], v[140:143]
    buffer_load_dwordx4 v4, s[8:11], s60 offen offset:2048 lds
    ds_read_b64_tr_b16 a[188:189], v13 offset:16384
    v_mfma_f32_16x16x32_bf16 v[136:139], a[156:159], a[48:51], v[136:139]
    ds_read_b64_tr_b16 a[190:191], v13 offset:16896
    s_waitcnt lgkmcnt(8)
    v_mfma_f32_16x16x32_bf16 v[144:147], a[160:163], a[48:51], v[144:147]
    s_add_u32 m0, s61, 0x3000
    ds_read_b64_tr_b16 a[144:145], v14 offset:4096
    ds_read_b64_tr_b16 a[146:147], v14 offset:4608
    v_mfma_f32_16x16x32_bf16 v[148:151], a[160:163], a[52:55], v[148:151]
    buffer_load_dwordx4 v2, s[12:15], s60 offen offset:0 lds
    v_mfma_f32_16x16x32_bf16 v[156:159], a[164:167], a[52:55], v[156:159]
    buffer_load_dwordx4 v3, s[12:15], s60 offen offset:1024 lds
    v_mfma_f32_16x16x32_bf16 v[152:155], a[164:167], a[48:51], v[152:155]
    ds_read_b64_tr_b16 a[148:149], v14 offset:16384
    ds_read_b64_tr_b16 a[150:151], v14 offset:16896
    v_mfma_f32_16x16x32_bf16 v[160:163], a[168:171], a[48:51], v[160:163]
    buffer_load_dwordx4 v4, s[12:15], s60 offen offset:2048 lds
    v_mfma_f32_16x16x32_bf16 v[164:167], a[168:171], a[52:55], v[164:167]
    ds_read_b64_tr_b16 a[152:153], v15 offset:4096
    ds_read_b64_tr_b16 a[154:155], v15 offset:4608
    v_mfma_f32_16x16x32_bf16 v[172:175], a[172:175], a[52:55], v[172:175]
    ds_read_b64_tr_b16 a[156:157], v15 offset:16384
    v_mfma_f32_16x16x32_bf16 v[168:171], a[172:175], a[48:51], v[168:171]
    s_waitcnt lgkmcnt(7)
    ds_read_b64_tr_b16 a[158:159], v15 offset:16896
    ds_read_b64_tr_b16 a[160:161], v12 offset:8192
    v_mfma_f32_16x16x32_bf16 v[112:115], a[176:179], a[56:59], v[112:115]
    s_waitcnt vmcnt(14)
    s_barrier
    v_mfma_f32_16x16x32_bf16 v[116:119], a[176:179], a[60:63], v[116:119]
    buffer_store_dword v43, v42, s[24:27], s32 offen offset:0 sc1
    v_mfma_f32_16x16x32_bf16 v[124:127], a[180:183], a[60:63], v[124:127]
    ds_read_b64_tr_b16 a[162:163], v12 offset:8704
    ds_read_b64_tr_b16 a[164:165], v12 offset:20480
    v_mfma_f32_16x16x32_bf16 v[120:123], a[180:183], a[56:59], v[120:123]
    buffer_store_dword v43, v42, s[24:27], s33 offen offset:0 sc1
    ds_read_b64_tr_b16 a[166:167], v12 offset:20992
    v_mfma_f32_16x16x32_bf16 v[128:131], a[184:187], a[56:59], v[128:131]
    ds_read_b64_tr_b16 a[168:169], v13 offset:8192
    ds_read_b128 a[80:83], v232 offset:8192
    v_mfma_f32_16x16x32_bf16 v[132:135], a[184:187], a[60:63], v[132:135]
    ds_read_b64_tr_b16 a[170:171], v13 offset:8704
    ds_read_b64_tr_b16 a[172:173], v13 offset:20480
    v_mfma_f32_16x16x32_bf16 v[140:143], a[188:191], a[60:63], v[140:143]
    ds_read_b128 a[84:87], v232 offset:10240
    v_mfma_f32_16x16x32_bf16 v[136:139], a[188:191], a[56:59], v[136:139]
    s_waitcnt lgkmcnt(9)
    ds_read_b64_tr_b16 a[174:175], v13 offset:20992
    ds_read_b64_tr_b16 a[176:177], v14 offset:8192
    v_mfma_f32_16x16x32_bf16 v[144:147], a[144:147], a[56:59], v[144:147]
    ds_read_b128 a[88:91], v233 offset:8192
    v_mfma_f32_16x16x32_bf16 v[148:151], a[144:147], a[60:63], v[148:151]
    ds_read_b64_tr_b16 a[178:179], v14 offset:8704
    ds_read_b64_tr_b16 a[180:181], v14 offset:20480
    v_mfma_f32_16x16x32_bf16 v[156:159], a[148:151], a[60:63], v[156:159]
    ds_read_b64_tr_b16 a[182:183], v14 offset:20992
    v_mfma_f32_16x16x32_bf16 v[152:155], a[148:151], a[56:59], v[152:155]
    ds_read_b128 a[92:95], v233 offset:10240
    v_mfma_f32_16x16x32_bf16 v[160:163], a[152:155], a[56:59], v[160:163]
    ds_read_b64_tr_b16 a[184:185], v15 offset:8192
    v_mfma_f32_16x16x32_bf16 v[164:167], a[152:155], a[60:63], v[164:167]
    s_waitcnt lgkmcnt(1)
    ds_read_b64_tr_b16 a[186:187], v15 offset:8704
    v_mfma_f32_16x16x32_bf16 v[172:175], a[156:159], a[60:63], v[172:175]
    s_add_u32 m0, s63, 0x2000
    ds_read_b64_tr_b16 a[188:189], v15 offset:20480
    s_add_u32 s62, s101, 1024
    v_mfma_f32_16x16x32_bf16 v[168:171], a[156:159], a[56:59], v[168:171]
    buffer_load_dwordx4 v228, s[4:7], s62 offen offset:0 lds
    v_mfma_f32_16x16x32_bf16 v[112:115], a[160:163], a[64:67], v[112:115]
    ds_read_b64_tr_b16 a[190:191], v15 offset:20992
    ds_read_b64_tr_b16 a[144:145], v12 offset:24576
    v_mfma_f32_16x16x32_bf16 v[116:119], a[160:163], a[68:71], v[116:119]
    ds_read_b64_tr_b16 a[146:147], v12 offset:25088
    ds_read_b64_tr_b16 a[148:149], v12 offset:36864
    v_mfma_f32_16x16x32_bf16 v[124:127], a[164:167], a[68:71], v[124:127]
    buffer_load_dwordx4 v229, s[4:7], s62 offen offset:1024 lds
    v_mfma_f32_16x16x32_bf16 v[120:123], a[164:167], a[64:67], v[120:123]
    ds_read_b64_tr_b16 a[150:151], v12 offset:37376
    ds_read_b64_tr_b16 a[152:153], v13 offset:24576
    v_mfma_f32_16x16x32_bf16 v[128:131], a[168:171], a[64:67], v[128:131]
    buffer_load_dwordx4 v230, s[4:7], s62 offen offset:2048 lds
    v_mfma_f32_16x16x32_bf16 v[132:135], a[168:171], a[68:71], v[132:135]
    ds_read_b64_tr_b16 a[154:155], v13 offset:25088
    ds_read_b64_tr_b16 a[156:157], v13 offset:36864
    v_mfma_f32_16x16x32_bf16 v[140:143], a[172:175], a[68:71], v[140:143]
    buffer_load_dwordx4 v231, s[4:7], s62 offen offset:3072 lds
    v_mfma_f32_16x16x32_bf16 v[136:139], a[172:175], a[64:67], v[136:139]
    s_waitcnt lgkmcnt(7)
    ds_read_b64_tr_b16 a[158:159], v13 offset:37376
    v_mfma_f32_16x16x32_bf16 v[144:147], a[176:179], a[64:67], v[144:147]
    ds_read_b64_tr_b16 a[160:161], v14 offset:24576
    v_mfma_f32_16x16x32_bf16 v[148:151], a[176:179], a[68:71], v[148:151]
    ds_read_b64_tr_b16 a[162:163], v14 offset:25088
    v_mfma_f32_16x16x32_bf16 v[156:159], a[180:183], a[68:71], v[156:159]
    ds_read_b64_tr_b16 a[164:165], v14 offset:36864
    v_mfma_f32_16x16x32_bf16 v[152:155], a[180:183], a[64:67], v[152:155]
    ds_read_b64_tr_b16 a[166:167], v14 offset:37376
    s_add_u32 s60, s58, 0x438000
    v_mfma_f32_16x16x32_bf16 v[160:163], a[184:187], a[64:67], v[160:163]
    ds_read_b64_tr_b16 a[168:169], v15 offset:24576
    s_add_u32 m0, s61, 0x6000
    v_mfma_f32_16x16x32_bf16 v[164:167], a[184:187], a[68:71], v[164:167]
    buffer_load_dwordx4 v2, s[8:11], s60 offen offset:0 lds
    v_mfma_f32_16x16x32_bf16 v[172:175], a[188:191], a[68:71], v[172:175]
    ds_read_b64_tr_b16 a[170:171], v15 offset:25088
    v_mfma_f32_16x16x32_bf16 v[168:171], a[188:191], a[64:67], v[168:171]
    s_waitcnt lgkmcnt(6)
    ds_read_b64_tr_b16 a[172:173], v15 offset:36864
    ds_read_b64_tr_b16 a[174:175], v15 offset:37376
    v_mfma_f32_16x16x32_bf16 v[112:115], a[144:147], a[72:75], v[112:115]
    buffer_load_dwordx4 v3, s[8:11], s60 offen offset:1024 lds
    v_mfma_f32_16x16x32_bf16 v[116:119], a[144:147], a[76:79], v[116:119]
    ds_read_b64_tr_b16 a[176:177], v12 offset:28672
    v_mfma_f32_16x16x32_bf16 v[124:127], a[148:151], a[76:79], v[124:127]
    buffer_load_dwordx4 v4, s[8:11], s60 offen offset:2048 lds
    v_mfma_f32_16x16x32_bf16 v[120:123], a[148:151], a[72:75], v[120:123]
    ds_read_b64_tr_b16 a[178:179], v12 offset:29184
    ds_read_b64_tr_b16 a[180:181], v12 offset:40960
    v_mfma_f32_16x16x32_bf16 v[128:131], a[152:155], a[72:75], v[128:131]
    ds_read_b64_tr_b16 a[182:183], v12 offset:41472
    v_mfma_f32_16x16x32_bf16 v[132:135], a[152:155], a[76:79], v[132:135]
    s_add_u32 m0, s61, 0x9000
    ds_read_b64_tr_b16 a[184:185], v13 offset:28672
    ds_read_b64_tr_b16 a[186:187], v13 offset:29184
    v_mfma_f32_16x16x32_bf16 v[140:143], a[156:159], a[76:79], v[140:143]
    ds_read_b64_tr_b16 a[188:189], v13 offset:40960
    ds_read_b64_tr_b16 a[190:191], v13 offset:41472
    v_mfma_f32_16x16x32_bf16 v[136:139], a[156:159], a[72:75], v[136:139]
    s_waitcnt lgkmcnt(8)
    buffer_load_dwordx4 v2, s[12:15], s60 offen offset:0 lds
    v_mfma_f32_16x16x32_bf16 v[144:147], a[160:163], a[72:75], v[144:147]
    ds_read_b64_tr_b16 a[144:145], v14 offset:28672
    v_mfma_f32_16x16x32_bf16 v[148:151], a[160:163], a[76:79], v[148:151]
    buffer_load_dwordx4 v3, s[12:15], s60 offen offset:1024 lds
    v_mfma_f32_16x16x32_bf16 v[156:159], a[164:167], a[76:79], v[156:159]
    ds_read_b64_tr_b16 a[146:147], v14 offset:29184
    v_mfma_f32_16x16x32_bf16 v[152:155], a[164:167], a[72:75], v[152:155]
    buffer_load_dwordx4 v4, s[12:15], s60 offen offset:2048 lds
    v_mfma_f32_16x16x32_bf16 v[160:163], a[168:171], a[72:75], v[160:163]
    ds_read_b64_tr_b16 a[148:149], v14 offset:40960
    v_mfma_f32_16x16x32_bf16 v[164:167], a[168:171], a[76:79], v[164:167]
    ds_read_b64_tr_b16 a[150:151], v14 offset:41472
    v_mfma_f32_16x16x32_bf16 v[172:175], a[172:175], a[76:79], v[172:175]
    ds_read_b64_tr_b16 a[152:153], v15 offset:28672
    ds_read_b64_tr_b16 a[154:155], v15 offset:29184
    v_mfma_f32_16x16x32_bf16 v[168:171], a[172:175], a[72:75], v[168:171]
    s_waitcnt lgkmcnt(6)
    ds_read_b64_tr_b16 a[156:157], v15 offset:40960
    ds_read_b64_tr_b16 a[158:159], v15 offset:41472
    v_mfma_f32_16x16x32_bf16 v[112:115], a[176:179], a[80:83], v[112:115]
    s_waitcnt vmcnt(12)
    s_barrier
    v_mfma_f32_16x16x32_bf16 v[116:119], a[176:179], a[84:87], v[116:119]
    ds_read_b64_tr_b16 a[160:161], v12 offset:32768
    v_mfma_f32_16x16x32_bf16 v[124:127], a[180:183], a[84:87], v[124:127]
    ds_read_b64_tr_b16 a[162:163], v12 offset:33280
    ds_read_b64_tr_b16 a[164:165], v12 offset:45056
    v_mfma_f32_16x16x32_bf16 v[120:123], a[180:183], a[80:83], v[120:123]
    ds_read_b64_tr_b16 a[166:167], v12 offset:45568
    ds_read_b64_tr_b16 a[168:169], v13 offset:32768
    v_mfma_f32_16x16x32_bf16 v[128:131], a[184:187], a[80:83], v[128:131]
    ds_read_b128 a[96:99], v232 offset:0
    global_load_dwordx4 a[192:195], v203, s[48:49] offset:0
    v_mfma_f32_16x16x32_bf16 v[132:135], a[184:187], a[84:87], v[132:135]
    ds_read_b64_tr_b16 a[170:171], v13 offset:33280
    ds_read_b64_tr_b16 a[172:173], v13 offset:45056
    v_mfma_f32_16x16x32_bf16 v[140:143], a[188:191], a[84:87], v[140:143]
    ds_read_b128 a[100:103], v232 offset:2048
    v_mfma_f32_16x16x32_bf16 v[136:139], a[188:191], a[80:83], v[136:139]
    s_waitcnt lgkmcnt(9)
    ds_read_b64_tr_b16 a[174:175], v13 offset:45568
    ds_read_b64_tr_b16 a[176:177], v14 offset:32768
    v_mfma_f32_16x16x32_bf16 v[144:147], a[144:147], a[80:83], v[144:147]
    ds_read_b128 a[104:107], v233 offset:0
    global_load_dwordx4 a[196:199], v203, s[48:49] offset:64
    v_mfma_f32_16x16x32_bf16 v[148:151], a[144:147], a[84:87], v[148:151]
    ds_read_b64_tr_b16 a[178:179], v14 offset:33280
    ds_read_b64_tr_b16 a[180:181], v14 offset:45056
    v_mfma_f32_16x16x32_bf16 v[156:159], a[148:151], a[84:87], v[156:159]
    ds_read_b64_tr_b16 a[182:183], v14 offset:45568
    s_add_u32 s60, s58, 0x80
    v_mfma_f32_16x16x32_bf16 v[152:155], a[148:151], a[80:83], v[152:155]
    ds_read_b128 a[108:111], v233 offset:2048
    v_mfma_f32_16x16x32_bf16 v[160:163], a[152:155], a[80:83], v[160:163]
    global_load_dwordx4 a[200:203], v203, s[48:49] offset:128
    v_mfma_f32_16x16x32_bf16 v[164:167], a[152:155], a[84:87], v[164:167]
    ds_read_b64_tr_b16 a[184:185], v15 offset:32768
    v_mfma_f32_16x16x32_bf16 v[172:175], a[156:159], a[84:87], v[172:175]
    ds_read_b64_tr_b16 a[186:187], v15 offset:33280
    ds_read_b64_tr_b16 a[188:189], v15 offset:45056
    v_mfma_f32_16x16x32_bf16 v[168:171], a[156:159], a[80:83], v[168:171]
    s_waitcnt lgkmcnt(9)
    s_add_u32 m0, s61, 0xc000
    ds_read_b64_tr_b16 a[190:191], v15 offset:45568
    v_mfma_f32_16x16x32_bf16 v[112:115], a[160:163], a[88:91], v[112:115]
    global_load_dwordx4 a[204:207], v203, s[48:49] offset:192
    v_mfma_f32_16x16x32_bf16 v[116:119], a[160:163], a[92:95], v[116:119]
    ds_read_b64_tr_b16 a[144:145], v8 offset:0
    ds_read_b64_tr_b16 a[146:147], v8 offset:512
    v_mfma_f32_16x16x32_bf16 v[124:127], a[164:167], a[92:95], v[124:127]
    buffer_load_dwordx4 v2, s[8:11], s60 offen offset:0 lds
    v_mfma_f32_16x16x32_bf16 v[120:123], a[164:167], a[88:91], v[120:123]
    global_load_dwordx4 a[208:211], v203, s[48:49] offset:256
    ds_read_b64_tr_b16 a[148:149], v8 offset:12288
    v_mfma_f32_16x16x32_bf16 v[128:131], a[168:171], a[88:91], v[128:131]
    buffer_load_dwordx4 v3, s[8:11], s60 offen offset:1024 lds
    ds_read_b64_tr_b16 a[150:151], v8 offset:12800
    v_mfma_f32_16x16x32_bf16 v[132:135], a[168:171], a[92:95], v[132:135]
    ds_read_b64_tr_b16 a[152:153], v9 offset:0
    ds_read_b64_tr_b16 a[154:155], v9 offset:512
    v_mfma_f32_16x16x32_bf16 v[140:143], a[172:175], a[92:95], v[140:143]
    ds_read_b64_tr_b16 a[156:157], v9 offset:12288
    buffer_load_dwordx4 v4, s[8:11], s60 offen offset:2048 lds
    v_mfma_f32_16x16x32_bf16 v[136:139], a[172:175], a[88:91], v[136:139]
    s_waitcnt lgkmcnt(7)
    ds_read_b64_tr_b16 a[158:159], v9 offset:12800
    ds_read_b64_tr_b16 a[160:161], v10 offset:0
    v_mfma_f32_16x16x32_bf16 v[144:147], a[176:179], a[88:91], v[144:147]
    global_load_dwordx4 a[212:215], v203, s[48:49] offset:320
    v_mfma_f32_16x16x32_bf16 v[148:151], a[176:179], a[92:95], v[148:151]
    s_add_u32 m0, s61, 0xf000
    ds_read_b64_tr_b16 a[162:163], v10 offset:512
    ds_read_b64_tr_b16 a[164:165], v10 offset:12288
    v_mfma_f32_16x16x32_bf16 v[156:159], a[180:183], a[92:95], v[156:159]
    ds_read_b64_tr_b16 a[166:167], v10 offset:12800
    ds_read_b64_tr_b16 a[168:169], v11 offset:0
    v_mfma_f32_16x16x32_bf16 v[152:155], a[180:183], a[88:91], v[152:155]
    buffer_load_dwordx4 v2, s[12:15], s60 offen offset:0 lds
    v_mfma_f32_16x16x32_bf16 v[160:163], a[184:187], a[88:91], v[160:163]
    global_load_dwordx4 a[216:219], v203, s[48:49] offset:384
    v_mfma_f32_16x16x32_bf16 v[164:167], a[184:187], a[92:95], v[164:167]
    buffer_load_dwordx4 v3, s[12:15], s60 offen offset:1024 lds
    v_mfma_f32_16x16x32_bf16 v[172:175], a[188:191], a[92:95], v[172:175]
    ds_read_b64_tr_b16 a[170:171], v11 offset:512
    ds_read_b64_tr_b16 a[172:173], v11 offset:12288
    v_mfma_f32_16x16x32_bf16 v[168:171], a[188:191], a[88:91], v[168:171]
    s_waitcnt lgkmcnt(7)
    ds_read_b64_tr_b16 a[174:175], v11 offset:12800
    v_mfma_f32_16x16x32_bf16 v[112:115], a[144:147], a[96:99], v[112:115]
    global_load_dwordx4 a[220:223], v203, s[48:49] offset:448
    v_mfma_f32_16x16x32_bf16 v[116:119], a[144:147], a[100:103], v[116:119]
    ds_read_b64_tr_b16 a[176:177], v8 offset:4096
    ds_read_b64_tr_b16 a[178:179], v8 offset:4608
    v_mfma_f32_16x16x32_bf16 v[124:127], a[148:151], a[100:103], v[124:127]
    buffer_load_dwordx4 v4, s[12:15], s60 offen offset:2048 lds
    v_mfma_f32_16x16x32_bf16 v[120:123], a[148:151], a[96:99], v[120:123]
    ds_read_b64_tr_b16 a[180:181], v8 offset:16384
    ds_read_b64_tr_b16 a[182:183], v8 offset:16896
    v_mfma_f32_16x16x32_bf16 v[128:131], a[152:155], a[96:99], v[128:131]
    ds_read_b64_tr_b16 a[184:185], v9 offset:4096
    global_load_dwordx4 a[224:227], v203, s[48:49] offset:512
    ds_read_b128 a[112:115], v232 offset:4096
    v_mfma_f32_16x16x32_bf16 v[132:135], a[152:155], a[100:103], v[132:135]
    ds_read_b64_tr_b16 a[186:187], v9 offset:4608
    ds_read_b64_tr_b16 a[188:189], v9 offset:16384
    v_mfma_f32_16x16x32_bf16 v[140:143], a[156:159], a[100:103], v[140:143]
    ds_read_b64_tr_b16 a[190:191], v9 offset:16896
    ds_read_b128 a[116:119], v232 offset:6144
    v_mfma_f32_16x16x32_bf16 v[136:139], a[156:159], a[96:99], v[136:139]
    s_waitcnt lgkmcnt(10)
    ds_read_b64_tr_b16 a[144:145], v10 offset:4096
    ds_read_b64_tr_b16 a[146:147], v10 offset:4608
    v_mfma_f32_16x16x32_bf16 v[144:147], a[160:163], a[96:99], v[144:147]
    global_load_dwordx4 a[228:231], v203, s[48:49] offset:576
    v_mfma_f32_16x16x32_bf16 v[148:151], a[160:163], a[100:103], v[148:151]
    ds_read_b128 a[120:123], v233 offset:4096
    v_mfma_f32_16x16x32_bf16 v[156:159], a[164:167], a[100:103], v[156:159]
    ds_read_b64_tr_b16 a[148:149], v10 offset:16384
    ds_read_b64_tr_b16 a[150:151], v10 offset:16896
    v_mfma_f32_16x16x32_bf16 v[152:155], a[164:167], a[96:99], v[152:155]
    ds_read_b128 a[124:127], v233 offset:6144
    v_mfma_f32_16x16x32_bf16 v[160:163], a[168:171], a[96:99], v[160:163]
    global_load_dwordx4 a[232:235], v203, s[48:49] offset:640
    v_mfma_f32_16x16x32_bf16 v[164:167], a[168:171], a[100:103], v[164:167]
    ds_read_b64_tr_b16 a[152:153], v11 offset:4096
    v_mfma_f32_16x16x32_bf16 v[172:175], a[172:175], a[100:103], v[172:175]
    ds_read_b64_tr_b16 a[154:155], v11 offset:4608
    v_mfma_f32_16x16x32_bf16 v[168:171], a[172:175], a[96:99], v[168:171]
    s_waitcnt lgkmcnt(9)
    ds_read_b64_tr_b16 a[156:157], v11 offset:16384
    ds_read_b64_tr_b16 a[158:159], v11 offset:16896
    v_mfma_f32_16x16x32_bf16 v[112:115], a[176:179], a[104:107], v[112:115]
    s_waitcnt vmcnt(17)
    s_barrier
    v_mfma_f32_16x16x32_bf16 v[116:119], a[176:179], a[108:111], v[116:119]
    ds_read_b64_tr_b16 a[160:161], v8 offset:8192
    ds_read_b64_tr_b16 a[162:163], v8 offset:8704
    v_mfma_f32_16x16x32_bf16 v[124:127], a[180:183], a[108:111], v[124:127]
    global_load_dwordx4 a[236:239], v203, s[48:49] offset:704
    v_mfma_f32_16x16x32_bf16 v[120:123], a[180:183], a[104:107], v[120:123]
    ds_read_b64_tr_b16 a[164:165], v8 offset:20480
    ds_read_b64_tr_b16 a[166:167], v8 offset:20992
    v_mfma_f32_16x16x32_bf16 v[128:131], a[184:187], a[104:107], v[128:131]
    global_load_dwordx4 a[240:243], v203, s[48:49] offset:768
    v_mfma_f32_16x16x32_bf16 v[132:135], a[184:187], a[108:111], v[132:135]
    ds_read_b64_tr_b16 a[168:169], v9 offset:8192
    ds_read_b64_tr_b16 a[170:171], v9 offset:8704
    v_mfma_f32_16x16x32_bf16 v[140:143], a[188:191], a[108:111], v[140:143]
    ds_read_b128 a[128:131], v232 offset:8192
    ds_read_b64_tr_b16 a[172:173], v9 offset:20480
    v_mfma_f32_16x16x32_bf16 v[136:139], a[188:191], a[104:107], v[136:139]
    s_waitcnt lgkmcnt(8)
    ds_read_b64_tr_b16 a[174:175], v9 offset:20992
    ds_read_b64_tr_b16 a[176:177], v10 offset:8192
    v_mfma_f32_16x16x32_bf16 v[144:147], a[144:147], a[104:107], v[144:147]
    ds_read_b128 a[132:135], v232 offset:10240
    global_load_dwordx4 a[244:247], v203, s[48:49] offset:832
    v_mfma_f32_16x16x32_bf16 v[148:151], a[144:147], a[108:111], v[148:151]
    ds_read_b64_tr_b16 a[178:179], v10 offset:8704
    v_mfma_f32_16x16x32_bf16 v[156:159], a[148:151], a[108:111], v[156:159]
    ds_read_b64_tr_b16 a[180:181], v10 offset:20480
    ds_read_b64_tr_b16 a[182:183], v10 offset:20992
    v_mfma_f32_16x16x32_bf16 v[152:155], a[148:151], a[104:107], v[152:155]
    ds_read_b128 a[136:139], v233 offset:8192
    v_mfma_f32_16x16x32_bf16 v[160:163], a[152:155], a[104:107], v[160:163]
    global_load_dwordx4 a[248:251], v203, s[48:49] offset:896
    v_mfma_f32_16x16x32_bf16 v[164:167], a[152:155], a[108:111], v[164:167]
    ds_read_b64_tr_b16 a[184:185], v11 offset:8192
    ds_read_b64_tr_b16 a[186:187], v11 offset:8704
    v_mfma_f32_16x16x32_bf16 v[172:175], a[156:159], a[108:111], v[172:175]
    ds_read_b64_tr_b16 a[188:189], v11 offset:20480
    ds_read_b128 a[140:143], v233 offset:10240
    v_mfma_f32_16x16x32_bf16 v[168:171], a[156:159], a[104:107], v[168:171]
    s_waitcnt lgkmcnt(10)
    ds_read_b64_tr_b16 a[190:191], v11 offset:20992
    ds_read_b64_tr_b16 a[144:145], v8 offset:24576
    v_mfma_f32_16x16x32_bf16 v[112:115], a[160:163], a[112:115], v[112:115]
    global_load_dwordx4 a[252:255], v203, s[48:49] offset:960
    v_mfma_f32_16x16x32_bf16 v[116:119], a[160:163], a[116:119], v[116:119]
    s_add_u32 s60, s58, 0xd8080
    ds_read_b64_tr_b16 a[146:147], v8 offset:25088
    v_mfma_f32_16x16x32_bf16 v[124:127], a[164:167], a[116:119], v[124:127]
    ds_read_b64_tr_b16 a[148:149], v8 offset:36864
    v_mfma_f32_16x16x32_bf16 v[120:123], a[164:167], a[112:115], v[120:123]
    ds_read_b64_tr_b16 a[150:151], v8 offset:37376
    v_mfma_f32_16x16x32_bf16 v[128:131], a[168:171], a[112:115], v[128:131]
    global_load_dwordx4 v[248:251], v203, s[48:49] offset:1024
    v_mfma_f32_16x16x32_bf16 v[132:135], a[168:171], a[116:119], v[132:135]
    s_add_u32 m0, s61, 0x12000
    ds_read_b64_tr_b16 a[152:153], v8 offset:28672
    v_mfma_f32_16x16x32_bf16 v[140:143], a[172:175], a[116:119], v[140:143]
    ds_read_b64_tr_b16 a[154:155], v8 offset:29184
    ds_read_b64_tr_b16 a[156:157], v8 offset:40960
    v_mfma_f32_16x16x32_bf16 v[136:139], a[172:175], a[112:115], v[136:139]
    ds_read_b64_tr_b16 a[158:159], v8 offset:41472
    s_waitcnt lgkmcnt(8)
    v_mfma_f32_16x16x32_bf16 v[144:147], a[176:179], a[112:115], v[144:147]
    global_load_dwordx4 v[252:255], v203, s[48:49] offset:1088
    v_mfma_f32_16x16x32_bf16 v[148:151], a[176:179], a[116:119], v[148:151]
    ds_read_b64_tr_b16 a[160:161], v8 offset:32768
    ds_read_b64_tr_b16 a[162:163], v8 offset:33280
    v_mfma_f32_16x16x32_bf16 v[156:159], a[180:183], a[116:119], v[156:159]
    buffer_load_dwordx4 v2, s[8:11], s60 offen offset:0 lds
    v_mfma_f32_16x16x32_bf16 v[152:155], a[180:183], a[112:115], v[152:155]
    buffer_load_dwordx4 v3, s[8:11], s60 offen offset:1024 lds
    ds_read_b64_tr_b16 a[164:165], v8 offset:45056
    v_mfma_f32_16x16x32_bf16 v[160:163], a[184:187], a[112:115], v[160:163]
    ds_read_b64_tr_b16 a[166:167], v8 offset:45568
    ds_read_b64_tr_b16 a[168:169], v9 offset:24576
    v_mfma_f32_16x16x32_bf16 v[164:167], a[184:187], a[116:119], v[164:167]
    ds_read_b64_tr_b16 a[170:171], v9 offset:25088
    ds_read_b64_tr_b16 a[172:173], v9 offset:36864
    v_mfma_f32_16x16x32_bf16 v[172:175], a[188:191], a[116:119], v[172:175]
    buffer_load_dwordx4 v4, s[8:11], s60 offen offset:2048 lds
    v_mfma_f32_16x16x32_bf16 v[168:171], a[188:191], a[112:115], v[168:171]
    s_waitcnt lgkmcnt(7)
    s_add_u32 m0, s61, 0x15000
    ds_read_b64_tr_b16 a[174:175], v9 offset:37376
    v_mfma_f32_16x16x32_bf16 v[112:115], a[144:147], a[120:123], v[112:115]
    ds_read_b64_tr_b16 a[176:177], v9 offset:28672
    ds_read_b64_tr_b16 a[178:179], v9 offset:29184
    v_mfma_f32_16x16x32_bf16 v[116:119], a[144:147], a[124:127], v[116:119]
    ds_read_b64_tr_b16 a[180:181], v9 offset:40960
    v_mfma_f32_16x16x32_bf16 v[124:127], a[148:151], a[124:127], v[124:127]
    ds_read_b64_tr_b16 a[182:183], v9 offset:41472
    ds_read_b64_tr_b16 a[184:185], v9 offset:32768
    v_mfma_f32_16x16x32_bf16 v[120:123], a[148:151], a[120:123], v[120:123]
    ds_read_b64_tr_b16 a[186:187], v9 offset:33280
    v_mfma_f32_16x16x32_bf16 v[112:115], a[152:155], a[128:131], v[112:115]
    buffer_load_dwordx4 v2, s[12:15], s60 offen offset:0 lds
    v_mfma_f32_16x16x32_bf16 v[116:119], a[152:155], a[132:135], v[116:119]
    ds_read_b64_tr_b16 a[188:189], v9 offset:45056
    v_mfma_f32_16x16x32_bf16 v[124:127], a[156:159], a[132:135], v[124:127]
    ds_read_b64_tr_b16 a[190:191], v9 offset:45568
    v_mfma_f32_16x16x32_bf16 v[120:123], a[156:159], a[128:131], v[120:123]
    s_waitcnt lgkmcnt(8)
    buffer_load_dwordx4 v3, s[12:15], s60 offen offset:1024 lds
    v_mfma_f32_16x16x32_bf16 v[112:115], a[160:163], a[136:139], v[112:115]
    ds_read_b64_tr_b16 a[144:145], v10 offset:24576
    ds_read_b64_tr_b16 a[146:147], v10 offset:25088
    v_mfma_f32_16x16x32_bf16 v[116:119], a[160:163], a[140:143], v[116:119]
    ds_read_b64_tr_b16 a[148:149], v10 offset:36864
    v_mfma_f32_16x16x32_bf16 v[124:127], a[164:167], a[140:143], v[124:127]
    buffer_load_dwordx4 v4, s[12:15], s60 offen offset:2048 lds
    v_mfma_f32_16x16x32_bf16 v[120:123], a[164:167], a[136:139], v[120:123]
    ds_read_b64_tr_b16 a[150:151], v10 offset:37376
    v_mul_f32 v50, s68, v114
    v_mfma_f32_16x16x32_bf16 v[128:131], a[168:171], a[120:123], v[128:131]
    ds_read_b64_tr_b16 a[152:153], v10 offset:28672
    v_mfma_f32_16x16x32_bf16 v[132:135], a[168:171], a[124:127], v[132:135]
    ds_read_b64_tr_b16 a[154:155], v10 offset:29184
    ds_read_b64_tr_b16 a[156:157], v10 offset:40960
    v_mfma_f32_16x16x32_bf16 v[140:143], a[172:175], a[124:127], v[140:143]
    v_mul_f32 v48, s68, v112
    v_mul_f32 v49, s68, v113
    v_mfma_f32_16x16x32_bf16 v[136:139], a[172:175], a[120:123], v[136:139]
    s_waitcnt lgkmcnt(7)
    ds_read_b64_tr_b16 a[158:159], v10 offset:41472
    ds_read_b64_tr_b16 a[160:161], v10 offset:32768
    v_mfma_f32_16x16x32_bf16 v[128:131], a[176:179], a[128:131], v[128:131]
    s_waitcnt vmcnt(16)
    s_barrier
    v_mfma_f32_16x16x32_bf16 v[132:135], a[176:179], a[132:135], v[132:135]
    ds_read_b64_tr_b16 a[162:163], v10 offset:33280
    v_mul_f32 v54, s68, v118
    v_mfma_f32_16x16x32_bf16 v[140:143], a[180:183], a[132:135], v[140:143]
    ds_read_b64_tr_b16 a[164:165], v10 offset:45056
    v_mul_f32 v55, s68, v119
    v_mul_f32 v52, s68, v116
    v_mfma_f32_16x16x32_bf16 v[136:139], a[180:183], a[128:131], v[136:139]
    ds_read_b64_tr_b16 a[166:167], v10 offset:45568
    v_mul_f32 v51, s68, v115
    v_mfma_f32_16x16x32_bf16 v[128:131], a[184:187], a[136:139], v[128:131]
    s_add_u32 s60, s58, 0x1b0080
    ds_read_b64_tr_b16 a[168:169], v11 offset:24576
    v_mul_f32 v53, s68, v117
    v_mfma_f32_16x16x32_bf16 v[132:135], a[184:187], a[140:143], v[132:135]
    ds_read_b64_tr_b16 a[170:171], v11 offset:25088
    v_mul_f32 v58, v114, v122
    v_mfma_f32_16x16x32_bf16 v[140:143], a[188:191], a[140:143], v[140:143]
    s_add_u32 m0, s61, 0x0
    ds_read_b64_tr_b16 a[172:173], v11 offset:36864
    v_mul_f32 v56, v112, v120
    v_mfma_f32_16x16x32_bf16 v[136:139], a[188:191], a[136:139], v[136:139]
    s_waitcnt lgkmcnt(7)
    ds_read_b64_tr_b16 a[174:175], v11 offset:37376
    v_mul_f32 v60, v116, v124
    v_mfma_f32_16x16x32_bf16 v[144:147], a[144:147], a[120:123], v[144:147]
    ds_read_b64_tr_b16 a[176:177], v11 offset:28672
    buffer_load_dwordx4 v2, s[8:11], s60 offen offset:0 lds
    ds_read_b64_tr_b16 a[178:179], v11 offset:29184
    v_mfma_f32_16x16x32_bf16 v[148:151], a[144:147], a[124:127], v[148:151]
    v_mul_f32 v64, s68, v128
    v_mul_f32 v63, v119, v127
    v_mul_f32 v61, v117, v125
    v_mul_f32 v59, v115, v123
    v_mul_f32 v57, v113, v121
    v_mfma_f32_16x16x32_bf16 v[156:159], a[148:151], a[124:127], v[156:159]
    ds_read_b64_tr_b16 a[180:181], v11 offset:40960
    v_mul_f32 v65, s68, v129
    v_mfma_f32_16x16x32_bf16 v[152:155], a[148:151], a[120:123], v[152:155]
    ds_read_b64_tr_b16 a[182:183], v11 offset:41472
    buffer_load_dwordx4 v3, s[8:11], s60 offen offset:1024 lds
    ds_read_b64_tr_b16 a[184:185], v11 offset:32768
    v_mfma_f32_16x16x32_bf16 v[144:147], a[152:155], a[128:131], v[144:147]
    v_mul_f32 v66, s68, v130
    v_mul_f32 v62, v118, v126
    v_mfma_f32_16x16x32_bf16 v[148:151], a[152:155], a[132:135], v[148:151]
    ds_read_b64_tr_b16 a[186:187], v11 offset:33280
    v_mul_f32 v68, s68, v132
    v_mfma_f32_16x16x32_bf16 v[156:159], a[156:159], a[132:135], v[156:159]
    buffer_load_dwordx4 v4, s[8:11], s60 offen offset:2048 lds
    ds_read_b64_tr_b16 a[188:189], v11 offset:45056
    v_mfma_f32_16x16x32_bf16 v[152:155], a[156:159], a[128:131], v[152:155]
    s_waitcnt lgkmcnt(7)
    ds_read_b64_tr_b16 a[190:191], v11 offset:45568
    v_mul_f32 v67, s68, v131
    v_mul_f32 v70, s68, v134
    v_mfma_f32_16x16x32_bf16 v[144:147], a[160:163], a[136:139], v[144:147]
    ds_read_b64_tr_b16 a[144:145], v12 offset:0
    v_mul_f32 v72, v128, v136
    v_mfma_f32_16x16x32_bf16 v[148:151], a[160:163], a[140:143], v[148:151]
    s_add_u32 m0, s61, 0x3000
    ds_read_b64_tr_b16 a[146:147], v12 offset:512
    v_mul_f32 v71, s68, v135
    v_mul_f32 v75, v131, v139
    v_mul_f32 v74, v130, v138
    v_mul_f32 v73, v129, v137
    v_mfma_f32_16x16x32_bf16 v[156:159], a[164:167], a[140:143], v[156:159]
    ds_read_b64_tr_b16 a[148:149], v12 offset:12288
    v_mul_f32 v69, s68, v133
    v_mfma_f32_16x16x32_bf16 v[152:155], a[164:167], a[136:139], v[152:155]
    ds_read_b64_tr_b16 a[150:151], v12 offset:12800
    v_mul_f32 v76, v132, v140
    v_mfma_f32_16x16x32_bf16 v[160:163], a[168:171], a[120:123], v[160:163]
    ds_read_b64_tr_b16 a[152:153], v12 offset:4096
    buffer_load_dwordx4 v2, s[12:15], s60 offen offset:0 lds
    v_mfma_f32_16x16x32_bf16 v[164:167], a[168:171], a[124:127], v[164:167]
    ds_read_b64_tr_b16 a[154:155], v12 offset:4608
    v_mul_f32 v78, v134, v142
    v_mul_f32 v77, v133, v141
    v_mfma_f32_16x16x32_bf16 v[172:175], a[172:175], a[124:127], v[172:175]
    ds_read_b64_tr_b16 a[156:157], v12 offset:16384
    v_mul_f32 v79, v135, v143
    v_mfma_f32_16x16x32_bf16 v[168:171], a[172:175], a[120:123], v[168:171]
    s_waitcnt lgkmcnt(7)
    ds_read_b64_tr_b16 a[158:159], v12 offset:16896
    v_mul_f32 v84, s68, v148
    v_mfma_f32_16x16x32_bf16 v[160:163], a[176:179], a[128:131], v[160:163]
    buffer_load_dwordx4 v3, s[12:15], s60 offen offset:1024 lds
    ds_read_b64_tr_b16 a[160:161], v12 offset:8192
    v_mfma_f32_16x16x32_bf16 v[164:167], a[176:179], a[132:135], v[164:167]
    ds_read_b64_tr_b16 a[162:163], v12 offset:8704
    v_mul_f32 v85, s68, v149
    v_mfma_f32_16x16x32_bf16 v[172:175], a[180:183], a[132:135], v[172:175]
    ds_read_b64_tr_b16 a[164:165], v12 offset:20480
    v_mul_f32 v86, s68, v150
    v_mfma_f32_16x16x32_bf16 v[168:171], a[180:183], a[128:131], v[168:171]
    ds_read_b64_tr_b16 a[166:167], v12 offset:20992
    buffer_load_dwordx4 v4, s[12:15], s60 offen offset:2048 lds
    v_mul_f32 v89, v145, v153
    v_mul_f32 v82, s68, v146
    v_mfma_f32_16x16x32_bf16 v[160:163], a[184:187], a[136:139], v[160:163]
    ds_read_b64_tr_b16 a[168:169], v13 offset:0
    v_mul_f32 v83, s68, v147
    v_mul_f32 v87, s68, v151
    v_mul_f32 v80, s68, v144
    v_mul_f32 v88, v144, v152
    v_mul_f32 v81, s68, v145
    v_mfma_f32_16x16x32_bf16 v[164:167], a[184:187], a[140:143], v[164:167]
    ds_read_b64_tr_b16 a[170:171], v13 offset:512
    v_mul_f32 v90, v146, v154
    v_mfma_f32_16x16x32_bf16 v[172:175], a[188:191], a[140:143], v[172:175]
    ds_read_b64_tr_b16 a[172:173], v13 offset:12288
    v_mul_f32 v91, v147, v155
    v_mfma_f32_16x16x32_bf16 v[168:171], a[188:191], a[136:139], v[168:171]
    s_waitcnt lgkmcnt(7)
    s_waitcnt vmcnt(12)
    ds_read_b64_tr_b16 a[174:175], v13 offset:12800
    v_mfma_f32_16x16x32_bf16 v[112:115], a[144:147], a[0:3], 0
    s_mov_b32 m0, s63
    ds_read_b64_tr_b16 a[176:177], v13 offset:4096
    v_mul_f32 v95, v151, v159
    v_mfma_f32_16x16x32_bf16 v[116:119], a[144:147], a[4:7], 0
    ds_read_b64_tr_b16 a[178:179], v13 offset:4608
    buffer_load_dwordx4 v228, s[4:7], s3 offen offset:0 lds
    v_mfma_f32_16x16x32_bf16 v[124:127], a[148:151], a[4:7], 0
    ds_read_b64_tr_b16 a[180:181], v13 offset:16384
    v_mul_f32 v93, v149, v157
    v_mfma_f32_16x16x32_bf16 v[120:123], a[148:151], a[0:3], 0
    ds_read_b64_tr_b16 a[182:183], v13 offset:16896
    v_mul_f32 v97, s68, v161
    v_mfma_f32_16x16x32_bf16 v[112:115], a[152:155], a[8:11], v[112:115]
    ds_read_b64_tr_b16 a[184:185], v13 offset:8192
    v_mul_f32 v92, v148, v156
    v_mul_f32 v94, v150, v158
    v_mfma_f32_16x16x32_bf16 v[192:195], a[192:195], a[0:3], 0
    buffer_load_dwordx4 v229, s[4:7], s3 offen offset:1024 lds
    ds_read_b64_tr_b16 a[186:187], v13 offset:8704
    v_mfma_f32_16x16x32_bf16 v[116:119], a[152:155], a[12:15], v[116:119]
    v_mul_f32 v100, s68, v164
    v_mul_f32 v99, s68, v163
    v_mfma_f32_16x16x32_bf16 v[124:127], a[156:159], a[12:15], v[124:127]
    ds_read_b64_tr_b16 a[188:189], v13 offset:20480
    v_mul_f32 v96, s68, v160
    v_mul_f32 v101, s68, v165
    v_mfma_f32_16x16x32_bf16 v[120:123], a[156:159], a[8:11], v[120:123]
    s_waitcnt lgkmcnt(7)
    ds_read_b64_tr_b16 a[190:191], v13 offset:20992
    buffer_load_dwordx4 v230, s[4:7], s3 offen offset:2048 lds
    v_mfma_f32_16x16x32_bf16 v[112:115], a[160:163], a[16:19], v[112:115]
    ds_read_b64_tr_b16 a[144:145], v14 offset:0
    v_mul_f32 v98, s68, v162
    v_mfma_f32_16x16x32_bf16 v[196:199], a[192:195], a[4:7], 0
    v_mul_f32 v103, s68, v167
    v_mul_f32 v104, v160, v168
    v_mfma_f32_16x16x32_bf16 v[116:119], a[160:163], a[20:23], v[116:119]
    ds_read_b64_tr_b16 a[146:147], v14 offset:512
    v_mul_f32 v105, v161, v169
    v_mfma_f32_16x16x32_bf16 v[124:127], a[164:167], a[20:23], v[124:127]
    ds_read_b64_tr_b16 a[148:149], v14 offset:12288
    buffer_load_dwordx4 v231, s[4:7], s3 offen offset:3072 lds
    v_mfma_f32_16x16x32_bf16 v[120:123], a[164:167], a[16:19], v[120:123]
    ds_read_b64_tr_b16 a[150:151], v14 offset:12800
    v_mul_f32 v107, v163, v171
    v_mfma_f32_16x16x32_bf16 v[128:131], a[168:171], a[0:3], 0
    ds_read_b64_tr_b16 a[152:153], v14 offset:4096
    v_mul_f32 v102, s68, v166
    v_mfma_f32_16x16x32_bf16 v[192:195], a[196:199], a[8:11], v[192:195]
    v_mul_f32 v109, v165, v173
    v_mul_f32 v110, v166, v174
    v_mfma_f32_16x16x32_bf16 v[132:135], a[168:171], a[4:7], 0
    ds_read_b64_tr_b16 a[154:155], v14 offset:4608
    v_mul_f32 v111, v167, v175
    v_mfma_f32_16x16x32_bf16 v[140:143], a[172:175], a[4:7], 0
    ds_read_b64_tr_b16 a[156:157], v14 offset:16384
    v_mul_f32 v108, v164, v172
    v_mfma_f32_16x16x32_bf16 v[136:139], a[172:175], a[0:3], 0
    s_waitcnt lgkmcnt(7)
    ds_read_b64_tr_b16 a[158:159], v14 offset:16896
    ds_read_b64_tr_b16 a[160:161], v14 offset:8192
    v_mfma_f32_16x16x32_bf16 v[128:131], a[176:179], a[8:11], v[128:131]
    s_waitcnt vmcnt(10)
    s_barrier
    v_mfma_f32_16x16x32_bf16 v[196:199], a[196:199], a[12:15], v[196:199]
    s_add_u32 s60, s58, 0x288080
    ds_read_b64_tr_b16 a[162:163], v14 offset:8704
    v_exp_f32 v49, v49
    v_mfma_f32_16x16x32_bf16 v[132:135], a[176:179], a[12:15], v[132:135]
    s_add_u32 m0, s61, 0x6000
    v_mul_f32 v106, v162, v170
    v_exp_f32 v48, v48
    v_mfma_f32_16x16x32_bf16 v[140:143], a[180:183], a[12:15], v[140:143]
    ds_read_b64_tr_b16 a[164:165], v14 offset:20480
    ds_read_b64_tr_b16 a[166:167], v14 offset:20992
    v_mfma_f32_16x16x32_bf16 v[136:139], a[180:183], a[8:11], v[136:139]
    v_exp_f32 v50, v50
    v_mfma_f32_16x16x32_bf16 v[128:131], a[184:187], a[16:19], v[128:131]
    ds_read_b64_tr_b16 a[168:169], v15 offset:0
    v_mfma_f32_16x16x32_bf16 v[192:195], a[200:203], a[16:19], v[192:195]
    v_exp_f32 v51, v51
    v_mfma_f32_16x16x32_bf16 v[132:135], a[184:187], a[20:23], v[132:135]
    ds_read_b64_tr_b16 a[170:171], v15 offset:512
    v_add_f32 v49, 1.0, v49
    v_mfma_f32_16x16x32_bf16 v[140:143], a[188:191], a[20:23], v[140:143]
    ds_read_b64_tr_b16 a[172:173], v15 offset:12288
    v_mfma_f32_16x16x32_bf16 v[136:139], a[188:191], a[16:19], v[136:139]
    s_waitcnt lgkmcnt(7)
    ds_read_b64_tr_b16 a[174:175], v15 offset:12800
    v_mfma_f32_16x16x32_bf16 v[144:147], a[144:147], a[0:3], 0
    ds_read_b64_tr_b16 a[176:177], v15 offset:4096
    v_add_f32 v48, 1.0, v48
    v_mfma_f32_16x16x32_bf16 v[196:199], a[200:203], a[20:23], v[196:199]
    v_rcp_f32 v48, v48
    v_mfma_f32_16x16x32_bf16 v[148:151], a[144:147], a[4:7], 0
    ds_read_b64_tr_b16 a[178:179], v15 offset:4608
    v_rcp_f32 v49, v49
    v_mfma_f32_16x16x32_bf16 v[156:159], a[148:151], a[4:7], 0
    ds_read_b64_tr_b16 a[180:181], v15 offset:16384
    v_add_f32 v50, 1.0, v50
    v_mfma_f32_16x16x32_bf16 v[152:155], a[148:151], a[0:3], 0
    buffer_load_dwordx4 v2, s[8:11], s60 offen offset:0 lds
    ds_read_b64_tr_b16 a[182:183], v15 offset:16896
    v_mfma_f32_16x16x32_bf16 v[144:147], a[152:155], a[8:11], v[144:147]
    ds_read_b64_tr_b16 a[184:185], v15 offset:8192
    v_add_f32 v51, 1.0, v51
    v_mfma_f32_16x16x32_bf16 v[192:195], a[204:207], a[24:27], v[192:195]
    v_rcp_f32 v51, v51
    v_mfma_f32_16x16x32_bf16 v[148:151], a[152:155], a[12:15], v[148:151]
    ds_read_b64_tr_b16 a[186:187], v15 offset:8704
    v_rcp_f32 v50, v50
    v_mfma_f32_16x16x32_bf16 v[156:159], a[156:159], a[12:15], v[156:159]
    ds_read_b64_tr_b16 a[188:189], v15 offset:20480
    v_mul_f32 v56, v56, v48
    v_mfma_f32_16x16x32_bf16 v[152:155], a[156:159], a[8:11], v[152:155]
    v_mul_f32 v57, v57, v49
    s_waitcnt lgkmcnt(7)
    v_mfma_f32_16x16x32_bf16 v[144:147], a[160:163], a[16:19], v[144:147]
    ds_read_b64_tr_b16 a[190:191], v15 offset:20992
    ds_read_b64_tr_b16 a[144:145], v12 offset:24576
    v_mfma_f32_16x16x32_bf16 v[196:199], a[204:207], a[28:31], v[196:199]
    buffer_load_dwordx4 v3, s[8:11], s60 offen offset:1024 lds
    v_mfma_f32_16x16x32_bf16 v[148:151], a[160:163], a[20:23], v[148:151]
    ds_read_b64_tr_b16 a[146:147], v12 offset:25088
    v_mul_f32 v59, v59, v51
    v_mfma_f32_16x16x32_bf16 v[156:159], a[164:167], a[20:23], v[156:159]
    ds_read_b64_tr_b16 a[148:149], v12 offset:36864
    v_cvt_pk_bf16_f32 v176, v56, v57
    v_mfma_f32_16x16x32_bf16 v[152:155], a[164:167], a[16:19], v[152:155]
    ds_read_b64_tr_b16 a[150:151], v12 offset:37376
    v_mul_f32 v58, v58, v50
    v_mfma_f32_16x16x32_bf16 v[160:163], a[168:171], a[0:3], 0
    ds_read_b64_tr_b16 a[152:153], v13 offset:24576
    v_cvt_pk_bf16_f32 v177, v58, v59
    v_mfma_f32_16x16x32_bf16 v[192:195], a[208:211], a[32:35], v[192:195]
    v_exp_f32 v52, v52
    v_mfma_f32_16x16x32_bf16 v[164:167], a[168:171], a[4:7], 0
    buffer_load_dwordx4 v4, s[8:11], s60 offen offset:2048 lds
    ds_read_b64_tr_b16 a[154:155], v13 offset:25088
    v_mfma_f32_16x16x32_bf16 v[172:175], a[172:175], a[4:7], 0
    ds_read_b64_tr_b16 a[156:157], v13 offset:36864
    v_exp_f32 v53, v53
    v_mfma_f32_16x16x32_bf16 v[168:171], a[172:175], a[0:3], 0
    s_waitcnt lgkmcnt(7)
    ds_read_b64_tr_b16 a[158:159], v13 offset:37376
    ds_read_b64_tr_b16 a[160:161], v14 offset:24576
    v_mfma_f32_16x16x32_bf16 v[160:163], a[176:179], a[8:11], v[160:163]
    v_exp_f32 v54, v54
    v_mfma_f32_16x16x32_bf16 v[196:199], a[208:211], a[36:39], v[196:199]
    v_exp_f32 v55, v55
    v_mfma_f32_16x16x32_bf16 v[164:167], a[176:179], a[12:15], v[164:167]
    ds_read_b64_tr_b16 a[162:163], v14 offset:25088
    v_add_f32 v52, 1.0, v52
    v_mfma_f32_16x16x32_bf16 v[172:175], a[180:183], a[12:15], v[172:175]
    s_add_u32 m0, s61, 0x9000
    ds_read_b64_tr_b16 a[164:165], v14 offset:36864
    v_mfma_f32_16x16x32_bf16 v[168:171], a[180:183], a[8:11], v[168:171]
    ds_read_b64_tr_b16 a[166:167], v14 offset:37376
    v_add_f32 v53, 1.0, v53
    v_mfma_f32_16x16x32_bf16 v[160:163], a[184:187], a[16:19], v[160:163]
    ds_read_b64_tr_b16 a[168:169], v15 offset:24576
    v_add_f32 v54, 1.0, v54
    v_mfma_f32_16x16x32_bf16 v[192:195], a[212:215], a[40:43], v[192:195]
    v_rcp_f32 v52, v52
    v_mfma_f32_16x16x32_bf16 v[164:167], a[184:187], a[20:23], v[164:167]
    ds_read_b64_tr_b16 a[170:171], v15 offset:25088
    v_add_f32 v55, 1.0, v55
    v_mfma_f32_16x16x32_bf16 v[172:175], a[188:191], a[20:23], v[172:175]
    ds_read_b64_tr_b16 a[172:173], v15 offset:36864
    v_rcp_f32 v53, v53
    v_mfma_f32_16x16x32_bf16 v[168:171], a[188:191], a[16:19], v[168:171]
    s_waitcnt lgkmcnt(7)
    buffer_load_dwordx4 v2, s[12:15], s60 offen offset:0 lds
    v_mfma_f32_16x16x32_bf16 v[112:115], a[144:147], a[24:27], v[112:115]
    ds_read_b64_tr_b16 a[174:175], v15 offset:37376
    ds_read_b64_tr_b16 a[176:177], v12 offset:28672
    v_mfma_f32_16x16x32_bf16 v[196:199], a[212:215], a[44:47], v[196:199]
    v_rcp_f32 v54, v54
    v_mfma_f32_16x16x32_bf16 v[116:119], a[144:147], a[28:31], v[116:119]
    v_rcp_f32 v55, v55
    v_mfma_f32_16x16x32_bf16 v[124:127], a[148:151], a[28:31], v[124:127]
    ds_read_b64_tr_b16 a[178:179], v12 offset:29184
    ds_read_b64_tr_b16 a[180:181], v12 offset:40960
    v_mfma_f32_16x16x32_bf16 v[120:123], a[148:151], a[24:27], v[120:123]
    ds_read_b64_tr_b16 a[182:183], v12 offset:41472
    v_mul_f32 v60, v60, v52
    v_mfma_f32_16x16x32_bf16 v[128:131], a[152:155], a[24:27], v[128:131]
    s_waitcnt vmcnt(4)
    ds_read_b64_tr_b16 a[184:185], v13 offset:28672
    ds_read_b64_tr_b16 v[204:205], v220
    v_mfma_f32_16x16x32_bf16 v[192:195], a[216:219], a[48:51], v[192:195]
    buffer_load_dwordx4 v3, s[12:15], s60 offen offset:1024 lds
    v_mfma_f32_16x16x32_bf16 v[132:135], a[152:155], a[28:31], v[132:135]
    ds_read_b64_tr_b16 a[186:187], v13 offset:29184
    v_mul_f32 v61, v61, v53
    v_mfma_f32_16x16x32_bf16 v[140:143], a[156:159], a[28:31], v[140:143]
    ds_read_b64_tr_b16 a[188:189], v13 offset:40960
    ds_read_b64_tr_b16 v[206:207], v221
    v_mfma_f32_16x16x32_bf16 v[136:139], a[156:159], a[24:27], v[136:139]
    s_waitcnt lgkmcnt(9)
    ds_read_b64_tr_b16 a[190:191], v13 offset:41472
    ds_read_b64_tr_b16 v[208:209], v222
    v_mfma_f32_16x16x32_bf16 v[144:147], a[160:163], a[24:27], v[144:147]
    ds_read_b64_tr_b16 a[144:145], v14 offset:28672
    ds_read_b64_tr_b16 v[210:211], v223
    v_mfma_f32_16x16x32_bf16 v[196:199], a[216:219], a[52:55], v[196:199]
    v_mul_f32 v62, v62, v54
    v_mul_f32 v63, v63, v55
    v_mfma_f32_16x16x32_bf16 v[148:151], a[160:163], a[28:31], v[148:151]
    ds_read_b64_tr_b16 a[146:147], v14 offset:29184
    buffer_load_dwordx4 v4, s[12:15], s60 offen offset:2048 lds
    v_mfma_f32_16x16x32_bf16 v[156:159], a[164:167], a[28:31], v[156:159]
    ds_read_b64_tr_b16 a[148:149], v14 offset:40960
    ds_read_b64_tr_b16 v[212:213], v224
    v_mfma_f32_16x16x32_bf16 v[152:155], a[164:167], a[24:27], v[152:155]
    ds_read_b64_tr_b16 a[150:151], v14 offset:41472
    ds_read_b64_tr_b16 v[214:215], v225
    v_mfma_f32_16x16x32_bf16 v[160:163], a[168:171], a[24:27], v[160:163]
    ds_read_b64_tr_b16 a[152:153], v15 offset:28672
    ds_read_b64_tr_b16 v[216:217], v226
    v_mfma_f32_16x16x32_bf16 v[192:195], a[220:223], a[56:59], v[192:195]
    ds_read_b64_tr_b16 a[154:155], v15 offset:29184
    v_cvt_pk_bf16_f32 v180, v60, v61
    v_mfma_f32_16x16x32_bf16 v[164:167], a[168:171], a[28:31], v[164:167]
    v_exp_f32 v64, v64
    v_mfma_f32_16x16x32_bf16 v[172:175], a[172:175], a[28:31], v[172:175]
    ds_read_b64_tr_b16 a[156:157], v15 offset:40960
    ds_read_b64_tr_b16 v[218:219], v227
    v_mfma_f32_16x16x32_bf16 v[168:171], a[172:175], a[24:27], v[168:171]
    ds_read_b64_tr_b16 a[158:159], v15 offset:41472
    s_waitcnt lgkmcnt(14)
    v_mfma_f32_16x16x32_bf16 v[112:115], a[176:179], a[32:35], v[112:115]
    s_barrier
    v_cvt_pk_bf16_f32 v181, v62, v63
    v_mfma_f32_16x16x32_bf16 v[196:199], a[220:223], a[60:63], v[196:199]
    v_exp_f32 v65, v65
    v_mfma_f32_16x16x32_bf16 v[116:119], a[176:179], a[36:39], v[116:119]
    ds_read_b64_tr_b16 a[160:161], v12 offset:32768
    ds_read_b64_tr_b16 a[162:163], v12 offset:33280
    v_mfma_f32_16x16x32_bf16 v[124:127], a[180:183], a[36:39], v[124:127]
    ds_read_b64_tr_b16 a[164:165], v12 offset:45056
    v_mfma_f32_16x16x32_bf16 v[120:123], a[180:183], a[32:35], v[120:123]
    ds_read_b64_tr_b16 a[166:167], v12 offset:45568
    s_add_u32 s60, s58, 0x360080
    v_mfma_f32_16x16x32_bf16 v[128:131], a[184:187], a[32:35], v[128:131]
    s_waitcnt lgkmcnt(5)
    ds_read_b64_tr_b16 a[168:169], v13 offset:32768
    v_mfma_f32_16x16x32_bf16 v[192:195], a[224:227], a[64:67], v[192:195]
    v_exp_f32 v67, v67
    v_mfma_f32_16x16x32_bf16 v[132:135], a[184:187], a[36:39], v[132:135]
    buffer_store_dwordx4 v[204:207], v47, s[24:27], 0 offen offset:0 sc1
    v_exp_f32 v66, v66
    v_add_f32 v64, 1.0, v64
    v_mfma_f32_16x16x32_bf16 v[140:143], a[188:191], a[36:39], v[140:143]
    ds_read_b64_tr_b16 a[170:171], v13 offset:33280
    ds_read_b64_tr_b16 a[172:173], v13 offset:45056
    v_mfma_f32_16x16x32_bf16 v[136:139], a[188:191], a[32:35], v[136:139]
    v_add_f32 v65, 1.0, v65
    s_waitcnt lgkmcnt(7)
    v_mfma_f32_16x16x32_bf16 v[144:147], a[144:147], a[32:35], v[144:147]
    ds_read_b64_tr_b16 a[174:175], v13 offset:45568
    ds_read_b64_tr_b16 a[176:177], v14 offset:32768
    v_mfma_f32_16x16x32_bf16 v[196:199], a[224:227], a[68:71], v[196:199]
    s_add_u32 m0, s61, 0xc000
    v_rcp_f32 v64, v64
    v_mfma_f32_16x16x32_bf16 v[148:151], a[144:147], a[36:39], v[148:151]
    buffer_store_dwordx4 v[208:211], v47, s[24:27], 0 offen offset:1024 sc1
    ds_read_b64_tr_b16 a[178:179], v14 offset:33280
    v_add_f32 v66, 1.0, v66
    v_add_f32 v67, 1.0, v67
    v_mfma_f32_16x16x32_bf16 v[156:159], a[148:151], a[36:39], v[156:159]
    ds_read_b64_tr_b16 a[180:181], v14 offset:45056
    ds_read_b64_tr_b16 a[182:183], v14 offset:45568
    v_mfma_f32_16x16x32_bf16 v[152:155], a[148:151], a[32:35], v[152:155]
    buffer_load_dwordx4 v2, s[8:11], s60 offen offset:0 lds
    v_mfma_f32_16x16x32_bf16 v[160:163], a[152:155], a[32:35], v[160:163]
    ds_read_b64_tr_b16 a[184:185], v15 offset:32768
    v_mfma_f32_16x16x32_bf16 v[192:195], a[228:231], a[72:75], v[192:195]
    v_rcp_f32 v66, v66
    v_mfma_f32_16x16x32_bf16 v[164:167], a[152:155], a[36:39], v[164:167]
    buffer_store_dwordx4 v[212:215], v47, s[24:27], 0 offen offset:2048 sc1
    ds_read_b64_tr_b16 a[186:187], v15 offset:33280
    v_rcp_f32 v65, v65
    v_mfma_f32_16x16x32_bf16 v[172:175], a[156:159], a[36:39], v[172:175]
    ds_read_b64_tr_b16 a[188:189], v15 offset:45056
    v_mfma_f32_16x16x32_bf16 v[168:171], a[156:159], a[32:35], v[168:171]
    s_waitcnt lgkmcnt(7)
    ds_read_b64_tr_b16 a[190:191], v15 offset:45568
    v_mfma_f32_16x16x32_bf16 v[112:115], a[160:163], a[40:43], v[112:115]
    buffer_load_dwordx4 v3, s[8:11], s60 offen offset:1024 lds
    v_mfma_f32_16x16x32_bf16 v[196:199], a[228:231], a[76:79], v[196:199]
    v_rcp_f32 v67, v67
    v_mfma_f32_16x16x32_bf16 v[116:119], a[160:163], a[44:47], v[116:119]
    buffer_store_dwordx4 v[216:219], v47, s[24:27], 0 offen offset:3072 sc1
    ds_read_b64_tr_b16 a[144:145], v8 offset:0
    ds_read_b64_tr_b16 a[146:147], v8 offset:512
    v_mfma_f32_16x16x32_bf16 v[124:127], a[164:167], a[44:47], v[124:127]
    ds_read_b64_tr_b16 a[148:149], v8 offset:12288
    v_mul_f32 v72, v72, v64
    v_mfma_f32_16x16x32_bf16 v[120:123], a[164:167], a[40:43], v[120:123]
    ds_read_b64_tr_b16 a[150:151], v8 offset:12800
    v_mul_f32 v73, v73, v65
    v_mfma_f32_16x16x32_bf16 v[128:131], a[168:171], a[40:43], v[128:131]
    ds_read_b64_tr_b16 a[152:153], v9 offset:0
    v_mul_f32 v74, v74, v66
    v_mfma_f32_16x16x32_bf16 v[192:195], a[232:235], a[80:83], v[192:195]
    v_mul_f32 v75, v75, v67
    v_cvt_pk_bf16_f32 v178, v72, v73
    v_mfma_f32_16x16x32_bf16 v[132:135], a[168:171], a[44:47], v[132:135]
    buffer_load_dwordx4 v4, s[8:11], s60 offen offset:2048 lds
    v_mfma_f32_16x16x32_bf16 v[140:143], a[172:175], a[44:47], v[140:143]
    ds_read_b64_tr_b16 a[154:155], v9 offset:512
    ds_read_b64_tr_b16 a[156:157], v9 offset:12288
    v_mfma_f32_16x16x32_bf16 v[136:139], a[172:175], a[40:43], v[136:139]
    ds_read_b64_tr_b16 a[158:159], v9 offset:12800
    s_waitcnt lgkmcnt(8)
    v_mfma_f32_16x16x32_bf16 v[144:147], a[176:179], a[40:43], v[144:147]
    ds_read_b64_tr_b16 a[160:161], v10 offset:0
    v_cvt_pk_bf16_f32 v179, v74, v75
    v_mfma_f32_16x16x32_bf16 v[196:199], a[232:235], a[84:87], v[196:199]
    v_exp_f32 v68, v68
    v_mfma_f32_16x16x32_bf16 v[148:151], a[176:179], a[44:47], v[148:151]
    ds_read_b64_tr_b16 a[162:163], v10 offset:512
    v_mfma_f32_16x16x32_bf16 v[156:159], a[180:183], a[44:47], v[156:159]
    ds_read_b64_tr_b16 a[164:165], v10 offset:12288
    v_mfma_f32_16x16x32_bf16 v[152:155], a[180:183], a[40:43], v[152:155]
    buffer_store_dwordx4 v[176:179], v40, s[24:27], 0 offen offset:0 sc1
    ds_read_b64_tr_b16 a[166:167], v10 offset:12800
    v_exp_f32 v69, v69
    v_mfma_f32_16x16x32_bf16 v[160:163], a[184:187], a[40:43], v[160:163]
    s_add_u32 m0, s61, 0xf000
    ds_read_b64_tr_b16 a[168:169], v11 offset:0
    ds_read_b64_tr_b16 a[170:171], v11 offset:512
    v_mfma_f32_16x16x32_bf16 v[192:195], a[236:239], a[88:91], v[192:195]
    v_exp_f32 v70, v70
    v_mfma_f32_16x16x32_bf16 v[164:167], a[184:187], a[44:47], v[164:167]
    v_exp_f32 v71, v71
    v_mfma_f32_16x16x32_bf16 v[172:175], a[188:191], a[44:47], v[172:175]
    ds_read_b64_tr_b16 a[172:173], v11 offset:12288
    v_add_f32 v68, 1.0, v68
    v_mfma_f32_16x16x32_bf16 v[168:171], a[188:191], a[40:43], v[168:171]
    s_waitcnt lgkmcnt(7)
    buffer_load_dwordx4 v2, s[12:15], s60 offen offset:0 lds
    v_mfma_f32_16x16x32_bf16 v[112:115], a[144:147], a[48:51], v[112:115]
    ds_read_b64_tr_b16 a[174:175], v11 offset:12800
    ds_read_b64_tr_b16 a[176:177], v8 offset:4096
    v_mfma_f32_16x16x32_bf16 v[196:199], a[236:239], a[92:95], v[196:199]
    v_add_f32 v70, 1.0, v70
    v_add_f32 v71, 1.0, v71
    v_mfma_f32_16x16x32_bf16 v[116:119], a[144:147], a[52:55], v[116:119]
    ds_read_b64_tr_b16 a[178:179], v8 offset:4608
    v_add_f32 v69, 1.0, v69
    v_mfma_f32_16x16x32_bf16 v[124:127], a[148:151], a[52:55], v[124:127]
    v_rcp_f32 v68, v68
    v_mfma_f32_16x16x32_bf16 v[120:123], a[148:151], a[48:51], v[120:123]
    ds_read_b64_tr_b16 a[180:181], v8 offset:16384
    ds_read_b64_tr_b16 a[182:183], v8 offset:16896
    v_mfma_f32_16x16x32_bf16 v[128:131], a[152:155], a[48:51], v[128:131]
    ds_read_b64_tr_b16 a[184:185], v9 offset:4096
    buffer_load_dwordx4 v3, s[12:15], s60 offen offset:1024 lds
    v_mfma_f32_16x16x32_bf16 v[192:195], a[240:243], a[96:99], v[192:195]
    v_rcp_f32 v69, v69
    v_mfma_f32_16x16x32_bf16 v[132:135], a[152:155], a[52:55], v[132:135]
    ds_read_b64_tr_b16 a[186:187], v9 offset:4608
    ds_read_b64_tr_b16 a[188:189], v9 offset:16384
    v_mfma_f32_16x16x32_bf16 v[140:143], a[156:159], a[52:55], v[140:143]
    v_rcp_f32 v70, v70
    v_mfma_f32_16x16x32_bf16 v[136:139], a[156:159], a[48:51], v[136:139]
    s_waitcnt lgkmcnt(7)
    ds_read_b64_tr_b16 a[190:191], v9 offset:16896
    v_mul_f32 v78, v78, v70
    v_mfma_f32_16x16x32_bf16 v[144:147], a[160:163], a[48:51], v[144:147]
    ds_read_b64_tr_b16 a[144:145], v10 offset:4096
    ds_read_b64_tr_b16 a[146:147], v10 offset:4608
    v_mfma_f32_16x16x32_bf16 v[196:199], a[240:243], a[100:103], v[196:199]
    v_rcp_f32 v71, v71
    v_mfma_f32_16x16x32_bf16 v[148:151], a[160:163], a[52:55], v[148:151]
    buffer_load_dwordx4 v4, s[12:15], s60 offen offset:2048 lds
    v_mfma_f32_16x16x32_bf16 v[156:159], a[164:167], a[52:55], v[156:159]
    ds_read_b64_tr_b16 a[148:149], v10 offset:16384
    v_mul_f32 v77, v77, v69
    v_mfma_f32_16x16x32_bf16 v[152:155], a[164:167], a[48:51], v[152:155]
    ds_read_b64_tr_b16 a[150:151], v10 offset:16896
    v_mul_f32 v76, v76, v68
    v_mfma_f32_16x16x32_bf16 v[160:163], a[168:171], a[48:51], v[160:163]
    v_mul_f32 v79, v79, v71
    v_mfma_f32_16x16x32_bf16 v[192:195], a[244:247], a[104:107], v[192:195]
    ds_read_b64_tr_b16 a[152:153], v11 offset:4096
    v_cvt_pk_bf16_f32 v182, v76, v77
    v_mfma_f32_16x16x32_bf16 v[164:167], a[168:171], a[52:55], v[164:167]
    ds_read_b64_tr_b16 a[154:155], v11 offset:4608
    v_cvt_pk_bf16_f32 v183, v78, v79
    v_mfma_f32_16x16x32_bf16 v[172:175], a[172:175], a[52:55], v[172:175]
    ds_read_b64_tr_b16 a[156:157], v11 offset:16384
    v_mfma_f32_16x16x32_bf16 v[168:171], a[172:175], a[48:51], v[168:171]
    s_waitcnt lgkmcnt(7)
    ds_read_b64_tr_b16 a[158:159], v11 offset:16896
    v_mfma_f32_16x16x32_bf16 v[112:115], a[176:179], a[56:59], v[112:115]
    buffer_store_dwordx4 v[180:183], v40, s[24:27], 0 offen offset:1024 sc1
    s_waitcnt vmcnt(12)
    s_barrier
    v_mfma_f32_16x16x32_bf16 v[196:199], a[244:247], a[108:111], v[196:199]
    v_exp_f32 v80, v80
    v_mfma_f32_16x16x32_bf16 v[116:119], a[176:179], a[60:63], v[116:119]
    ds_read_b64_tr_b16 a[160:161], v8 offset:8192
    ds_read_b64_tr_b16 a[162:163], v8 offset:8704
    v_mfma_f32_16x16x32_bf16 v[124:127], a[180:183], a[60:63], v[124:127]
    v_exp_f32 v81, v81
    v_mfma_f32_16x16x32_bf16 v[120:123], a[180:183], a[56:59], v[120:123]
    s_add_u32 s60, s58, 0x438080
    ds_read_b64_tr_b16 a[164:165], v8 offset:20480
    ds_read_b64_tr_b16 a[166:167], v8 offset:20992
    v_mfma_f32_16x16x32_bf16 v[128:131], a[184:187], a[56:59], v[128:131]
    s_add_u32 m0, s61, 0x12000
    v_exp_f32 v82, v82
    v_mfma_f32_16x16x32_bf16 v[192:195], a[248:251], a[112:115], v[192:195]
    v_exp_f32 v83, v83
    v_mfma_f32_16x16x32_bf16 v[132:135], a[184:187], a[60:63], v[132:135]
    ds_read_b64_tr_b16 a[168:169], v9 offset:8192
    ds_read_b64_tr_b16 a[170:171], v9 offset:8704
    v_mfma_f32_16x16x32_bf16 v[140:143], a[188:191], a[60:63], v[140:143]
    ds_read_b64_tr_b16 a[172:173], v9 offset:20480
    v_add_f32 v80, 1.0, v80
    v_mfma_f32_16x16x32_bf16 v[136:139], a[188:191], a[56:59], v[136:139]
    v_add_f32 v81, 1.0, v81
    s_waitcnt lgkmcnt(7)
    v_mfma_f32_16x16x32_bf16 v[144:147], a[144:147], a[56:59], v[144:147]
    ds_read_b64_tr_b16 a[174:175], v9 offset:20992
    ds_read_b64_tr_b16 a[176:177], v10 offset:8192
    v_mfma_f32_16x16x32_bf16 v[196:199], a[248:251], a[116:119], v[196:199]
    v_add_f32 v83, 1.0, v83
    v_add_f32 v82, 1.0, v82
    v_mfma_f32_16x16x32_bf16 v[148:151], a[144:147], a[60:63], v[148:151]
    v_rcp_f32 v80, v80
    v_mfma_f32_16x16x32_bf16 v[156:159], a[148:151], a[60:63], v[156:159]
    ds_read_b64_tr_b16 a[178:179], v10 offset:8704
    ds_read_b64_tr_b16 a[180:181], v10 offset:20480
    v_mfma_f32_16x16x32_bf16 v[152:155], a[148:151], a[56:59], v[152:155]
    buffer_load_dwordx4 v2, s[8:11], s60 offen offset:0 lds
    v_mfma_f32_16x16x32_bf16 v[160:163], a[152:155], a[56:59], v[160:163]
    ds_read_b64_tr_b16 a[182:183], v10 offset:20992
    ds_read_b64_tr_b16 a[184:185], v11 offset:8192
    v_mfma_f32_16x16x32_bf16 v[192:195], a[252:255], a[120:123], v[192:195]
    ds_read_b64_tr_b16 a[186:187], v11 offset:8704
    v_rcp_f32 v82, v82
    v_mfma_f32_16x16x32_bf16 v[164:167], a[152:155], a[60:63], v[164:167]
    v_rcp_f32 v81, v81
    v_mfma_f32_16x16x32_bf16 v[172:175], a[156:159], a[60:63], v[172:175]
    ds_read_b64_tr_b16 a[188:189], v11 offset:20480
    v_rcp_f32 v83, v83
    v_mfma_f32_16x16x32_bf16 v[168:171], a[156:159], a[56:59], v[168:171]
    v_mul_f32 v88, v88, v80
    s_waitcnt lgkmcnt(7)
    v_mfma_f32_16x16x32_bf16 v[112:115], a[160:163], a[64:67], v[112:115]
    ds_read_b64_tr_b16 a[190:191], v11 offset:20992
    v_mul_f32 v89, v89, v81
    v_mfma_f32_16x16x32_bf16 v[196:199], a[252:255], a[124:127], v[196:199]
    ds_read_b64_tr_b16 a[144:145], v8 offset:24576
    buffer_load_dwordx4 v3, s[8:11], s60 offen offset:1024 lds
    v_mfma_f32_16x16x32_bf16 v[116:119], a[160:163], a[68:71], v[116:119]
    ds_read_b64_tr_b16 a[146:147], v8 offset:25088
    v_mul_f32 v90, v90, v82
    v_mfma_f32_16x16x32_bf16 v[124:127], a[164:167], a[68:71], v[124:127]
    ds_read_b64_tr_b16 a[148:149], v8 offset:36864
    v_mul_f32 v91, v91, v83
    v_mfma_f32_16x16x32_bf16 v[120:123], a[164:167], a[64:67], v[120:123]
    ds_read_b64_tr_b16 a[150:151], v8 offset:37376
    v_cvt_pk_bf16_f32 v184, v88, v89
    v_mfma_f32_16x16x32_bf16 v[128:131], a[168:171], a[64:67], v[128:131]
    ds_read_b64_tr_b16 a[152:153], v9 offset:24576
    v_cvt_pk_bf16_f32 v185, v90, v91
    v_mfma_f32_16x16x32_bf16 v[192:195], v[248:251], a[128:131], v[192:195]
    v_exp_f32 v84, v84
    v_mfma_f32_16x16x32_bf16 v[132:135], a[168:171], a[68:71], v[132:135]
    buffer_load_dwordx4 v4, s[8:11], s60 offen offset:2048 lds
    v_mfma_f32_16x16x32_bf16 v[140:143], a[172:175], a[68:71], v[140:143]
    ds_read_b64_tr_b16 a[154:155], v9 offset:25088
    ds_read_b64_tr_b16 a[156:157], v9 offset:36864
    v_mfma_f32_16x16x32_bf16 v[136:139], a[172:175], a[64:67], v[136:139]
    s_waitcnt lgkmcnt(7)
    v_exp_f32 v85, v85
    v_mfma_f32_16x16x32_bf16 v[144:147], a[176:179], a[64:67], v[144:147]
    ds_read_b64_tr_b16 a[158:159], v9 offset:37376
    ds_read_b64_tr_b16 a[160:161], v10 offset:24576
    v_mfma_f32_16x16x32_bf16 v[196:199], v[248:251], a[132:135], v[196:199]
    s_add_u32 m0, s61, 0x15000
    v_exp_f32 v86, v86
    v_mfma_f32_16x16x32_bf16 v[148:151], a[176:179], a[68:71], v[148:151]
    v_exp_f32 v87, v87
    v_mfma_f32_16x16x32_bf16 v[156:159], a[180:183], a[68:71], v[156:159]
    ds_read_b64_tr_b16 a[162:163], v10 offset:25088
    ds_read_b64_tr_b16 a[164:165], v10 offset:36864
    v_mfma_f32_16x16x32_bf16 v[152:155], a[180:183], a[64:67], v[152:155]
    ds_read_b64_tr_b16 a[166:167], v10 offset:37376
    v_add_f32 v84, 1.0, v84
    v_mfma_f32_16x16x32_bf16 v[160:163], a[184:187], a[64:67], v[160:163]
    ds_read_b64_tr_b16 a[168:169], v11 offset:24576
    v_add_f32 v85, 1.0, v85
    v_mfma_f32_16x16x32_bf16 v[192:195], v[252:255], a[136:139], v[192:195]
    v_add_f32 v86, 1.0, v86
    v_add_f32 v87, 1.0, v87
    v_mfma_f32_16x16x32_bf16 v[164:167], a[184:187], a[68:71], v[164:167]
    ds_read_b64_tr_b16 a[170:171], v11 offset:25088
    buffer_load_dwordx4 v2, s[12:15], s60 offen offset:0 lds
    ds_read_b64_tr_b16 a[172:173], v11 offset:36864
    v_mfma_f32_16x16x32_bf16 v[172:175], a[188:191], a[68:71], v[172:175]
    v_rcp_f32 v84, v84
    v_mfma_f32_16x16x32_bf16 v[168:171], a[188:191], a[64:67], v[168:171]
    ds_read_b64_tr_b16 a[174:175], v11 offset:37376
    s_waitcnt lgkmcnt(8)
    v_mfma_f32_16x16x32_bf16 v[112:115], a[144:147], a[72:75], v[112:115]
    s_waitcnt vmcnt(10)
    buffer_store_dword v43, v42, s[24:27], s41 offen offset:0 sc1
    v_mfma_f32_16x16x32_bf16 v[196:199], v[252:255], a[140:143], v[196:199]
    ds_read_b64_tr_b16 a[176:177], v8 offset:28672
    ds_read_b64_tr_b16 a[178:179], v8 offset:29184
    v_mfma_f32_16x16x32_bf16 v[116:119], a[144:147], a[76:79], v[116:119]
    v_rcp_f32 v85, v85
    v_mfma_f32_16x16x32_bf16 v[124:127], a[148:151], a[76:79], v[124:127]
    ds_read_b64_tr_b16 a[180:181], v8 offset:40960
    ds_read_b64_tr_b16 a[182:183], v8 offset:41472
    v_mfma_f32_16x16x32_bf16 v[120:123], a[148:151], a[72:75], v[120:123]
    v_rcp_f32 v86, v86
    v_mfma_f32_16x16x32_bf16 v[128:131], a[152:155], a[72:75], v[128:131]
    buffer_load_dwordx4 v3, s[12:15], s60 offen offset:1024 lds
    v_mfma_f32_16x16x32_bf16 v[132:135], a[152:155], a[76:79], v[132:135]
    ds_read_b64_tr_b16 a[184:185], v9 offset:28672
    ds_read_b64_tr_b16 a[186:187], v9 offset:29184
    v_mfma_f32_16x16x32_bf16 v[140:143], a[156:159], a[76:79], v[140:143]
    ds_read_b64_tr_b16 a[188:189], v9 offset:40960
    v_rcp_f32 v87, v87
    v_mfma_f32_16x16x32_bf16 v[136:139], a[156:159], a[72:75], v[136:139]
    s_waitcnt lgkmcnt(7)
    ds_read_b64_tr_b16 a[190:191], v9 offset:41472
    v_and_b32 v200, 15, v1
    v_mfma_f32_16x16x32_bf16 v[144:147], a[160:163], a[72:75], v[144:147]
    ds_read_b64_tr_b16 a[144:145], v10 offset:28672
    v_mul_f32 v92, v92, v84
    v_mfma_f32_16x16x32_bf16 v[148:151], a[160:163], a[76:79], v[148:151]
    ds_read_b64_tr_b16 a[146:147], v10 offset:29184
    buffer_load_dwordx4 v4, s[12:15], s60 offen offset:2048 lds
    v_mfma_f32_16x16x32_bf16 v[156:159], a[164:167], a[76:79], v[156:159]
    ds_read_b64_tr_b16 a[148:149], v10 offset:40960
    v_lshl_add_u32 v200, v200, 2, s63
    v_mfma_f32_16x16x32_bf16 v[152:155], a[164:167], a[72:75], v[152:155]
    ds_read_b64_tr_b16 a[150:151], v10 offset:41472
    v_mul_f32 v93, v93, v85
    v_mfma_f32_16x16x32_bf16 v[160:163], a[168:171], a[72:75], v[160:163]
    ds_read_b64_tr_b16 a[152:153], v11 offset:28672
    v_cvt_pk_bf16_f32 v192, v192, v192
    v_mfma_f32_16x16x32_bf16 v[164:167], a[168:171], a[76:79], v[164:167]
    ds_read_b64_tr_b16 a[154:155], v11 offset:29184
    v_mul_f32 v94, v94, v86
    v_mfma_f32_16x16x32_bf16 v[172:175], a[172:175], a[76:79], v[172:175]
    ds_read_b64_tr_b16 a[156:157], v11 offset:40960
    v_mul_f32 v95, v95, v87
    v_mfma_f32_16x16x32_bf16 v[168:171], a[172:175], a[72:75], v[168:171]
    s_waitcnt lgkmcnt(7)
    ds_read_b64_tr_b16 a[158:159], v11 offset:41472
    v_cvt_pk_bf16_f32 v196, v196, v196
    v_mfma_f32_16x16x32_bf16 v[112:115], a[176:179], a[80:83], v[112:115]
    s_waitcnt vmcnt(8)
    ds_read_b64_tr_b16 a[160:161], v8 offset:32768
    s_barrier
    v_mfma_f32_16x16x32_bf16 v[116:119], a[176:179], a[84:87], v[116:119]
    ds_read_b64_tr_b16 a[162:163], v8 offset:33280
    v_cvt_pk_bf16_f32 v188, v92, v93
    v_mfma_f32_16x16x32_bf16 v[124:127], a[180:183], a[84:87], v[124:127]
    s_add_u32 s60, s58, 0x100
    ds_read_b64_tr_b16 a[164:165], v8 offset:45056
    v_mfma_f32_16x16x32_bf16 v[120:123], a[180:183], a[80:83], v[120:123]
    ds_read_b64_tr_b16 a[166:167], v8 offset:45568
    v_lshlrev_b32 v192, 16, v192
    v_mfma_f32_16x16x32_bf16 v[128:131], a[184:187], a[80:83], v[128:131]
    ds_read_b64_tr_b16 a[168:169], v9 offset:32768
    v_cvt_pk_bf16_f32 v189, v94, v95
    v_mfma_f32_16x16x32_bf16 v[132:135], a[184:187], a[84:87], v[132:135]
    ds_read_b64_tr_b16 a[170:171], v9 offset:33280
    v_lshlrev_b32 v196, 16, v196
    v_mfma_f32_16x16x32_bf16 v[140:143], a[188:191], a[84:87], v[140:143]
    ds_read_b64_tr_b16 a[172:173], v9 offset:45056
    v_mfma_f32_16x16x32_bf16 v[136:139], a[188:191], a[80:83], v[136:139]
    s_add_u32 m0, s61, 0x0
    ds_read_b64_tr_b16 a[174:175], v9 offset:45568
    s_waitcnt lgkmcnt(8)
    v_mfma_f32_16x16x32_bf16 v[144:147], a[144:147], a[80:83], v[144:147]
    ds_read_b64_tr_b16 a[176:177], v10 offset:32768
    v_mul_f32 v192, s68, v192
    v_mfma_f32_16x16x32_bf16 v[148:151], a[144:147], a[84:87], v[148:151]
    ds_read_b64_tr_b16 a[178:179], v10 offset:33280
    v_exp_f32 v96, v96
    v_mfma_f32_16x16x32_bf16 v[156:159], a[148:151], a[84:87], v[156:159]
    ds_read_b64_tr_b16 a[180:181], v10 offset:45056
    v_exp_f32 v97, v97
    v_mfma_f32_16x16x32_bf16 v[152:155], a[148:151], a[80:83], v[152:155]
    ds_read_b64_tr_b16 a[182:183], v10 offset:45568
    buffer_load_dwordx4 v2, s[8:11], s60 offen offset:0 lds
    v_mfma_f32_16x16x32_bf16 v[160:163], a[152:155], a[80:83], v[160:163]
    ds_read_b64_tr_b16 a[184:185], v11 offset:32768
    v_mul_f32 v196, s68, v196
    v_mfma_f32_16x16x32_bf16 v[164:167], a[152:155], a[84:87], v[164:167]
    ds_read_b64_tr_b16 a[186:187], v11 offset:33280
    ds_read_b64_tr_b16 a[188:189], v11 offset:45056
    v_mfma_f32_16x16x32_bf16 v[172:175], a[156:159], a[84:87], v[172:175]
    v_exp_f32 v98, v98
    v_mfma_f32_16x16x32_bf16 v[168:171], a[156:159], a[80:83], v[168:171]
    s_waitcnt lgkmcnt(7)
    ds_read_b64_tr_b16 a[190:191], v11 offset:45568
    ds_read_b64_tr_b16 a[144:145], v12 offset:0
    v_mfma_f32_16x16x32_bf16 v[112:115], a[160:163], a[88:91], v[112:115]
    buffer_load_dwordx4 v3, s[8:11], s60 offen offset:1024 lds
    v_mfma_f32_16x16x32_bf16 v[116:119], a[160:163], a[92:95], v[116:119]
    ds_read_b64_tr_b16 a[146:147], v12 offset:512
    v_exp_f32 v192, v192
    v_mfma_f32_16x16x32_bf16 v[124:127], a[164:167], a[92:95], v[124:127]
    v_exp_f32 v99, v99
    v_mfma_f32_16x16x32_bf16 v[120:123], a[164:167], a[88:91], v[120:123]
    ds_read_b64_tr_b16 a[148:149], v12 offset:12288
    ds_read_b64_tr_b16 a[150:151], v12 offset:12800
    v_mfma_f32_16x16x32_bf16 v[128:131], a[168:171], a[88:91], v[128:131]
    ds_read_b64_tr_b16 a[152:153], v13 offset:0
    v_add_f32 v96, 1.0, v96
    v_mfma_f32_16x16x32_bf16 v[132:135], a[168:171], a[92:95], v[132:135]
    ds_read_b64_tr_b16 a[154:155], v13 offset:512
    ds_read_b64_tr_b16 a[156:157], v13 offset:12288
    v_mfma_f32_16x16x32_bf16 v[140:143], a[172:175], a[92:95], v[140:143]
    v_exp_f32 v196, v196
    v_mfma_f32_16x16x32_bf16 v[136:139], a[172:175], a[88:91], v[136:139]
    s_waitcnt lgkmcnt(7)
    ds_read_b64_tr_b16 a[158:159], v13 offset:12800
    buffer_load_dwordx4 v4, s[8:11], s60 offen offset:2048 lds
    v_mfma_f32_16x16x32_bf16 v[144:147], a[176:179], a[88:91], v[144:147]
    ds_read_b64_tr_b16 a[160:161], v14 offset:0
    v_add_f32 v98, 1.0, v98
    v_mfma_f32_16x16x32_bf16 v[148:151], a[176:179], a[92:95], v[148:151]
    s_add_u32 m0, s61, 0x3000
    ds_read_b64_tr_b16 a[162:163], v14 offset:512
    v_add_f32 v192, 1.0, v192
    v_mfma_f32_16x16x32_bf16 v[156:159], a[180:183], a[92:95], v[156:159]
    ds_read_b64_tr_b16 a[164:165], v14 offset:12288
    v_add_f32 v99, 1.0, v99
    v_mfma_f32_16x16x32_bf16 v[152:155], a[180:183], a[88:91], v[152:155]
    ds_read_b64_tr_b16 a[166:167], v14 offset:12800
    v_add_f32 v97, 1.0, v97
    v_mfma_f32_16x16x32_bf16 v[160:163], a[184:187], a[88:91], v[160:163]
    ds_read_b64_tr_b16 a[168:169], v15 offset:0
    v_add_f32 v196, 1.0, v196
    v_mfma_f32_16x16x32_bf16 v[164:167], a[184:187], a[92:95], v[164:167]
    v_rcp_f32 v96, v96
    v_mfma_f32_16x16x32_bf16 v[172:175], a[188:191], a[92:95], v[172:175]
    ds_read_b64_tr_b16 a[170:171], v15 offset:512
    ds_read_b64_tr_b16 a[172:173], v15 offset:12288
    v_mfma_f32_16x16x32_bf16 v[168:171], a[188:191], a[88:91], v[168:171]
    s_waitcnt lgkmcnt(7)
    ds_read_b64_tr_b16 a[174:175], v15 offset:12800
    ds_read_b64_tr_b16 a[176:177], v12 offset:4096
    v_mfma_f32_16x16x32_bf16 v[112:115], a[144:147], a[96:99], v[112:115]
    ds_read_b64_tr_b16 a[178:179], v12 offset:4608
    v_rcp_f32 v97, v97
    v_mfma_f32_16x16x32_bf16 v[116:119], a[144:147], a[100:103], v[116:119]
    v_rcp_f32 v192, v192
    v_mfma_f32_16x16x32_bf16 v[124:127], a[148:151], a[100:103], v[124:127]
    buffer_load_dwordx4 v2, s[12:15], s60 offen offset:0 lds
    ds_read_b64_tr_b16 a[180:181], v12 offset:16384
    v_mfma_f32_16x16x32_bf16 v[120:123], a[148:151], a[96:99], v[120:123]
    v_rcp_f32 v98, v98
    v_mfma_f32_16x16x32_bf16 v[128:131], a[152:155], a[96:99], v[128:131]
    buffer_load_dwordx4 v3, s[12:15], s60 offen offset:1024 lds
    ds_read_b64_tr_b16 a[182:183], v12 offset:16896
    v_mfma_f32_16x16x32_bf16 v[132:135], a[152:155], a[100:103], v[132:135]
    ds_read_b64_tr_b16 a[184:185], v13 offset:4096
    ds_read_b64_tr_b16 a[186:187], v13 offset:4608
    v_mfma_f32_16x16x32_bf16 v[140:143], a[156:159], a[100:103], v[140:143]
    v_rcp_f32 v196, v196
    v_mfma_f32_16x16x32_bf16 v[136:139], a[156:159], a[96:99], v[136:139]
    s_waitcnt lgkmcnt(6)
    ds_read_b64_tr_b16 a[188:189], v13 offset:16384
    v_rcp_f32 v99, v99
    v_mfma_f32_16x16x32_bf16 v[144:147], a[160:163], a[96:99], v[144:147]
    ds_read_b64_tr_b16 a[190:191], v13 offset:16896
    ds_read_b64_tr_b16 a[144:145], v14 offset:4096
    v_mfma_f32_16x16x32_bf16 v[148:151], a[160:163], a[100:103], v[148:151]
    buffer_load_dwordx4 v4, s[12:15], s60 offen offset:2048 lds
    ds_read_b64_tr_b16 a[146:147], v14 offset:4608
    v_mfma_f32_16x16x32_bf16 v[156:159], a[164:167], a[100:103], v[156:159]
    ds_read_b64_tr_b16 a[148:149], v14 offset:16384
    v_mul_f32 v104, v104, v96
    v_mfma_f32_16x16x32_bf16 v[152:155], a[164:167], a[96:99], v[152:155]
    ds_read_b64_tr_b16 a[150:151], v14 offset:16896
    v_cvt_pk_bf16_f32 v36, v192, v192
    v_mfma_f32_16x16x32_bf16 v[160:163], a[168:171], a[96:99], v[160:163]
    ds_read_b64_tr_b16 a[152:153], v15 offset:4096
    v_mul_f32 v105, v105, v97
    v_mfma_f32_16x16x32_bf16 v[164:167], a[168:171], a[100:103], v[164:167]
    ds_read_b64_tr_b16 a[154:155], v15 offset:4608
    v_cvt_pk_bf16_f32 v37, v196, v196
    v_mfma_f32_16x16x32_bf16 v[172:175], a[172:175], a[100:103], v[172:175]
    ds_read_b64_tr_b16 a[156:157], v15 offset:16384
    v_mul_f32 v106, v106, v98
    v_mfma_f32_16x16x32_bf16 v[168:171], a[172:175], a[96:99], v[168:171]
    s_waitcnt lgkmcnt(7)
    ds_read_b64_tr_b16 a[158:159], v15 offset:16896
    ds_write_b32 v200, v36 offset:16256
    v_mfma_f32_16x16x32_bf16 v[112:115], a[176:179], a[104:107], v[112:115]
    s_waitcnt vmcnt(6)
    ds_read_b64_tr_b16 a[160:161], v12 offset:8192
    s_barrier
    v_mfma_f32_16x16x32_bf16 v[116:119], a[176:179], a[108:111], v[116:119]
    ds_read_b64_tr_b16 a[162:163], v12 offset:8704
    v_mul_f32 v107, v107, v99
    v_mfma_f32_16x16x32_bf16 v[124:127], a[180:183], a[108:111], v[124:127]
    ds_read_b64_tr_b16 a[164:165], v12 offset:20480
    v_mfma_f32_16x16x32_bf16 v[120:123], a[180:183], a[104:107], v[120:123]
    s_add_u32 s60, s58, 0xd8100
    ds_read_b64_tr_b16 a[166:167], v12 offset:20992
    v_mfma_f32_16x16x32_bf16 v[128:131], a[184:187], a[104:107], v[128:131]
    ds_write_b32 v200, v37 offset:16320
    v_cvt_pk_bf16_f32 v186, v104, v105
    v_mfma_f32_16x16x32_bf16 v[132:135], a[184:187], a[108:111], v[132:135]
    ds_read_b64_tr_b16 a[168:169], v13 offset:8192
    ds_read_b64_tr_b16 a[170:171], v13 offset:8704
    v_mfma_f32_16x16x32_bf16 v[140:143], a[188:191], a[108:111], v[140:143]
    ds_read_b64_tr_b16 a[172:173], v13 offset:20480
    v_cvt_pk_bf16_f32 v187, v106, v107
    v_mfma_f32_16x16x32_bf16 v[136:139], a[188:191], a[104:107], v[136:139]
    ds_read_b64_tr_b16 a[174:175], v13 offset:20992
    s_waitcnt lgkmcnt(10)
    v_mfma_f32_16x16x32_bf16 v[144:147], a[144:147], a[104:107], v[144:147]
    ds_read_b64_tr_b16 a[176:177], v14 offset:8192
    s_add_u32 m0, s61, 0x6000
    v_mfma_f32_16x16x32_bf16 v[148:151], a[144:147], a[108:111], v[148:151]
    buffer_store_dwordx4 v[184:187], v40, s[24:27], 0 offen offset:2048 sc1
    ds_read_b64_tr_b16 a[178:179], v14 offset:8704
    v_exp_f32 v100, v100
    v_mfma_f32_16x16x32_bf16 v[156:159], a[148:151], a[108:111], v[156:159]
    ds_read_b64_tr_b16 a[180:181], v14 offset:20480
    ds_read_b64_tr_b16 a[182:183], v14 offset:20992
    v_mfma_f32_16x16x32_bf16 v[152:155], a[148:151], a[104:107], v[152:155]
    buffer_load_dwordx4 v2, s[8:11], s60 offen offset:0 lds
    v_mfma_f32_16x16x32_bf16 v[160:163], a[152:155], a[104:107], v[160:163]
    v_exp_f32 v101, v101
    v_mfma_f32_16x16x32_bf16 v[164:167], a[152:155], a[108:111], v[164:167]
    ds_read_b64_tr_b16 a[184:185], v15 offset:8192
    ds_read_b64_tr_b16 a[186:187], v15 offset:8704
    v_mfma_f32_16x16x32_bf16 v[172:175], a[156:159], a[108:111], v[172:175]
    ds_read_b64_tr_b16 a[188:189], v15 offset:20480
    v_exp_f32 v102, v102
    v_mfma_f32_16x16x32_bf16 v[168:171], a[156:159], a[104:107], v[168:171]
    s_waitcnt lgkmcnt(7)
    ds_read_b64_tr_b16 a[190:191], v15 offset:20992
    ds_read_b64_tr_b16 a[144:145], v12 offset:24576
    v_mfma_f32_16x16x32_bf16 v[112:115], a[160:163], a[112:115], v[112:115]
    ds_read_b64_tr_b16 a[146:147], v12 offset:25088
    buffer_load_dwordx4 v3, s[8:11], s60 offen offset:1024 lds
    v_mfma_f32_16x16x32_bf16 v[116:119], a[160:163], a[116:119], v[116:119]
    v_exp_f32 v103, v103
    v_mfma_f32_16x16x32_bf16 v[124:127], a[164:167], a[116:119], v[124:127]
    ds_read_b64_tr_b16 a[148:149], v12 offset:36864
    v_add_f32 v100, 1.0, v100
    v_mfma_f32_16x16x32_bf16 v[120:123], a[164:167], a[112:115], v[120:123]
    ds_read_b64_tr_b16 a[150:151], v12 offset:37376
    v_add_f32 v101, 1.0, v101
    v_mfma_f32_16x16x32_bf16 v[128:131], a[168:171], a[112:115], v[128:131]
    ds_read_b64_tr_b16 a[152:153], v12 offset:28672
    ds_read_b64_tr_b16 a[154:155], v12 offset:29184
    v_mfma_f32_16x16x32_bf16 v[132:135], a[168:171], a[116:119], v[132:135]
    buffer_load_dwordx4 v4, s[8:11], s60 offen offset:2048 lds
    v_mfma_f32_16x16x32_bf16 v[140:143], a[172:175], a[116:119], v[140:143]
    ds_read_b64_tr_b16 a[156:157], v12 offset:40960
    v_add_f32 v103, 1.0, v103
    v_mfma_f32_16x16x32_bf16 v[136:139], a[172:175], a[112:115], v[136:139]
    s_waitcnt lgkmcnt(7)
    ds_read_b64_tr_b16 a[158:159], v12 offset:41472
    v_add_f32 v102, 1.0, v102
    v_mfma_f32_16x16x32_bf16 v[144:147], a[176:179], a[112:115], v[144:147]
    v_rcp_f32 v100, v100
    v_mfma_f32_16x16x32_bf16 v[148:151], a[176:179], a[116:119], v[148:151]
    ds_read_b64_tr_b16 a[160:161], v12 offset:32768
    ds_read_b64_tr_b16 a[162:163], v12 offset:33280
    v_mfma_f32_16x16x32_bf16 v[156:159], a[180:183], a[116:119], v[156:159]
    ds_read_b64_tr_b16 a[164:165], v12 offset:45056
    v_mfma_f32_16x16x32_bf16 v[152:155], a[180:183], a[112:115], v[152:155]
    s_add_u32 m0, s61, 0x9000
    v_rcp_f32 v101, v101
    v_mfma_f32_16x16x32_bf16 v[160:163], a[184:187], a[112:115], v[160:163]
    ds_read_b64_tr_b16 a[166:167], v12 offset:45568
    ds_read_b64_tr_b16 a[168:169], v13 offset:24576
    v_mfma_f32_16x16x32_bf16 v[164:167], a[184:187], a[116:119], v[164:167]
    s_and_b32 s55, s51, 6
    v_rcp_f32 v102, v102
    v_mfma_f32_16x16x32_bf16 v[172:175], a[188:191], a[116:119], v[172:175]
    ds_read_b64_tr_b16 a[170:171], v13 offset:25088
    ds_read_b64_tr_b16 a[172:173], v13 offset:36864
    v_mfma_f32_16x16x32_bf16 v[168:171], a[188:191], a[112:115], v[168:171]
    s_waitcnt lgkmcnt(7)
    ds_read_b64_tr_b16 a[174:175], v13 offset:37376
    ds_read_b64_tr_b16 a[176:177], v13 offset:28672
    v_mfma_f32_16x16x32_bf16 v[112:115], a[144:147], a[120:123], v[112:115]
    s_lshl_b32 s41, s55, 6
    v_rcp_f32 v103, v103
    v_mfma_f32_16x16x32_bf16 v[116:119], a[144:147], a[124:127], v[116:119]
    ds_read_b64_tr_b16 a[178:179], v13 offset:29184
    buffer_load_dwordx4 v2, s[12:15], s60 offen offset:0 lds
    v_mfma_f32_16x16x32_bf16 v[124:127], a[148:151], a[124:127], v[124:127]
    ds_read_b64_tr_b16 a[180:181], v13 offset:40960
    v_mul_f32 v108, v108, v100
    v_mfma_f32_16x16x32_bf16 v[120:123], a[148:151], a[120:123], v[120:123]
    s_add_u32 s55, s41, 128
    ds_read_b64_tr_b16 a[182:183], v13 offset:41472
    v_mul_f32 v109, v109, v101
    v_mfma_f32_16x16x32_bf16 v[112:115], a[152:155], a[128:131], v[112:115]
    ds_read_b64_tr_b16 a[184:185], v13 offset:32768
    buffer_load_dwordx4 v3, s[12:15], s60 offen offset:1024 lds
    v_mfma_f32_16x16x32_bf16 v[116:119], a[152:155], a[132:135], v[116:119]
    ds_read_b64_tr_b16 a[186:187], v13 offset:33280
    v_mul_f32 v110, v110, v102
    v_mfma_f32_16x16x32_bf16 v[124:127], a[156:159], a[132:135], v[124:127]
    ds_read_b64_tr_b16 a[188:189], v13 offset:45056
    v_mfma_f32_16x16x32_bf16 v[120:123], a[156:159], a[128:131], v[120:123]
    s_waitcnt lgkmcnt(7)
    ds_read_b64_tr_b16 a[190:191], v13 offset:45568
    v_mul_f32 v111, v111, v103
    v_mfma_f32_16x16x32_bf16 v[112:115], a[160:163], a[136:139], v[112:115]
    ds_read_b64_tr_b16 a[144:145], v14 offset:24576
    s_and_b32 s0, s55, 511
    v_mfma_f32_16x16x32_bf16 v[116:119], a[160:163], a[140:143], v[116:119]
    buffer_load_dwordx4 v4, s[12:15], s60 offen offset:2048 lds
    ds_read_b64_tr_b16 a[146:147], v14 offset:25088
    v_mfma_f32_16x16x32_bf16 v[124:127], a[164:167], a[140:143], v[124:127]
    s_add_u32 s55, s41, 256
    ds_read_b64_tr_b16 a[148:149], v14 offset:36864
    v_cvt_pk_bf16_f32 v191, v110, v111
    v_mfma_f32_16x16x32_bf16 v[120:123], a[164:167], a[136:139], v[120:123]
    ds_read_b64_tr_b16 a[150:151], v14 offset:37376
    v_mfma_f32_16x16x32_bf16 v[128:131], a[168:171], a[120:123], v[128:131]
    s_and_b32 s1, s55, 511
    ds_read_b64_tr_b16 a[152:153], v14 offset:28672
    v_cvt_pk_bf16_f32 v190, v108, v109
    v_mfma_f32_16x16x32_bf16 v[132:135], a[168:171], a[124:127], v[132:135]
    s_add_u32 s55, s41, 384
    ds_read_b64_tr_b16 a[154:155], v14 offset:29184
    v_mul_f32 v50, s68, v114
    v_mfma_f32_16x16x32_bf16 v[140:143], a[172:175], a[124:127], v[140:143]
    buffer_store_dwordx4 v[188:191], v40, s[24:27], 0 offen offset:3072 sc1
    ds_read_b64_tr_b16 a[156:157], v14 offset:40960
    v_mul_f32 v48, s68, v112
    v_mul_f32 v49, s68, v113
    v_mfma_f32_16x16x32_bf16 v[136:139], a[172:175], a[120:123], v[136:139]
    s_waitcnt lgkmcnt(7)
    ds_read_b64_tr_b16 a[158:159], v14 offset:41472
    ds_read_b64_tr_b16 a[160:161], v14 offset:32768
    v_mfma_f32_16x16x32_bf16 v[128:131], a[176:179], a[128:131], v[128:131]
    s_waitcnt vmcnt(8)
    s_barrier
    v_mfma_f32_16x16x32_bf16 v[132:135], a[176:179], a[132:135], v[132:135]
    s_add_u32 s60, s58, 0x1b0100
    ds_read_b64_tr_b16 a[162:163], v14 offset:33280
    v_mul_f32 v52, s68, v116
    v_mfma_f32_16x16x32_bf16 v[140:143], a[180:183], a[132:135], v[140:143]
    ds_read_b64_tr_b16 a[164:165], v14 offset:45056
    v_mul_f32 v53, s68, v117
    v_mfma_f32_16x16x32_bf16 v[136:139], a[180:183], a[128:131], v[136:139]
    ds_read_b64_tr_b16 a[166:167], v14 offset:45568
    v_mul_f32 v54, s68, v118
    v_mfma_f32_16x16x32_bf16 v[128:131], a[184:187], a[136:139], v[128:131]
    ds_read_b64_tr_b16 a[168:169], v15 offset:24576
    v_mul_f32 v57, v113, v121
    v_mfma_f32_16x16x32_bf16 v[132:135], a[184:187], a[140:143], v[132:135]
    s_and_b32 s3, s55, 511
    ds_read_b64_tr_b16 a[170:171], v15 offset:25088
    v_mul_f32 v51, s68, v115
    v_mfma_f32_16x16x32_bf16 v[140:143], a[188:191], a[140:143], v[140:143]
    s_andn2_b32 s55, 1, s51
    ds_read_b64_tr_b16 a[172:173], v15 offset:36864
    v_mul_f32 v58, v114, v122
    v_mfma_f32_16x16x32_bf16 v[136:139], a[188:191], a[136:139], v[136:139]
    s_waitcnt lgkmcnt(7)
    ds_read_b64_tr_b16 a[174:175], v15 offset:37376
    v_mul_f32 v55, s68, v119
    v_mfma_f32_16x16x32_bf16 v[144:147], a[144:147], a[120:123], v[144:147]
    s_add_u32 m0, s61, 0xc000
    ds_read_b64_tr_b16 a[176:177], v15 offset:28672
    v_mul_f32 v60, v116, v124
    v_mfma_f32_16x16x32_bf16 v[148:151], a[144:147], a[124:127], v[148:151]
    s_lshl_b32 s101, s55, 16
    ds_read_b64_tr_b16 a[178:179], v15 offset:29184
    v_mul_f32 v63, v119, v127
    v_mfma_f32_16x16x32_bf16 v[156:159], a[148:151], a[124:127], v[156:159]
    s_mul_i32 s56, s50, 14336
    ds_read_b64_tr_b16 a[180:181], v15 offset:40960
    v_mul_f32 v61, v117, v125
    v_mfma_f32_16x16x32_bf16 v[152:155], a[148:151], a[120:123], v[152:155]
    ds_read_b64_tr_b16 a[182:183], v15 offset:41472
    buffer_load_dwordx4 v2, s[8:11], s60 offen offset:0 lds
    v_mul_f32 v59, v115, v123
    v_mul_f32 v62, v118, v126
    v_mul_f32 v56, v112, v120
    v_mul_f32 v64, s68, v128
    v_mfma_f32_16x16x32_bf16 v[144:147], a[152:155], a[128:131], v[144:147]
    ds_read_b64_tr_b16 a[184:185], v15 offset:32768
    v_mul_f32 v66, s68, v130
    v_mfma_f32_16x16x32_bf16 v[148:151], a[152:155], a[132:135], v[148:151]
    ds_read_b64_tr_b16 a[186:187], v15 offset:33280
    v_mul_f32 v67, s68, v131
    v_mfma_f32_16x16x32_bf16 v[156:159], a[156:159], a[132:135], v[156:159]
    ds_read_b64_tr_b16 a[188:189], v15 offset:45056
    v_mul_f32 v69, s68, v133
    v_mfma_f32_16x16x32_bf16 v[152:155], a[156:159], a[128:131], v[152:155]
    s_waitcnt lgkmcnt(7)
    ds_read_b64_tr_b16 a[190:191], v15 offset:45568
    v_mul_f32 v72, v128, v136
    v_mul_f32 v65, s68, v129
    v_mfma_f32_16x16x32_bf16 v[144:147], a[160:163], a[136:139], v[144:147]
    s_mul_i32 s55, s52, 458752
    ds_read_b64_tr_b16 a[144:145], v8 offset:0
    buffer_load_dwordx4 v3, s[8:11], s60 offen offset:1024 lds
    v_mul_f32 v71, s68, v135
    v_mfma_f32_16x16x32_bf16 v[148:151], a[160:163], a[140:143], v[148:151]
    ds_read_b64_tr_b16 a[146:147], v8 offset:512
    v_mul_f32 v68, s68, v132
    v_mul_f32 v70, s68, v134
    v_mfma_f32_16x16x32_bf16 v[156:159], a[164:167], a[140:143], v[156:159]
    ds_read_b64_tr_b16 a[148:149], v8 offset:12288
    v_mul_f32 v78, v134, v142
    v_mul_f32 v76, v132, v140
    v_mfma_f32_16x16x32_bf16 v[152:155], a[164:167], a[136:139], v[152:155]
    ds_read_b64_tr_b16 a[150:151], v8 offset:12800
    v_mul_f32 v75, v131, v139
    v_mfma_f32_16x16x32_bf16 v[160:163], a[168:171], a[120:123], v[160:163]
    s_mul_i32 s57, s51, 7168
    ds_read_b64_tr_b16 a[152:153], v8 offset:4096
    v_mul_f32 v74, v130, v138
    v_mfma_f32_16x16x32_bf16 v[164:167], a[168:171], a[124:127], v[164:167]
    s_add_u32 s55, s55, s57
    ds_read_b64_tr_b16 a[154:155], v8 offset:4608
    buffer_load_dwordx4 v4, s[8:11], s60 offen offset:2048 lds
    v_mul_f32 v73, v129, v137
    v_mul_f32 v77, v133, v141
    v_mfma_f32_16x16x32_bf16 v[172:175], a[172:175], a[124:127], v[172:175]
    ds_read_b64_tr_b16 a[156:157], v8 offset:16384
    v_mul_f32 v81, s68, v145
    v_mfma_f32_16x16x32_bf16 v[168:171], a[172:175], a[120:123], v[168:171]
    s_waitcnt lgkmcnt(7)
    ds_read_b64_tr_b16 a[158:159], v8 offset:16896
    v_mul_f32 v79, v135, v143
    v_mfma_f32_16x16x32_bf16 v[160:163], a[176:179], a[128:131], v[160:163]
    ds_read_b64_tr_b16 a[160:161], v8 offset:8192
    v_mul_f32 v83, s68, v147
    v_mfma_f32_16x16x32_bf16 v[164:167], a[176:179], a[132:135], v[164:167]
    s_sub_u32 s56, s56, s55
    ds_read_b64_tr_b16 a[162:163], v8 offset:8704
    v_mul_f32 v82, s68, v146
    v_mfma_f32_16x16x32_bf16 v[172:175], a[180:183], a[132:135], v[172:175]
    s_add_u32 m0, s61, 0xf000
    ds_read_b64_tr_b16 a[164:165], v8 offset:20480
    v_mul_f32 v85, s68, v149
    v_mfma_f32_16x16x32_bf16 v[168:171], a[180:183], a[128:131], v[168:171]
    s_add_u32 s100, s56, 0x1000000
    ds_read_b64_tr_b16 a[166:167], v8 offset:20992
    v_mul_f32 v87, s68, v151
    v_mfma_f32_16x16x32_bf16 v[160:163], a[184:187], a[136:139], v[160:163]
    ds_read_b64_tr_b16 a[168:169], v9 offset:0
    v_mul_f32 v89, v145, v153
    v_mul_f32 v88, v144, v152
    v_mul_f32 v80, s68, v144
    v_mul_f32 v84, s68, v148
    v_mul_f32 v86, s68, v150
    v_mfma_f32_16x16x32_bf16 v[164:167], a[184:187], a[140:143], v[164:167]
    ds_read_b64_tr_b16 a[170:171], v9 offset:512
    v_mul_f32 v90, v146, v154
    v_mfma_f32_16x16x32_bf16 v[172:175], a[188:191], a[140:143], v[172:175]
    ds_read_b64_tr_b16 a[172:173], v9 offset:12288
    v_mul_f32 v92, v148, v156
    v_mfma_f32_16x16x32_bf16 v[168:171], a[188:191], a[136:139], v[168:171]
    s_waitcnt lgkmcnt(7)
    ds_read_b64_tr_b16 a[174:175], v9 offset:12800
    buffer_load_dwordx4 v2, s[12:15], s60 offen offset:0 lds
    v_mfma_f32_16x16x32_bf16 v[112:115], a[144:147], a[0:3], 0
    ds_read_b64_tr_b16 a[176:177], v9 offset:4096
    v_mul_f32 v91, v147, v155
    v_mfma_f32_16x16x32_bf16 v[116:119], a[144:147], a[4:7], 0
    ds_read_b64_tr_b16 a[178:179], v9 offset:4608
    v_mul_f32 v96, s68, v160
    v_mfma_f32_16x16x32_bf16 v[124:127], a[148:151], a[4:7], 0
    ds_read_b64_tr_b16 a[180:181], v9 offset:16384
    v_mul_f32 v95, v151, v159
    v_mfma_f32_16x16x32_bf16 v[120:123], a[148:151], a[0:3], 0
    ds_read_b64_tr_b16 a[182:183], v9 offset:16896
    v_mul_f32 v97, s68, v161
    v_mfma_f32_16x16x32_bf16 v[112:115], a[152:155], a[8:11], v[112:115]
    buffer_load_dwordx4 v3, s[12:15], s60 offen offset:1024 lds
    ds_read_b64_tr_b16 a[184:185], v9 offset:8192
    v_mfma_f32_16x16x32_bf16 v[116:119], a[152:155], a[12:15], v[116:119]
    ds_read_b64_tr_b16 a[186:187], v9 offset:8704
    v_mul_f32 v93, v149, v157
    v_mul_f32 v99, s68, v163
    v_mfma_f32_16x16x32_bf16 v[124:127], a[156:159], a[12:15], v[124:127]
    ds_read_b64_tr_b16 a[188:189], v9 offset:20480
    v_mul_f32 v98, s68, v162
    v_mul_f32 v100, s68, v164
    v_mfma_f32_16x16x32_bf16 v[120:123], a[156:159], a[8:11], v[120:123]
    s_waitcnt lgkmcnt(7)
    ds_read_b64_tr_b16 a[190:191], v9 offset:20992
    v_mul_f32 v101, s68, v165
    v_mul_f32 v94, v150, v158
    v_mfma_f32_16x16x32_bf16 v[112:115], a[160:163], a[16:19], v[112:115]
    ds_read_b64_tr_b16 a[144:145], v10 offset:0
    v_exp_f32 v48, v48
    v_mul_f32 v104, v160, v168
    v_mul_f32 v107, v163, v171
    v_mul_f32 v102, s68, v166
    v_mfma_f32_16x16x32_bf16 v[116:119], a[160:163], a[20:23], v[116:119]
    ds_read_b64_tr_b16 a[146:147], v10 offset:512
    buffer_load_dwordx4 v4, s[12:15], s60 offen offset:2048 lds
    v_mfma_f32_16x16x32_bf16 v[124:127], a[164:167], a[20:23], v[124:127]
    ds_read_b64_tr_b16 a[148:149], v10 offset:12288
    v_mul_f32 v103, s68, v167
    v_mfma_f32_16x16x32_bf16 v[120:123], a[164:167], a[16:19], v[120:123]
    ds_read_b64_tr_b16 a[150:151], v10 offset:12800
    v_mov_b32 v208, -1
    v_mfma_f32_16x16x32_bf16 v[128:131], a[168:171], a[0:3], 0
    ds_read_b64_tr_b16 a[152:153], v10 offset:4096
    v_mul_f32 v106, v162, v170
    v_mul_f32 v109, v165, v173
    v_mfma_f32_16x16x32_bf16 v[132:135], a[168:171], a[4:7], 0
    ds_read_b64_tr_b16 a[154:155], v10 offset:4608
    v_mul_f32 v105, v161, v169
    v_mfma_f32_16x16x32_bf16 v[140:143], a[172:175], a[4:7], 0
    ds_read_b64_tr_b16 a[156:157], v10 offset:16384
    v_mul_f32 v108, v164, v172
    v_mfma_f32_16x16x32_bf16 v[136:139], a[172:175], a[0:3], 0
    s_waitcnt lgkmcnt(7)
    ds_read_b64_tr_b16 a[158:159], v10 offset:16896
    ds_read_b64_tr_b16 a[160:161], v10 offset:8192
    v_mfma_f32_16x16x32_bf16 v[128:131], a[176:179], a[8:11], v[128:131]
    s_waitcnt vmcnt(7)
    s_barrier
    v_mul_f32 v111, v167, v175
    v_mul_f32 v110, v166, v174
    v_mov_b32 v209, -1
    v_mfma_f32_16x16x32_bf16 v[132:135], a[176:179], a[12:15], v[132:135]
    s_add_u32 s60, s58, 0x288100
    ds_read_b64_tr_b16 a[162:163], v10 offset:8704
    v_exp_f32 v49, v49
    v_mfma_f32_16x16x32_bf16 v[140:143], a[180:183], a[12:15], v[140:143]
    ds_read_b64_tr_b16 a[164:165], v10 offset:20480
    v_exp_f32 v50, v50
    v_mfma_f32_16x16x32_bf16 v[136:139], a[180:183], a[8:11], v[136:139]
    ds_read_b64_tr_b16 a[166:167], v10 offset:20992
    v_mov_b32 v210, -1
    v_mfma_f32_16x16x32_bf16 v[128:131], a[184:187], a[16:19], v[128:131]
    ds_read_b64_tr_b16 a[168:169], v11 offset:0
    v_mov_b32 v211, -1
    v_mfma_f32_16x16x32_bf16 v[132:135], a[184:187], a[20:23], v[132:135]
    s_add_u32 m0, s61, 0x12000
    ds_read_b64_tr_b16 a[170:171], v11 offset:512
    v_exp_f32 v51, v51
    v_mfma_f32_16x16x32_bf16 v[140:143], a[188:191], a[20:23], v[140:143]
    ds_read_b64_tr_b16 a[172:173], v11 offset:12288
    v_add_f32 v48, 1.0, v48
    v_mfma_f32_16x16x32_bf16 v[136:139], a[188:191], a[16:19], v[136:139]
    s_waitcnt lgkmcnt(7)
    ds_read_b64_tr_b16 a[174:175], v11 offset:12800
    v_add_f32 v49, 1.0, v49
    v_mfma_f32_16x16x32_bf16 v[144:147], a[144:147], a[0:3], 0
    buffer_load_dword v46, v246, s[24:27], 0 offen sc1
    ds_read_b64_tr_b16 a[176:177], v11 offset:4096
    v_mfma_f32_16x16x32_bf16 v[148:151], a[144:147], a[4:7], 0
    s_lshl_b32 s62, s3, 10
    ds_read_b64_tr_b16 a[178:179], v11 offset:4608
    buffer_load_dword v240, off, s[24:27], s44 sc1
    ds_read_b64_tr_b16 a[180:181], v11 offset:16384
    v_mfma_f32_16x16x32_bf16 v[156:159], a[148:151], a[4:7], 0
    v_add_f32 v51, 1.0, v51
    v_add_f32 v50, 1.0, v50
    v_mfma_f32_16x16x32_bf16 v[152:155], a[148:151], a[0:3], 0
    buffer_load_dwordx4 v2, s[8:11], s60 offen offset:0 lds
    v_mfma_f32_16x16x32_bf16 v[144:147], a[152:155], a[8:11], v[144:147]
    s_add_u32 s62, s62, s101
    ds_read_b64_tr_b16 a[182:183], v11 offset:16896
    ds_read_b64_tr_b16 a[184:185], v11 offset:8192
    v_mfma_f32_16x16x32_bf16 v[148:151], a[152:155], a[12:15], v[148:151]
    buffer_store_dwordx4 v[208:211], v44, s[24:27], s62 offen offset:0 sc1
    ds_read_b64_tr_b16 a[186:187], v11 offset:8704
    v_rcp_f32 v48, v48
    v_mfma_f32_16x16x32_bf16 v[156:159], a[156:159], a[12:15], v[156:159]
    ds_read_b64_tr_b16 a[188:189], v11 offset:20480
    ds_read_b64_tr_b16 a[190:191], v11 offset:20992
    v_mfma_f32_16x16x32_bf16 v[152:155], a[156:159], a[8:11], v[152:155]
    s_waitcnt lgkmcnt(8)
    v_rcp_f32 v49, v49
    v_mfma_f32_16x16x32_bf16 v[144:147], a[160:163], a[16:19], v[144:147]
    buffer_load_dwordx4 v3, s[8:11], s60 offen offset:1024 lds
    v_mfma_f32_16x16x32_bf16 v[148:151], a[160:163], a[20:23], v[148:151]
    ds_read_b64_tr_b16 a[144:145], v8 offset:24576
    ds_read_b64_tr_b16 a[146:147], v8 offset:25088
    v_mfma_f32_16x16x32_bf16 v[156:159], a[164:167], a[20:23], v[156:159]
    buffer_store_dwordx4 v[208:211], v44, s[24:27], s62 offen offset:1024 sc1
    ds_read_b64_tr_b16 a[148:149], v8 offset:36864
    v_rcp_f32 v50, v50
    v_mfma_f32_16x16x32_bf16 v[152:155], a[164:167], a[16:19], v[152:155]
    s_xor_b32 s62, s62, 0x10000
    ds_read_b64_tr_b16 a[150:151], v8 offset:37376
    ds_read_b64_tr_b16 a[152:153], v9 offset:24576
    v_mfma_f32_16x16x32_bf16 v[160:163], a[168:171], a[0:3], 0
    v_rcp_f32 v51, v51
    v_mfma_f32_16x16x32_bf16 v[164:167], a[168:171], a[4:7], 0
    ds_read_b64_tr_b16 a[154:155], v9 offset:25088
    buffer_load_dwordx4 v4, s[8:11], s60 offen offset:2048 lds
    v_mfma_f32_16x16x32_bf16 v[172:175], a[172:175], a[4:7], 0
    ds_read_b64_tr_b16 a[156:157], v9 offset:36864
    v_mul_f32 v56, v56, v48
    v_mfma_f32_16x16x32_bf16 v[168:171], a[172:175], a[0:3], 0
    s_waitcnt lgkmcnt(7)
    ds_read_b64_tr_b16 a[158:159], v9 offset:37376
    v_mul_f32 v57, v57, v49
    v_mfma_f32_16x16x32_bf16 v[160:163], a[176:179], a[8:11], v[160:163]
    s_add_u32 m0, s61, 0x15000
    ds_read_b64_tr_b16 a[160:161], v10 offset:24576
    v_mul_f32 v58, v58, v50
    v_mfma_f32_16x16x32_bf16 v[164:167], a[176:179], a[12:15], v[164:167]
    v_mul_f32 v59, v59, v51
    v_cvt_pk_bf16_f32 v193, v58, v59
    v_mfma_f32_16x16x32_bf16 v[172:175], a[180:183], a[12:15], v[172:175]
    buffer_store_dwordx4 v[208:211], v44, s[24:27], s62 offen offset:0 sc1
    ds_read_b64_tr_b16 a[162:163], v10 offset:25088
    ds_read_b64_tr_b16 a[164:165], v10 offset:36864
    v_mfma_f32_16x16x32_bf16 v[168:171], a[180:183], a[8:11], v[168:171]
    ds_read_b64_tr_b16 a[166:167], v10 offset:37376
    v_cvt_pk_bf16_f32 v192, v56, v57
    v_mfma_f32_16x16x32_bf16 v[160:163], a[184:187], a[16:19], v[160:163]
    v_exp_f32 v52, v52
    v_mfma_f32_16x16x32_bf16 v[164:167], a[184:187], a[20:23], v[164:167]
    ds_read_b64_tr_b16 a[168:169], v11 offset:24576
    ds_read_b64_tr_b16 a[170:171], v11 offset:25088
    v_mfma_f32_16x16x32_bf16 v[172:175], a[188:191], a[20:23], v[172:175]
    buffer_store_dwordx4 v[208:211], v44, s[24:27], s62 offen offset:1024 sc1
    ds_read_b64_tr_b16 a[172:173], v11 offset:36864
    v_exp_f32 v53, v53
    v_mfma_f32_16x16x32_bf16 v[168:171], a[188:191], a[16:19], v[168:171]
    s_waitcnt lgkmcnt(7)
    ds_read_b64_tr_b16 a[174:175], v11 offset:37376
    ds_read_b64_tr_b16 a[176:177], v8 offset:28672
    v_mfma_f32_16x16x32_bf16 v[112:115], a[144:147], a[24:27], v[112:115]
    v_exp_f32 v54, v54
    v_mfma_f32_16x16x32_bf16 v[116:119], a[144:147], a[28:31], v[116:119]
    buffer_load_dwordx4 v2, s[12:15], s60 offen offset:0 lds
    ds_read_b64_tr_b16 a[178:179], v8 offset:29184
    v_mfma_f32_16x16x32_bf16 v[124:127], a[148:151], a[28:31], v[124:127]
    ds_read_b64_tr_b16 a[180:181], v8 offset:40960
    v_exp_f32 v55, v55
    v_mfma_f32_16x16x32_bf16 v[120:123], a[148:151], a[24:27], v[120:123]
    s_lshl_b32 s62, s41, 10
    ds_read_b64_tr_b16 a[182:183], v8 offset:41472
    v_add_f32 v52, 1.0, v52
    v_mfma_f32_16x16x32_bf16 v[128:131], a[152:155], a[24:27], v[128:131]
    s_add_u32 s62, s62, s101
    ds_read_b64_tr_b16 a[184:185], v9 offset:28672
    buffer_load_dwordx4 v3, s[12:15], s60 offen offset:1024 lds
    v_mfma_f32_16x16x32_bf16 v[132:135], a[152:155], a[28:31], v[132:135]
    ds_read_b64_tr_b16 a[186:187], v9 offset:29184
    v_add_f32 v53, 1.0, v53
    v_mfma_f32_16x16x32_bf16 v[140:143], a[156:159], a[28:31], v[140:143]
    ds_read_b64_tr_b16 a[188:189], v9 offset:40960
    v_mfma_f32_16x16x32_bf16 v[136:139], a[156:159], a[24:27], v[136:139]
    s_waitcnt lgkmcnt(7)
    ds_read_b64_tr_b16 a[190:191], v9 offset:41472
    v_add_f32 v54, 1.0, v54
    v_mfma_f32_16x16x32_bf16 v[144:147], a[160:163], a[24:27], v[144:147]
    ds_read_b64_tr_b16 a[144:145], v10 offset:28672
    v_add_f32 v55, 1.0, v55
    v_mfma_f32_16x16x32_bf16 v[148:151], a[160:163], a[28:31], v[148:151]
    buffer_store_dwordx4 v[208:211], v44, s[24:27], s62 offen offset:0 sc1
    buffer_load_dwordx4 v4, s[12:15], s60 offen offset:2048 lds
    ds_read_b64_tr_b16 a[146:147], v10 offset:29184
    v_mfma_f32_16x16x32_bf16 v[156:159], a[164:167], a[28:31], v[156:159]
    v_rcp_f32 v55, v55
    v_mfma_f32_16x16x32_bf16 v[152:155], a[164:167], a[24:27], v[152:155]
    ds_read_b64_tr_b16 a[148:149], v10 offset:40960
    buffer_store_dwordx4 v[208:211], v44, s[24:27], s62 offen offset:1024 sc1
    ds_read_b64_tr_b16 a[150:151], v10 offset:41472
    v_rcp_f32 v52, v52
    v_mfma_f32_16x16x32_bf16 v[160:163], a[168:171], a[24:27], v[160:163]
    v_rcp_f32 v53, v53
    v_mfma_f32_16x16x32_bf16 v[164:167], a[168:171], a[28:31], v[164:167]
    ds_read_b64_tr_b16 a[152:153], v11 offset:28672
    ds_read_b64_tr_b16 a[154:155], v11 offset:29184
    v_mfma_f32_16x16x32_bf16 v[172:175], a[172:175], a[28:31], v[172:175]
    ds_read_b64_tr_b16 a[156:157], v11 offset:40960
    v_rcp_f32 v54, v54
    v_mfma_f32_16x16x32_bf16 v[168:171], a[172:175], a[24:27], v[168:171]
    s_waitcnt lgkmcnt(7)
    ds_read_b64_tr_b16 a[158:159], v11 offset:41472
    ds_read_b64_tr_b16 a[160:161], v8 offset:32768
    v_mfma_f32_16x16x32_bf16 v[112:115], a[176:179], a[32:35], v[112:115]
    s_waitcnt vmcnt(14)
    s_barrier
    v_mfma_f32_16x16x32_bf16 v[116:119], a[176:179], a[36:39], v[116:119]
    ds_read_b64_tr_b16 a[162:163], v8 offset:33280
    v_mul_f32 v60, v60, v52
    v_mfma_f32_16x16x32_bf16 v[124:127], a[180:183], a[36:39], v[124:127]
    s_add_u32 s60, s58, 0x360100
    ds_read_b64_tr_b16 a[164:165], v8 offset:45056
    v_mul_f32 v61, v61, v53
    v_cvt_pk_bf16_f32 v196, v60, v61
    v_mfma_f32_16x16x32_bf16 v[120:123], a[180:183], a[32:35], v[120:123]
    ds_read_b64_tr_b16 a[166:167], v8 offset:45568
    v_mul_f32 v63, v63, v55
    v_mfma_f32_16x16x32_bf16 v[128:131], a[184:187], a[32:35], v[128:131]
    ds_read_b64_tr_b16 a[168:169], v9 offset:32768
    v_mul_f32 v62, v62, v54
    v_mfma_f32_16x16x32_bf16 v[132:135], a[184:187], a[36:39], v[132:135]
    ds_read_b64_tr_b16 a[170:171], v9 offset:33280
    v_cvt_pk_bf16_f32 v197, v62, v63
    v_mfma_f32_16x16x32_bf16 v[140:143], a[188:191], a[36:39], v[140:143]
    ds_read_b64_tr_b16 a[172:173], v9 offset:45056
    v_exp_f32 v64, v64
    v_mfma_f32_16x16x32_bf16 v[136:139], a[188:191], a[32:35], v[136:139]
    s_waitcnt lgkmcnt(7)
    ds_read_b64_tr_b16 a[174:175], v9 offset:45568
    ds_read_b64_tr_b16 a[176:177], v10 offset:32768
    v_mfma_f32_16x16x32_bf16 v[144:147], a[144:147], a[32:35], v[144:147]
    v_exp_f32 v65, v65
    v_mfma_f32_16x16x32_bf16 v[148:151], a[144:147], a[36:39], v[148:151]
    s_add_u32 m0, s61, 0x0
    v_exp_f32 v66, v66
    v_mfma_f32_16x16x32_bf16 v[156:159], a[148:151], a[36:39], v[156:159]
    ds_read_b64_tr_b16 a[178:179], v10 offset:33280
    ds_read_b64_tr_b16 a[180:181], v10 offset:45056
    v_mfma_f32_16x16x32_bf16 v[152:155], a[148:151], a[32:35], v[152:155]
    ds_read_b64_tr_b16 a[182:183], v10 offset:45568
    buffer_load_dwordx4 v2, s[8:11], s60 offen offset:0 lds
    v_mfma_f32_16x16x32_bf16 v[160:163], a[152:155], a[32:35], v[160:163]
    ds_read_b64_tr_b16 a[184:185], v11 offset:32768
    v_exp_f32 v67, v67
    v_mfma_f32_16x16x32_bf16 v[164:167], a[152:155], a[36:39], v[164:167]
    ds_read_b64_tr_b16 a[186:187], v11 offset:33280
    v_add_f32 v65, 1.0, v65
    v_mfma_f32_16x16x32_bf16 v[172:175], a[156:159], a[36:39], v[172:175]
    ds_read_b64_tr_b16 a[188:189], v11 offset:45056
    v_add_f32 v66, 1.0, v66
    v_mfma_f32_16x16x32_bf16 v[168:171], a[156:159], a[32:35], v[168:171]
    s_waitcnt lgkmcnt(7)
    ds_read_b64_tr_b16 a[190:191], v11 offset:45568
    buffer_load_dwordx4 v3, s[8:11], s60 offen offset:1024 lds
    ds_read_b64_tr_b16 a[144:145], v12 offset:0
    v_mfma_f32_16x16x32_bf16 v[112:115], a[160:163], a[40:43], v[112:115]
    ds_read_b64_tr_b16 a[146:147], v12 offset:512
    v_add_f32 v64, 1.0, v64
    v_mfma_f32_16x16x32_bf16 v[116:119], a[160:163], a[44:47], v[116:119]
    v_rcp_f32 v64, v64
    v_mfma_f32_16x16x32_bf16 v[124:127], a[164:167], a[44:47], v[124:127]
    ds_read_b64_tr_b16 a[148:149], v12 offset:12288
    v_rcp_f32 v65, v65
    v_mfma_f32_16x16x32_bf16 v[120:123], a[164:167], a[40:43], v[120:123]
    ds_read_b64_tr_b16 a[150:151], v12 offset:12800
    v_add_f32 v67, 1.0, v67
    v_mfma_f32_16x16x32_bf16 v[128:131], a[168:171], a[40:43], v[128:131]
    ds_read_b64_tr_b16 a[152:153], v13 offset:0
    v_rcp_f32 v66, v66
    v_mfma_f32_16x16x32_bf16 v[132:135], a[168:171], a[44:47], v[132:135]
    ds_read_b64_tr_b16 a[154:155], v13 offset:512
    buffer_load_dwordx4 v4, s[8:11], s60 offen offset:2048 lds
    ds_read_b64_tr_b16 a[156:157], v13 offset:12288
    v_mfma_f32_16x16x32_bf16 v[140:143], a[172:175], a[44:47], v[140:143]
    v_rcp_f32 v67, v67
    v_mfma_f32_16x16x32_bf16 v[136:139], a[172:175], a[40:43], v[136:139]
    s_waitcnt lgkmcnt(7)
    ds_read_b64_tr_b16 a[158:159], v13 offset:12800
    v_mul_f32 v72, v72, v64
    v_mfma_f32_16x16x32_bf16 v[144:147], a[176:179], a[40:43], v[144:147]
    ds_read_b64_tr_b16 a[160:161], v14 offset:0
    v_mul_f32 v73, v73, v65
    v_mfma_f32_16x16x32_bf16 v[148:151], a[176:179], a[44:47], v[148:151]
    ds_read_b64_tr_b16 a[162:163], v14 offset:512
    v_mul_f32 v74, v74, v66
    v_mfma_f32_16x16x32_bf16 v[156:159], a[180:183], a[44:47], v[156:159]
    ds_read_b64_tr_b16 a[164:165], v14 offset:12288
    v_cvt_pk_bf16_f32 v194, v72, v73
    v_mfma_f32_16x16x32_bf16 v[152:155], a[180:183], a[40:43], v[152:155]
    v_mul_f32 v75, v75, v67
    v_cvt_pk_bf16_f32 v195, v74, v75
    v_mfma_f32_16x16x32_bf16 v[160:163], a[184:187], a[40:43], v[160:163]
    s_add_u32 m0, s61, 0x3000
    ds_read_b64_tr_b16 a[166:167], v14 offset:12800
    ds_read_b64_tr_b16 a[168:169], v15 offset:0
    v_mfma_f32_16x16x32_bf16 v[164:167], a[184:187], a[44:47], v[164:167]
    ds_read_b64_tr_b16 a[170:171], v15 offset:512
    v_mfma_f32_16x16x32_bf16 v[172:175], a[188:191], a[44:47], v[172:175]
    buffer_store_dwordx4 v[192:195], v40, s[24:27], s80 offen offset:0 sc1
    ds_read_b64_tr_b16 a[172:173], v15 offset:12288
    v_exp_f32 v68, v68
    v_mfma_f32_16x16x32_bf16 v[168:171], a[188:191], a[40:43], v[168:171]
    s_waitcnt lgkmcnt(7)
    ds_read_b64_tr_b16 a[174:175], v15 offset:12800
    ds_read_b64_tr_b16 a[176:177], v12 offset:4096
    v_mfma_f32_16x16x32_bf16 v[112:115], a[144:147], a[48:51], v[112:115]
    ds_read_b64_tr_b16 a[178:179], v12 offset:4608
    v_exp_f32 v69, v69
    v_mfma_f32_16x16x32_bf16 v[116:119], a[144:147], a[52:55], v[116:119]
    buffer_load_dwordx4 v2, s[12:15], s60 offen offset:0 lds
    v_mfma_f32_16x16x32_bf16 v[124:127], a[148:151], a[52:55], v[124:127]
    v_exp_f32 v70, v70
    v_mfma_f32_16x16x32_bf16 v[120:123], a[148:151], a[48:51], v[120:123]
    ds_read_b64_tr_b16 a[180:181], v12 offset:16384
    v_exp_f32 v71, v71
    v_mfma_f32_16x16x32_bf16 v[128:131], a[152:155], a[48:51], v[128:131]
    ds_read_b64_tr_b16 a[182:183], v12 offset:16896
    buffer_load_dwordx4 v3, s[12:15], s60 offen offset:1024 lds
    ds_read_b64_tr_b16 a[184:185], v13 offset:4096
    v_mfma_f32_16x16x32_bf16 v[132:135], a[152:155], a[52:55], v[132:135]
    ds_read_b64_tr_b16 a[186:187], v13 offset:4608
    v_add_f32 v68, 1.0, v68
    v_mfma_f32_16x16x32_bf16 v[140:143], a[156:159], a[52:55], v[140:143]
    ds_read_b64_tr_b16 a[188:189], v13 offset:16384
    v_add_f32 v69, 1.0, v69
    v_mfma_f32_16x16x32_bf16 v[136:139], a[156:159], a[48:51], v[136:139]
    s_waitcnt lgkmcnt(7)
    ds_read_b64_tr_b16 a[190:191], v13 offset:16896
    v_add_f32 v70, 1.0, v70
    v_mfma_f32_16x16x32_bf16 v[144:147], a[160:163], a[48:51], v[144:147]
    ds_read_b64_tr_b16 a[144:145], v14 offset:4096
    v_add_f32 v71, 1.0, v71
    v_mfma_f32_16x16x32_bf16 v[148:151], a[160:163], a[52:55], v[148:151]
    buffer_load_dwordx4 v4, s[12:15], s60 offen offset:2048 lds
    ds_read_b64_tr_b16 a[146:147], v14 offset:4608
    v_mfma_f32_16x16x32_bf16 v[156:159], a[164:167], a[52:55], v[156:159]
    ds_read_b64_tr_b16 a[148:149], v14 offset:16384
    v_rcp_f32 v68, v68
    v_mfma_f32_16x16x32_bf16 v[152:155], a[164:167], a[48:51], v[152:155]
    v_rcp_f32 v69, v69
    v_mfma_f32_16x16x32_bf16 v[160:163], a[168:171], a[48:51], v[160:163]
    ds_read_b64_tr_b16 a[150:151], v14 offset:16896
    ds_read_b64_tr_b16 a[152:153], v15 offset:4096
    v_mfma_f32_16x16x32_bf16 v[164:167], a[168:171], a[52:55], v[164:167]
    ds_read_b64_tr_b16 a[154:155], v15 offset:4608
    v_rcp_f32 v70, v70
    v_mfma_f32_16x16x32_bf16 v[172:175], a[172:175], a[52:55], v[172:175]
    ds_read_b64_tr_b16 a[156:157], v15 offset:16384
    v_rcp_f32 v71, v71
    v_mfma_f32_16x16x32_bf16 v[168:171], a[172:175], a[48:51], v[168:171]
    s_waitcnt lgkmcnt(7)
    ds_read_b64_tr_b16 a[158:159], v15 offset:16896
    v_mul_f32 v76, v76, v68
    v_mfma_f32_16x16x32_bf16 v[112:115], a[176:179], a[56:59], v[112:115]
    s_waitcnt vmcnt(8)
    ds_read_b64_tr_b16 a[160:161], v12 offset:8192
    s_barrier
    v_mfma_f32_16x16x32_bf16 v[116:119], a[176:179], a[60:63], v[116:119]
    ds_read_b64_tr_b16 a[162:163], v12 offset:8704
    v_mul_f32 v78, v78, v70
    v_mfma_f32_16x16x32_bf16 v[124:127], a[180:183], a[60:63], v[124:127]
    s_add_u32 s60, s58, 0x438100
    ds_read_b64_tr_b16 a[164:165], v12 offset:20480
    v_mul_f32 v79, v79, v71
    v_mfma_f32_16x16x32_bf16 v[120:123], a[180:183], a[56:59], v[120:123]
    ds_read_b64_tr_b16 a[166:167], v12 offset:20992
    v_mul_f32 v77, v77, v69
    v_mfma_f32_16x16x32_bf16 v[128:131], a[184:187], a[56:59], v[128:131]
    s_add_u32 m0, s61, 0x6000
    ds_read_b64_tr_b16 a[168:169], v13 offset:8192
    v_cvt_pk_bf16_f32 v199, v78, v79
    v_mfma_f32_16x16x32_bf16 v[132:135], a[184:187], a[60:63], v[132:135]
    ds_read_b64_tr_b16 a[170:171], v13 offset:8704
    ds_read_b64_tr_b16 a[172:173], v13 offset:20480
    v_mfma_f32_16x16x32_bf16 v[140:143], a[188:191], a[60:63], v[140:143]
    ds_read_b64_tr_b16 a[174:175], v13 offset:20992
    v_cvt_pk_bf16_f32 v198, v76, v77
    v_mfma_f32_16x16x32_bf16 v[136:139], a[188:191], a[56:59], v[136:139]
    buffer_store_dwordx4 v[196:199], v40, s[24:27], s80 offen offset:1024 sc1
    buffer_load_dwordx4 v2, s[8:11], s60 offen offset:0 lds
    s_waitcnt lgkmcnt(8)
    v_mfma_f32_16x16x32_bf16 v[144:147], a[144:147], a[56:59], v[144:147]
    ds_read_b64_tr_b16 a[176:177], v14 offset:8192
    v_exp_f32 v80, v80
    v_mfma_f32_16x16x32_bf16 v[148:151], a[144:147], a[60:63], v[148:151]
    buffer_load_dwordx4 v3, s[8:11], s60 offen offset:1024 lds
    ds_read_b64_tr_b16 a[178:179], v14 offset:8704
    v_mfma_f32_16x16x32_bf16 v[156:159], a[148:151], a[60:63], v[156:159]
    v_exp_f32 v81, v81
    v_mfma_f32_16x16x32_bf16 v[152:155], a[148:151], a[56:59], v[152:155]
    ds_read_b64_tr_b16 a[180:181], v14 offset:20480
    ds_read_b64_tr_b16 a[182:183], v14 offset:20992
    v_mfma_f32_16x16x32_bf16 v[160:163], a[152:155], a[56:59], v[160:163]
    buffer_load_dwordx4 v4, s[8:11], s60 offen offset:2048 lds
    v_mfma_f32_16x16x32_bf16 v[164:167], a[152:155], a[60:63], v[164:167]
    ds_read_b64_tr_b16 a[184:185], v15 offset:8192
    ds_read_b64_tr_b16 a[186:187], v15 offset:8704
    v_mfma_f32_16x16x32_bf16 v[172:175], a[156:159], a[60:63], v[172:175]
    s_add_u32 m0, s61, 0x9000
    ds_read_b64_tr_b16 a[188:189], v15 offset:20480
    v_mfma_f32_16x16x32_bf16 v[168:171], a[156:159], a[56:59], v[168:171]
    s_waitcnt lgkmcnt(7)
    ds_read_b64_tr_b16 a[190:191], v15 offset:20992
    ds_read_b64_tr_b16 a[144:145], v12 offset:24576
    v_mfma_f32_16x16x32_bf16 v[112:115], a[160:163], a[64:67], v[112:115]
    v_add_f32 v80, 1.0, v80
    v_cmp_ne_u32 vcc, v46, v43
    v_exp_f32 v82, v82
    v_exp_f32 v83, v83
    v_add_f32 v81, 1.0, v81
    v_add_f32 v82, 1.0, v82
    v_mfma_f32_16x16x32_bf16 v[116:119], a[160:163], a[68:71], v[116:119]
    s_cbranch_vccnz SLOW1
BACK1:
    ds_read_b64_tr_b16 a[146:147], v12 offset:25088
    v_cmp_ne_u32 vcc, v240, v43
    buffer_load_dwordx4 v2, s[12:15], s60 offen offset:0 lds
    ds_read_b64_tr_b16 a[148:149], v12 offset:36864
    v_mfma_f32_16x16x32_bf16 v[124:127], a[164:167], a[68:71], v[124:127]
    s_cbranch_vccnz SLOW2
BACK2:
    v_mfma_f32_16x16x32_bf16 v[120:123], a[164:167], a[64:67], v[120:123]
    ds_read_b64_tr_b16 a[150:151], v12 offset:37376
    v_add_f32 v83, 1.0, v83
    v_mfma_f32_16x16x32_bf16 v[128:131], a[168:171], a[64:67], v[128:131]
    ds_read_b64_tr_b16 a[152:153], v13 offset:24576
    buffer_load_dwordx4 v3, s[12:15], s60 offen offset:1024 lds
    v_mfma_f32_16x16x32_bf16 v[132:135], a[168:171], a[68:71], v[132:135]
    ds_read_b64_tr_b16 a[154:155], v13 offset:25088
    v_lshlrev_b32 v240, 4, v1
    v_mfma_f32_16x16x32_bf16 v[140:143], a[172:175], a[68:71], v[140:143]
    buffer_load_dwordx4 v4, s[12:15], s60 offen offset:2048 lds
    ds_read_b64_tr_b16 a[156:157], v13 offset:36864
    v_mfma_f32_16x16x32_bf16 v[136:139], a[172:175], a[64:67], v[136:139]
    s_waitcnt lgkmcnt(7)
    ds_read_b64_tr_b16 a[158:159], v13 offset:37376
    v_rcp_f32 v80, v80
    v_mfma_f32_16x16x32_bf16 v[144:147], a[176:179], a[64:67], v[144:147]
    ds_read_b64_tr_b16 a[160:161], v14 offset:24576
    v_rcp_f32 v81, v81
    v_mfma_f32_16x16x32_bf16 v[148:151], a[176:179], a[68:71], v[148:151]
    s_mov_b32 s62, 0
    s_add_u32 m0, s63, 3072
    ds_read_b64_tr_b16 a[162:163], v14 offset:25088
    v_mfma_f32_16x16x32_bf16 v[156:159], a[180:183], a[68:71], v[156:159]
    ds_read_b64_tr_b16 a[164:165], v14 offset:36864
    v_rcp_f32 v82, v82
    v_mfma_f32_16x16x32_bf16 v[152:155], a[180:183], a[64:67], v[152:155]
    buffer_load_dwordx4 v247, s[24:27], s62 offen sc1 lds
    v_mfma_f32_16x16x32_bf16 v[160:163], a[184:187], a[64:67], v[160:163]
    s_add_u32 m0, s63, 4096
    ds_read_b64_tr_b16 a[166:167], v14 offset:37376
    ds_read_b64_tr_b16 a[168:169], v15 offset:24576
    v_mfma_f32_16x16x32_bf16 v[164:167], a[184:187], a[68:71], v[164:167]
    s_mov_b32 s62, 589824
    ds_read_b64_tr_b16 a[170:171], v15 offset:25088
    v_rcp_f32 v83, v83
    v_mfma_f32_16x16x32_bf16 v[172:175], a[188:191], a[68:71], v[172:175]
    ds_read_b64_tr_b16 a[172:173], v15 offset:36864
    v_mul_f32 v88, v88, v80
    v_mfma_f32_16x16x32_bf16 v[168:171], a[188:191], a[64:67], v[168:171]
    s_waitcnt lgkmcnt(7)
    ds_read_b64_tr_b16 a[174:175], v15 offset:37376
    v_mul_f32 v89, v89, v81
    v_mul_f32 v91, v91, v83
    v_mfma_f32_16x16x32_bf16 v[112:115], a[144:147], a[72:75], v[112:115]
    ds_read_b64_tr_b16 a[176:177], v12 offset:28672
    v_mul_f32 v90, v90, v82
    v_mfma_f32_16x16x32_bf16 v[116:119], a[144:147], a[76:79], v[116:119]
    ds_read_b64_tr_b16 a[178:179], v12 offset:29184
    buffer_load_dwordx4 v247, s[24:27], s62 offen sc1 lds
    v_mfma_f32_16x16x32_bf16 v[124:127], a[148:151], a[76:79], v[124:127]
    ds_read_b64_tr_b16 a[180:181], v12 offset:40960
    v_cvt_pk_bf16_f32 v200, v88, v89
    v_mfma_f32_16x16x32_bf16 v[120:123], a[148:151], a[72:75], v[120:123]
    ds_read_b64_tr_b16 a[182:183], v12 offset:41472
    s_add_u32 m0, s63, 5120
    v_mfma_f32_16x16x32_bf16 v[128:131], a[152:155], a[72:75], v[128:131]
    ds_read_b64_tr_b16 a[184:185], v13 offset:28672
    v_cvt_pk_bf16_f32 v201, v90, v91
    v_mfma_f32_16x16x32_bf16 v[132:135], a[152:155], a[76:79], v[132:135]
    ds_read_b64_tr_b16 a[186:187], v13 offset:29184
    v_exp_f32 v84, v84
    v_mfma_f32_16x16x32_bf16 v[140:143], a[156:159], a[76:79], v[140:143]
    s_mov_b32 s62, 1179648
    ds_read_b64_tr_b16 a[188:189], v13 offset:40960
    buffer_load_dwordx4 v247, s[24:27], s62 offen sc1 lds
    v_mfma_f32_16x16x32_bf16 v[136:139], a[156:159], a[72:75], v[136:139]
    s_waitcnt lgkmcnt(7)
    ds_read_b64_tr_b16 a[190:191], v13 offset:41472
    v_add_f32 v84, 1.0, v84
    v_mfma_f32_16x16x32_bf16 v[144:147], a[160:163], a[72:75], v[144:147]
    s_add_u32 m0, s63, 6144
    ds_read_b64_tr_b16 a[144:145], v14 offset:28672
    ds_read_b64_tr_b16 a[146:147], v14 offset:29184
    v_mfma_f32_16x16x32_bf16 v[148:151], a[160:163], a[76:79], v[148:151]
    v_exp_f32 v86, v86
    v_mfma_f32_16x16x32_bf16 v[156:159], a[164:167], a[76:79], v[156:159]
    ds_read_b64_tr_b16 a[148:149], v14 offset:40960
    v_exp_f32 v85, v85
    v_mfma_f32_16x16x32_bf16 v[152:155], a[164:167], a[72:75], v[152:155]
    s_mov_b32 s62, 1769472
    ds_read_b64_tr_b16 a[150:151], v14 offset:41472
    buffer_load_dwordx4 v247, s[24:27], s62 offen sc1 lds
    ds_read_b64_tr_b16 a[152:153], v15 offset:28672
    v_mfma_f32_16x16x32_bf16 v[160:163], a[168:171], a[72:75], v[160:163]
    v_exp_f32 v87, v87
    v_mfma_f32_16x16x32_bf16 v[164:167], a[168:171], a[76:79], v[164:167]
    ds_read_b64_tr_b16 a[154:155], v15 offset:29184
    v_add_f32 v85, 1.0, v85
    v_mfma_f32_16x16x32_bf16 v[172:175], a[172:175], a[76:79], v[172:175]
    ds_read_b64_tr_b16 a[156:157], v15 offset:40960
    v_add_f32 v86, 1.0, v86
    v_mfma_f32_16x16x32_bf16 v[168:171], a[172:175], a[72:75], v[168:171]
    s_waitcnt lgkmcnt(7)
    ds_read_b64_tr_b16 a[158:159], v15 offset:41472
    v_add_f32 v87, 1.0, v87
    v_mfma_f32_16x16x32_bf16 v[112:115], a[176:179], a[80:83], v[112:115]
    s_waitcnt vmcnt(11)
    ds_read_b64_tr_b16 a[160:161], v12 offset:32768
    s_barrier
    v_mfma_f32_16x16x32_bf16 v[116:119], a[176:179], a[84:87], v[116:119]
    ds_read_b64_tr_b16 a[162:163], v12 offset:33280
    v_rcp_f32 v84, v84
    v_mfma_f32_16x16x32_bf16 v[124:127], a[180:183], a[84:87], v[124:127]
    s_mov_b32 m0, s63
    ds_read_b64_tr_b16 a[164:165], v12 offset:45056
    ds_read_b64_tr_b16 a[166:167], v12 offset:45568
    v_mfma_f32_16x16x32_bf16 v[120:123], a[180:183], a[80:83], v[120:123]
    v_rcp_f32 v85, v85
    v_mfma_f32_16x16x32_bf16 v[128:131], a[184:187], a[80:83], v[128:131]
    ds_read_b64_tr_b16 a[168:169], v13 offset:32768
    v_rcp_f32 v86, v86
    v_mfma_f32_16x16x32_bf16 v[132:135], a[184:187], a[84:87], v[132:135]
    buffer_load_dwordx4 v240, s[24:27], s45 offen offset:0 sc1 lds
    v_mfma_f32_16x16x32_bf16 v[140:143], a[188:191], a[84:87], v[140:143]
    ds_read_b64_tr_b16 a[170:171], v13 offset:33280
    ds_read_b64_tr_b16 a[172:173], v13 offset:45056
    v_mfma_f32_16x16x32_bf16 v[136:139], a[188:191], a[80:83], v[136:139]
    s_waitcnt lgkmcnt(7)
    ds_read_b64_tr_b16 a[174:175], v13 offset:45568
    v_mul_f32 v92, v92, v84
    v_mfma_f32_16x16x32_bf16 v[144:147], a[144:147], a[80:83], v[144:147]
    ds_read_b64_tr_b16 a[176:177], v14 offset:32768
    buffer_load_dwordx4 v240, s[24:27], s45 offen offset:1024 sc1 lds
    ds_read_b64_tr_b16 a[178:179], v14 offset:33280
    v_mfma_f32_16x16x32_bf16 v[148:151], a[144:147], a[84:87], v[148:151]
    v_rcp_f32 v87, v87
    v_mfma_f32_16x16x32_bf16 v[156:159], a[148:151], a[84:87], v[156:159]
    ds_read_b64_tr_b16 a[180:181], v14 offset:45056
    v_mul_f32 v94, v94, v86
    v_mfma_f32_16x16x32_bf16 v[152:155], a[148:151], a[80:83], v[152:155]
    s_add_u32 s60, s58, 0x180
    ds_read_b64_tr_b16 a[182:183], v14 offset:45568
    v_mul_f32 v95, v95, v87
    v_mfma_f32_16x16x32_bf16 v[160:163], a[152:155], a[80:83], v[160:163]
    ds_read_b64_tr_b16 a[184:185], v15 offset:32768
    v_mul_f32 v93, v93, v85
    v_mfma_f32_16x16x32_bf16 v[164:167], a[152:155], a[84:87], v[164:167]
    ds_read_b64_tr_b16 a[186:187], v15 offset:33280
    v_cvt_pk_bf16_f32 v205, v94, v95
    v_mfma_f32_16x16x32_bf16 v[172:175], a[156:159], a[84:87], v[172:175]
    ds_read_b64_tr_b16 a[188:189], v15 offset:45056
    v_exp_f32 v96, v96
    v_mfma_f32_16x16x32_bf16 v[168:171], a[156:159], a[80:83], v[168:171]
    s_waitcnt lgkmcnt(7)
    ds_read_b64_tr_b16 a[190:191], v15 offset:45568
    buffer_load_dwordx4 v240, s[24:27], s45 offen offset:2048 sc1 lds
    ds_read_b64_tr_b16 a[144:145], v8 offset:0
    v_mfma_f32_16x16x32_bf16 v[112:115], a[160:163], a[88:91], v[112:115]
    v_exp_f32 v97, v97
    v_mfma_f32_16x16x32_bf16 v[116:119], a[160:163], a[92:95], v[116:119]
    ds_read_b64_tr_b16 a[146:147], v8 offset:512
    v_cvt_pk_bf16_f32 v204, v92, v93
    v_mfma_f32_16x16x32_bf16 v[124:127], a[164:167], a[92:95], v[124:127]
    ds_read_b64_tr_b16 a[148:149], v8 offset:12288
    v_exp_f32 v98, v98
    v_mfma_f32_16x16x32_bf16 v[120:123], a[164:167], a[88:91], v[120:123]
    s_add_u32 m0, s61, 0xc000
    ds_read_b64_tr_b16 a[150:151], v8 offset:12800
    v_exp_f32 v99, v99
    v_mfma_f32_16x16x32_bf16 v[128:131], a[168:171], a[88:91], v[128:131]
    ds_read_b64_tr_b16 a[152:153], v9 offset:0
    v_add_f32 v96, 1.0, v96
    v_mfma_f32_16x16x32_bf16 v[132:135], a[168:171], a[92:95], v[132:135]
    ds_read_b64_tr_b16 a[154:155], v9 offset:512
    v_add_f32 v97, 1.0, v97
    v_mfma_f32_16x16x32_bf16 v[140:143], a[172:175], a[92:95], v[140:143]
    ds_read_b64_tr_b16 a[156:157], v9 offset:12288
    buffer_load_dwordx4 v2, s[8:11], s60 offen offset:0 lds
    v_mfma_f32_16x16x32_bf16 v[136:139], a[172:175], a[88:91], v[136:139]
    s_waitcnt lgkmcnt(7)
    ds_read_b64_tr_b16 a[158:159], v9 offset:12800
    v_add_f32 v98, 1.0, v98
    v_mfma_f32_16x16x32_bf16 v[144:147], a[176:179], a[88:91], v[144:147]
    ds_read_b64_tr_b16 a[160:161], v10 offset:0
    v_add_f32 v99, 1.0, v99
    v_mfma_f32_16x16x32_bf16 v[148:151], a[176:179], a[92:95], v[148:151]
    buffer_load_dwordx4 v3, s[8:11], s60 offen offset:1024 lds
    ds_read_b64_tr_b16 a[162:163], v10 offset:512
    v_mfma_f32_16x16x32_bf16 v[156:159], a[180:183], a[92:95], v[156:159]
    ds_read_b64_tr_b16 a[164:165], v10 offset:12288
    v_rcp_f32 v96, v96
    v_mfma_f32_16x16x32_bf16 v[152:155], a[180:183], a[88:91], v[152:155]
    ds_read_b64_tr_b16 a[166:167], v10 offset:12800
    v_rcp_f32 v97, v97
    v_mfma_f32_16x16x32_bf16 v[160:163], a[184:187], a[88:91], v[160:163]
    v_rcp_f32 v98, v98
    v_mfma_f32_16x16x32_bf16 v[164:167], a[184:187], a[92:95], v[164:167]
    ds_read_b64_tr_b16 a[168:169], v11 offset:0
    buffer_load_dwordx4 v4, s[8:11], s60 offen offset:2048 lds
    v_mfma_f32_16x16x32_bf16 v[172:175], a[188:191], a[92:95], v[172:175]
    ds_read_b64_tr_b16 a[170:171], v11 offset:512
    ds_read_b64_tr_b16 a[172:173], v11 offset:12288
    v_mfma_f32_16x16x32_bf16 v[168:171], a[188:191], a[88:91], v[168:171]
    s_waitcnt lgkmcnt(7)
    ds_read_b64_tr_b16 a[174:175], v11 offset:12800
    v_rcp_f32 v99, v99
    v_mfma_f32_16x16x32_bf16 v[112:115], a[144:147], a[96:99], v[112:115]
    ds_read_b64_tr_b16 a[176:177], v8 offset:4096
    v_mul_f32 v104, v104, v96
    v_mfma_f32_16x16x32_bf16 v[116:119], a[144:147], a[100:103], v[116:119]
    s_add_u32 m0, s61, 0xf000
    ds_read_b64_tr_b16 a[178:179], v8 offset:4608
    v_mul_f32 v105, v105, v97
    v_mfma_f32_16x16x32_bf16 v[124:127], a[148:151], a[100:103], v[124:127]
    ds_read_b64_tr_b16 a[180:181], v8 offset:16384
    v_mul_f32 v107, v107, v99
    v_mfma_f32_16x16x32_bf16 v[120:123], a[148:151], a[96:99], v[120:123]
    ds_read_b64_tr_b16 a[182:183], v8 offset:16896
    buffer_load_dwordx4 v2, s[12:15], s60 offen offset:0 lds
    ds_read_b64_tr_b16 a[184:185], v9 offset:4096
    v_mfma_f32_16x16x32_bf16 v[128:131], a[152:155], a[96:99], v[128:131]
    v_cvt_pk_bf16_f32 v202, v104, v105
    v_mul_f32 v106, v106, v98
    v_mfma_f32_16x16x32_bf16 v[132:135], a[152:155], a[100:103], v[132:135]
    ds_read_b64_tr_b16 a[186:187], v9 offset:4608
    v_cvt_pk_bf16_f32 v203, v106, v107
    v_mfma_f32_16x16x32_bf16 v[140:143], a[156:159], a[100:103], v[140:143]
    ds_read_b64_tr_b16 a[188:189], v9 offset:16384
    ds_read_b64_tr_b16 a[190:191], v9 offset:16896
    v_mfma_f32_16x16x32_bf16 v[136:139], a[156:159], a[96:99], v[136:139]
    buffer_store_dwordx4 v[200:203], v40, s[24:27], s80 offen offset:2048 sc1
    buffer_load_dwordx4 v3, s[12:15], s60 offen offset:1024 lds
    s_waitcnt lgkmcnt(8)
    v_mfma_f32_16x16x32_bf16 v[144:147], a[160:163], a[96:99], v[144:147]
    ds_read_b64_tr_b16 a[144:145], v10 offset:4096
    ds_read_b64_tr_b16 a[146:147], v10 offset:4608
    v_mfma_f32_16x16x32_bf16 v[148:151], a[160:163], a[100:103], v[148:151]
    v_exp_f32 v100, v100
    v_mfma_f32_16x16x32_bf16 v[156:159], a[164:167], a[100:103], v[156:159]
    buffer_load_dwordx4 v4, s[12:15], s60 offen offset:2048 lds
    v_mfma_f32_16x16x32_bf16 v[152:155], a[164:167], a[96:99], v[152:155]
    ds_read_b64_tr_b16 a[148:149], v10 offset:16384
    v_exp_f32 v101, v101
    v_mfma_f32_16x16x32_bf16 v[160:163], a[168:171], a[96:99], v[160:163]
    ds_read_b64_tr_b16 a[150:151], v10 offset:16896
    ds_read_b64_tr_b16 a[152:153], v11 offset:4096
    v_mfma_f32_16x16x32_bf16 v[164:167], a[168:171], a[100:103], v[164:167]
    ds_read_b64_tr_b16 a[154:155], v11 offset:4608
    v_exp_f32 v102, v102
    v_mfma_f32_16x16x32_bf16 v[172:175], a[172:175], a[100:103], v[172:175]
    ds_read_b64_tr_b16 a[156:157], v11 offset:16384
    v_exp_f32 v103, v103
    v_mfma_f32_16x16x32_bf16 v[168:171], a[172:175], a[96:99], v[168:171]
    s_waitcnt lgkmcnt(7)
    ds_read_b64_tr_b16 a[158:159], v11 offset:16896
    v_add_f32 v100, 1.0, v100
    v_mfma_f32_16x16x32_bf16 v[112:115], a[176:179], a[104:107], v[112:115]
    s_waitcnt vmcnt(14)
    ds_read_b64_tr_b16 a[160:161], v8 offset:8192
    s_barrier
    v_mfma_f32_16x16x32_bf16 v[116:119], a[176:179], a[108:111], v[116:119]
    ds_read_b64_tr_b16 a[162:163], v8 offset:8704
    v_add_f32 v101, 1.0, v101
    v_mfma_f32_16x16x32_bf16 v[124:127], a[180:183], a[108:111], v[124:127]
    s_add_u32 s60, s58, 0xd8180
    ds_read_b64_tr_b16 a[164:165], v8 offset:20480
    v_add_f32 v102, 1.0, v102
    v_mfma_f32_16x16x32_bf16 v[120:123], a[180:183], a[104:107], v[120:123]
    s_mul_i32 s56, s51, 1152
    ds_read_b64_tr_b16 a[166:167], v8 offset:20992
    v_add_f32 v103, 1.0, v103
    v_mfma_f32_16x16x32_bf16 v[128:131], a[184:187], a[104:107], v[128:131]
    s_lshl2_add_u32 s55, s52, s50
    ds_read_b64_tr_b16 a[168:169], v9 offset:8192
    v_rcp_f32 v100, v100
    v_mfma_f32_16x16x32_bf16 v[132:135], a[184:187], a[108:111], v[132:135]
    s_mul_i32 s57, s55, 73728
    s_add_u32 s57, s57, s56
    ds_read_b64_tr_b16 a[170:171], v9 offset:8704
    v_mfma_f32_16x16x32_bf16 v[140:143], a[188:191], a[108:111], v[140:143]
    s_add_u32 s57, s57, 512
    ds_read_b64_tr_b16 a[172:173], v9 offset:20480
    ds_read_b64_tr_b16 a[174:175], v9 offset:20992
    v_mfma_f32_16x16x32_bf16 v[136:139], a[188:191], a[104:107], v[136:139]
    s_mul_i32 s47, s55, 55296
    v_rcp_f32 v101, v101
    s_waitcnt lgkmcnt(8)
    v_mfma_f32_16x16x32_bf16 v[144:147], a[144:147], a[104:107], v[144:147]
    s_add_u32 m0, s61, 0x12000
    ds_read_b64_tr_b16 a[176:177], v10 offset:8192
    s_add_u32 s47, s47, s56
    v_mfma_f32_16x16x32_bf16 v[148:151], a[144:147], a[108:111], v[148:151]
    ds_read_b64_tr_b16 a[178:179], v10 offset:8704
    v_mov_b32 v248, s57
    v_mfma_f32_16x16x32_bf16 v[156:159], a[148:151], a[108:111], v[156:159]
    s_add_u32 s47, s47, 1696128
    ds_read_b64_tr_b16 a[180:181], v10 offset:20480
    v_mov_b32 v249, s47
    v_mfma_f32_16x16x32_bf16 v[152:155], a[148:151], a[104:107], v[152:155]
    ds_read_b64_tr_b16 a[182:183], v10 offset:20992
    buffer_load_dwordx4 v2, s[8:11], s60 offen offset:0 lds
    v_mfma_f32_16x16x32_bf16 v[160:163], a[152:155], a[104:107], v[160:163]
    ds_read_b64_tr_b16 a[184:185], v11 offset:8192
    v_add_u32 v250, 4294912640, v249
    v_mfma_f32_16x16x32_bf16 v[164:167], a[152:155], a[108:111], v[164:167]
    ds_read_b64_tr_b16 a[186:187], v11 offset:8704
    v_cmp_gt_u32 vcc, 8, v1
    v_mfma_f32_16x16x32_bf16 v[172:175], a[156:159], a[108:111], v[172:175]
    ds_read_b64_tr_b16 a[188:189], v11 offset:20480
    v_rcp_f32 v102, v102
    v_cndmask_b32 v248, v249, v248, vcc
    v_mfma_f32_16x16x32_bf16 v[168:171], a[156:159], a[104:107], v[168:171]
    s_waitcnt lgkmcnt(7)
    ds_read_b64_tr_b16 a[190:191], v11 offset:20992
    v_mul_f32 v109, v109, v101
    v_mfma_f32_16x16x32_bf16 v[112:115], a[160:163], a[112:115], v[112:115]
    ds_read_b64_tr_b16 a[144:145], v8 offset:24576
    buffer_load_dwordx4 v3, s[8:11], s60 offen offset:1024 lds
    v_mfma_f32_16x16x32_bf16 v[116:119], a[160:163], a[116:119], v[116:119]
    ds_read_b64_tr_b16 a[146:147], v8 offset:25088
    v_cmp_gt_u32 vcc, 14, v1
    v_rcp_f32 v103, v103
    v_mfma_f32_16x16x32_bf16 v[124:127], a[164:167], a[116:119], v[124:127]
    ds_read_b64_tr_b16 a[148:149], v8 offset:36864
    v_cndmask_b32 v248, v250, v248, vcc
    v_mfma_f32_16x16x32_bf16 v[120:123], a[164:167], a[112:115], v[120:123]
    ds_read_b64_tr_b16 a[150:151], v8 offset:37376
    v_mov_b32 v250, 0x40000000
    v_mfma_f32_16x16x32_bf16 v[128:131], a[168:171], a[112:115], v[128:131]
    ds_read_b64_tr_b16 a[152:153], v8 offset:28672
    v_mul_f32 v108, v108, v100
    v_mfma_f32_16x16x32_bf16 v[132:135], a[168:171], a[116:119], v[132:135]
    buffer_load_dwordx4 v4, s[8:11], s60 offen offset:2048 lds
    ds_read_b64_tr_b16 a[154:155], v8 offset:29184
    v_mfma_f32_16x16x32_bf16 v[140:143], a[172:175], a[116:119], v[140:143]
    ds_read_b64_tr_b16 a[156:157], v8 offset:40960
    v_mul_f32 v110, v110, v102
    v_mfma_f32_16x16x32_bf16 v[136:139], a[172:175], a[112:115], v[136:139]
    s_waitcnt lgkmcnt(7)
    ds_read_b64_tr_b16 a[158:159], v8 offset:41472
    ds_read_b64_tr_b16 a[160:161], v8 offset:32768
    v_mfma_f32_16x16x32_bf16 v[144:147], a[176:179], a[112:115], v[144:147]
    s_add_u32 m0, s61, 0x15000
    v_mul_f32 v111, v111, v103
    v_cmp_gt_u32 vcc, 20, v1
    v_mfma_f32_16x16x32_bf16 v[148:151], a[176:179], a[116:119], v[148:151]
    s_mul_i32 s56, s51, 663552
    ds_read_b64_tr_b16 a[162:163], v8 offset:33280
    v_cvt_pk_bf16_f32 v206, v108, v109
    v_mfma_f32_16x16x32_bf16 v[156:159], a[180:183], a[116:119], v[156:159]
    s_mul_i32 s55, s55, 9216
    ds_read_b64_tr_b16 a[164:165], v8 offset:45056
    ds_read_b64_tr_b16 a[166:167], v8 offset:45568
    v_mfma_f32_16x16x32_bf16 v[152:155], a[180:183], a[112:115], v[152:155]
    s_add_u32 s55, s55, s56
    ds_read_b64_tr_b16 a[168:169], v9 offset:24576
    v_mul_u32_u24 v249, 9216, v1
    v_cvt_pk_bf16_f32 v207, v110, v111
    v_mfma_f32_16x16x32_bf16 v[160:163], a[184:187], a[112:115], v[160:163]
    v_add_u32 v248, v248, v249
    v_cndmask_b32 v246, v250, v248, vcc
    v_mfma_f32_16x16x32_bf16 v[164:167], a[184:187], a[116:119], v[164:167]
    ds_read_b64_tr_b16 a[170:171], v9 offset:25088
    v_cmp_gt_u32 vcc, 24, v1
    v_mfma_f32_16x16x32_bf16 v[172:175], a[188:191], a[116:119], v[172:175]
    buffer_store_dwordx4 v[204:207], v40, s[24:27], s80 offen offset:3072 sc1
    ds_read_b64_tr_b16 a[172:173], v9 offset:36864
    v_lshl_add_u32 v249, v1, 7, s55
    v_cndmask_b32 v247, v250, v249, vcc
    v_mfma_f32_16x16x32_bf16 v[168:171], a[188:191], a[112:115], v[168:171]
    s_waitcnt lgkmcnt(7)
    buffer_load_dwordx4 v2, s[12:15], s60 offen offset:0 lds
    s_waitcnt vmcnt(12)
    ds_read_b64_tr_b16 a[174:175], v9 offset:37376
    s_cmp_ge_u32 s2, 144
    s_cbranch_scc1 NOCONV
    v_and_b32 v244, 15, v1
    v_lshrrev_b32 v245, 4, v1
    v_lshl_add_u32 v243, v245, 4, s63
    v_lshlrev_b32 v240, 5, v244
    v_mov_b32 v104, 0
    v_mov_b32 v105, 0
    v_mov_b32 v106, 0
    v_sub_u32 v240, v243, v240
    v_lshl_add_u32 v242, v1, 4, s63
    v_add_u32 v240, 3552, v240
    v_mov_b32 v107, 0
    ds_write_b128 v242, v[104:107] offset:7168
    v_and_b32 v242, 1, v1
    v_lshl_add_u32 v241, v244, 1, v243
    v_mul_u32_u24 v242, 1182, v242
    v_sub_u32 v241, v241, v242
    v_add_u32 v241, 1184, v241
    v_add_u32 v242, 512, v241
    ds_read2_b32 a[212:213], v242 offset0:144 offset1:145
    ds_read2_b32 a[214:215], v242 offset0:146 offset1:147
    ds_read2_b32 a[208:209], v242 offset0:128 offset1:129
    ds_read2_b32 a[210:211], v242 offset0:130 offset1:131
    ds_read_b128 v[80:83], v240 offset:3584
    ds_read2_b32 a[196:197], v242 offset0:0 offset1:1
    ds_read2_b32 a[198:199], v242 offset0:2 offset1:3
    ds_read2_b32 a[192:193], v241 offset0:0 offset1:1
    ds_read2_b32 a[194:195], v241 offset0:2 offset1:3
    ds_read_b128 v[84:87], v240 offset:2560
    s_waitcnt lgkmcnt(5)
    ds_read_b128 v[88:91], v240 offset:1536
    ds_read_b128 v[92:95], v240 offset:512
    ds_read_b128 v[96:99], v240 offset:3072
    v_lshlrev_b32 v104, 2, v244
    v_lshl_add_u32 v244, v245, 3, v244
    v_mfma_f32_16x16x32_bf16 v[64:67], a[212:215], v[80:83], 0
    ds_read_b128 v[100:103], v240 offset:2048
    v_sub_u32 v243, v243, v104
    v_mfma_f32_16x16x32_bf16 v[56:59], a[208:211], v[80:83], 0
    s_waitcnt lgkmcnt(7)
    v_mov_b32 v208, 0x3e00000
    v_min_u32 v244, 31, v244
    v_add_u32 v243, 2368, v243
    v_lshrrev_b32 v245, v244, v208
    v_and_b32 v245, 0xff, v245
    v_mfma_f32_16x16x32_bf16 v[52:55], a[196:199], v[80:83], 0
    s_waitcnt lgkmcnt(5)
    ds_read2_b32 a[200:201], v241 offset0:16 offset1:17
    v_lshl_or_b32 v245, v245, 15, v245
    v_and_b32 v208, 0x10001, v245
    v_mfma_f32_16x16x32_bf16 v[48:51], a[192:195], v[80:83], 0
    s_waitcnt lgkmcnt(5)
    ds_read_b128 v[80:83], v240 offset:1024
    ds_read2_b32 a[216:217], v243 offset0:111 offset1:112
    v_mfma_f32_16x16x32_bf16 v[72:75], a[212:215], v[84:87], 0
    ds_read2_b32 a[202:203], v241 offset0:18 offset1:19
    v_and_b32 v210, 0x100010, v245
    v_mul_u32_u24 v208, 0x3f80, v208
    v_mfma_f32_16x16x32_bf16 v[64:67], a[208:211], v[84:87], v[64:67]
    ds_read2_b32 a[218:219], v243 offset0:113 offset1:114
    v_and_b32 v209, 0x40004, v245
    v_mfma_f32_16x16x32_bf16 v[60:63], a[196:199], v[84:87], 0
    ds_read2_b32 a[204:205], v242 offset0:16 offset1:17
    v_mul_u32_u24 v209, 0xfe0, v209
    v_mul_u32_u24 v210, 0x3f8, v210
    v_mfma_f32_16x16x32_bf16 v[56:59], a[192:195], v[84:87], v[56:59]
    s_waitcnt lgkmcnt(9)
    ds_read_b128 v[84:87], v240 offset:0
    ds_read2_b32 a[220:221], v243 offset0:159 offset1:160
    v_mfma_f32_16x16x32_bf16 v[72:75], a[208:211], v[88:91], v[72:75]
    ds_read2_b32 a[206:207], v242 offset0:18 offset1:19
    v_and_b32 v211, 0x400040, v245
    v_mfma_f32_16x16x32_bf16 v[68:71], a[196:199], v[88:91], 0
    ds_read2_b32 a[222:223], v243 offset0:161 offset1:162
    v_mov_b32 v212, 0x1c000000
    v_mfma_f32_16x16x32_bf16 v[64:67], a[192:195], v[88:91], v[64:67]
    s_waitcnt lgkmcnt(12)
    ds_read_b128 v[88:91], v240 offset:3648
    v_lshrrev_b32 v245, v244, v212
    v_mfma_f32_16x16x32_bf16 v[76:79], a[196:199], v[92:95], 0
    v_mul_u32_u24 v211, 0xfe, v211
    v_and_b32 v245, 0xff, v245
    v_lshl_or_b32 v245, v245, 15, v245
    v_mfma_f32_16x16x32_bf16 v[72:75], a[192:195], v[92:95], v[72:75]
    s_waitcnt lgkmcnt(12)
    ds_read_b128 v[92:95], v240 offset:2624
    ds_read2_b32 a[224:225], v243 offset0:95 offset1:96
    v_mfma_f32_16x16x32_bf16 v[68:71], a[212:215], v[96:99], v[68:71]
    v_and_b32 v212, 0x10001, v245
    v_mul_u32_u24 v212, 0x3f80, v212
    v_mfma_f32_16x16x32_bf16 v[60:63], a[208:211], v[96:99], v[60:63]
    ds_read2_b32 a[226:227], v243 offset0:97 offset1:98
    v_and_b32 v213, 0x40004, v245
    v_mfma_f32_16x16x32_bf16 v[56:59], a[196:199], v[96:99], v[56:59]
    v_mul_u32_u24 v213, 0xfe0, v213
    v_and_b32 v214, 0x100010, v245
    v_mfma_f32_16x16x32_bf16 v[52:55], a[192:195], v[96:99], v[52:55]
    s_waitcnt lgkmcnt(14)
    ds_read_b128 v[96:99], v240 offset:1600
    v_mul_u32_u24 v214, 0x3f8, v214
    v_mfma_f32_16x16x32_bf16 v[76:79], a[212:215], v[100:103], v[76:79]
    ds_read2_b32 a[228:229], v243 offset0:143 offset1:144
    v_and_b32 v215, 0x400040, v245
    v_mfma_f32_16x16x32_bf16 v[68:71], a[208:211], v[100:103], v[68:71]
    ds_read2_b32 a[230:231], v243 offset0:145 offset1:146
    v_mul_u32_u24 v215, 0xfe, v215
    v_mfma_f32_16x16x32_bf16 v[64:67], a[196:199], v[100:103], v[64:67]
    v_mov_b32 v216, 0x7f00000
    v_lshrrev_b32 v245, v244, v216
    v_mfma_f32_16x16x32_bf16 v[60:63], a[192:195], v[100:103], v[60:63]
    s_waitcnt lgkmcnt(15)
    ds_read_b128 v[100:103], v240 offset:576
    v_and_b32 v245, 0xff, v245
    v_mfma_f32_16x16x32_bf16 v[76:79], a[208:211], v[80:83], v[76:79]
    ds_read2_b32 a[232:233], v243 offset0:79 offset1:80
    v_lshl_or_b32 v245, v245, 15, v245
    v_mfma_f32_16x16x32_bf16 v[72:75], a[196:199], v[80:83], v[72:75]
    v_and_b32 v216, 0x10001, v245
    v_mul_u32_u24 v216, 0x3f80, v216
    v_mfma_f32_16x16x32_bf16 v[68:71], a[192:195], v[80:83], v[68:71]
    s_waitcnt lgkmcnt(12)
    ds_read_b128 v[80:83], v240 offset:3136
    ds_read2_b32 a[234:235], v243 offset0:81 offset1:82
    v_mfma_f32_16x16x32_bf16 v[76:79], a[192:195], v[84:87], v[76:79]
    s_waitcnt lgkmcnt(10)
    ds_read_b128 v[84:87], v240 offset:2112
    v_and_b32 v217, 0x40004, v245
    v_mfma_f32_16x16x32_bf16 v[48:51], a[200:203], v[88:91], v[48:51]
    ds_read2_b32 a[236:237], v243 offset0:127 offset1:128
    v_mul_u32_u24 v217, 0xfe0, v217
    v_and_b32 v218, 0x100010, v245
    v_mfma_f32_16x16x32_bf16 v[52:55], a[204:207], v[88:91], v[52:55]
    s_waitcnt lgkmcnt(11)
    ds_read_b128 v[88:91], v240 offset:1088
    v_and_b32 v219, 0x400040, v245
    v_mfma_f32_16x16x32_bf16 v[56:59], a[200:203], v[92:95], v[56:59]
    ds_read2_b32 a[192:193], v241 offset0:32 offset1:33
    ds_read2_b32 a[238:239], v243 offset0:129 offset1:130
    v_mfma_f32_16x16x32_bf16 v[60:63], a[204:207], v[92:95], v[60:63]
    s_waitcnt lgkmcnt(11)
    ds_read_b128 v[92:95], v240 offset:64
    ds_read_b128 v[104:107], v240 offset:3584
    v_mul_u32_u24 v218, 0x3f8, v218
    v_mfma_f32_16x16x32_bf16 v[64:67], a[200:203], v[96:99], v[64:67]
    ds_read2_b32 a[194:195], v241 offset0:34 offset1:35
    v_mov_b32 v220, 0xff80000
    v_mul_u32_u24 v219, 0xfe, v219
    v_lshrrev_b32 v245, v244, v220
    v_mfma_f32_16x16x32_bf16 v[68:71], a[204:207], v[96:99], v[68:71]
    s_waitcnt lgkmcnt(11)
    ds_read_b128 v[96:99], v240 offset:3712
    ds_read2_b32 a[240:241], v243 offset0:63 offset1:64
    ds_read_b128 v[108:111], v240 offset:3600
    v_and_b32 v245, 0xff, v245
    v_mfma_f32_16x16x32_bf16 v[72:75], a[200:203], v[100:103], v[72:75]
    ds_read2_b32 a[196:197], v242 offset0:32 offset1:33
    v_lshl_or_b32 v245, v245, 15, v245
    v_mfma_f32_16x16x32_bf16 v[76:79], a[204:207], v[100:103], v[76:79]
    s_waitcnt lgkmcnt(13)
    ds_read_b128 v[100:103], v240 offset:2688
    v_and_b32 v220, 0x10001, v245
    v_mfma_f32_16x16x32_bf16 v[52:55], a[200:203], v[80:83], v[52:55]
    ds_read2_b32 a[242:243], v243 offset0:65 offset1:66
    ds_read2_b32 a[198:199], v242 offset0:34 offset1:35
    v_mfma_f32_16x16x32_bf16 v[56:59], a[204:207], v[80:83], v[56:59]
    s_waitcnt lgkmcnt(14)
    ds_read_b128 v[80:83], v240 offset:1664
    v_and_b32 v222, 0x100010, v245
    v_and_b32 v221, 0x40004, v245
    v_mul_u32_u24 v220, 0x3f80, v220
    v_mfma_f32_16x16x32_bf16 v[60:63], a[200:203], v[84:87], v[60:63]
    ds_read2_b32 a[244:245], v243 offset0:47 offset1:48
    v_and_b32 v223, 0x400040, v245
    v_mul_u32_u24 v221, 0xfe0, v221
    v_mfma_f32_16x16x32_bf16 v[64:67], a[204:207], v[84:87], v[64:67]
    s_waitcnt lgkmcnt(14)
    ds_read_b128 v[84:87], v240 offset:640
    v_mul_u32_u24 v222, 0x3f8, v222
    v_mfma_f32_16x16x32_bf16 v[68:71], a[200:203], v[88:91], v[68:71]
    ds_read2_b32 a[246:247], v243 offset0:49 offset1:50
    v_mul_u32_u24 v223, 0xfe, v223
    v_mfma_f32_16x16x32_bf16 v[72:75], a[204:207], v[88:91], v[72:75]
    s_waitcnt lgkmcnt(13)
    ds_read_b128 v[88:91], v240 offset:3200
    v_mfma_f32_16x16x32_bf16 v[76:79], a[200:203], v[92:95], v[76:79]
    ds_read_b128 v[92:95], v240 offset:2176
    s_waitcnt lgkmcnt(10)
    v_mfma_f32_16x16x32_bf16 v[224:227], v[104:107], v[208:211], 0
    ds_read2_b32 a[248:249], v243 offset0:31 offset1:32
    v_mfma_f32_16x16x32_bf16 v[228:231], v[104:107], v[212:215], 0
    ds_read2_b32 a[250:251], v243 offset0:33 offset1:34
    v_mfma_f32_16x16x32_bf16 v[232:235], v[108:111], v[208:211], 0
    v_mfma_f32_16x16x32_bf16 v[236:239], v[108:111], v[212:215], 0
    ds_read2_b32 a[252:253], v243 offset0:15 offset1:16
    v_mfma_f32_16x16x32_bf16 v[48:51], a[192:195], v[96:99], v[48:51]
    s_waitcnt lgkmcnt(9)
    s_nop 1
    v_cvt_pk_bf16_f32 v224, v224, v228
    v_cvt_pk_bf16_f32 v225, v225, v229
    v_mfma_f32_16x16x32_bf16 v[52:55], a[196:199], v[96:99], v[52:55]
    ds_read_b128 v[96:99], v240 offset:1152
    buffer_load_dword v46, v246, s[8:11], 0 offen
    ds_read2_b32 a[254:255], v243 offset0:17 offset1:18
    v_mfma_f32_16x16x32_bf16 v[56:59], a[192:195], v[100:103], v[56:59]
    ds_read2_b32 a[200:201], v241 offset0:48 offset1:49
    v_cvt_pk_bf16_f32 v226, v226, v230
    v_mfma_f32_16x16x32_bf16 v[60:63], a[196:199], v[100:103], v[60:63]
    s_waitcnt lgkmcnt(11)
    ds_read_b128 v[100:103], v240 offset:128
    v_cvt_pk_bf16_f32 v227, v227, v231
    v_mfma_f32_16x16x32_bf16 v[64:67], a[192:195], v[80:83], v[64:67]
    v_cvt_pk_bf16_f32 v234, v234, v238
    v_cvt_pk_bf16_f32 v233, v233, v237
    v_cvt_pk_bf16_f32 v235, v235, v239
    v_mfma_f32_16x16x32_bf16 v[228:231], v[108:111], v[220:223], 0
    ds_read2_b32 a[202:203], v241 offset0:50 offset1:51
    v_cvt_pk_bf16_f32 v232, v232, v236
    v_mfma_f32_16x16x32_bf16 v[236:239], v[104:107], v[216:219], 0
    ds_read2_b32 a[204:205], v242 offset0:48 offset1:49
    v_mfma_f32_16x16x32_bf16 v[68:71], a[196:199], v[80:83], v[68:71]
    ds_read_b128 v[104:107], v240 offset:3072
    v_mfma_f32_16x16x32_bf16 v[64:67], v[224:227], a[232:235], v[64:67]
    s_waitcnt lgkmcnt(13)
    ds_read_b128 v[80:83], v240 offset:3776
    v_mfma_f32_16x16x32_bf16 v[72:75], a[192:195], v[84:87], v[72:75]
    ds_read2_b32 a[206:207], v242 offset0:50 offset1:51
    ds_read_b128 v[108:111], v240 offset:3088
    v_mfma_f32_16x16x32_bf16 v[60:63], v[224:227], a[224:227], v[60:63]
    v_cvt_pk_bf16_f32 v228, v228, v236
    v_cvt_pk_bf16_f32 v231, v231, v239
    v_mfma_f32_16x16x32_bf16 v[76:79], a[196:199], v[84:87], v[76:79]
    ds_read_b128 v[84:87], v240 offset:2752
    v_cvt_pk_bf16_f32 v229, v229, v237
    v_mfma_f32_16x16x32_bf16 v[64:67], v[232:235], a[236:239], v[64:67]
    s_waitcnt lgkmcnt(15)
    v_cvt_pk_bf16_f32 v230, v230, v238
    v_mfma_f32_16x16x32_bf16 v[52:55], a[192:195], v[88:91], v[52:55]
    v_mfma_f32_16x16x32_bf16 v[56:59], a[196:199], v[88:91], v[56:59]
    s_waitcnt lgkmcnt(14)
    v_mfma_f32_16x16x32_bf16 v[60:63], a[192:195], v[92:95], v[60:63]
    ds_read_b128 v[88:91], v240 offset:1728
    v_mfma_f32_16x16x32_bf16 v[64:67], a[196:199], v[92:95], v[64:67]
    ds_read_b128 v[92:95], v240 offset:704
    v_mfma_f32_16x16x32_bf16 v[56:59], v[224:227], a[216:219], v[56:59]
    s_waitcnt lgkmcnt(12)
    v_mfma_f32_16x16x32_bf16 v[68:71], a[192:195], v[96:99], v[68:71]
    v_mfma_f32_16x16x32_bf16 v[60:63], v[232:235], a[228:231], v[60:63]
    v_mfma_f32_16x16x32_bf16 v[72:75], a[196:199], v[96:99], v[72:75]
    ds_read_b128 v[96:99], v240 offset:3264
    v_mfma_f32_16x16x32_bf16 v[56:59], v[232:235], a[220:223], v[56:59]
    s_waitcnt lgkmcnt(10)
    buffer_load_dword v46, v246, s[12:15], 0 offen
    v_mfma_f32_16x16x32_bf16 v[76:79], a[192:195], v[100:103], v[76:79]
    v_mfma_f32_16x16x32_bf16 v[72:75], v[228:231], a[248:251], v[72:75]
    ds_read_b128 v[100:103], v240 offset:2240
    v_mfma_f32_16x16x32_bf16 v[68:71], v[228:231], a[244:247], v[68:71]
    v_mfma_f32_16x16x32_bf16 v[76:79], v[228:231], a[252:255], v[76:79]
    v_mfma_f32_16x16x32_bf16 v[64:67], v[228:231], a[240:243], v[64:67]
    s_waitcnt lgkmcnt(5)
    v_mfma_f32_16x16x32_bf16 v[224:227], v[104:107], v[208:211], 0
    v_mfma_f32_16x16x32_bf16 v[228:231], v[104:107], v[212:215], 0
    v_mfma_f32_16x16x32_bf16 v[232:235], v[108:111], v[208:211], 0
    v_mfma_f32_16x16x32_bf16 v[236:239], v[108:111], v[212:215], 0
    v_mfma_f32_16x16x32_bf16 v[48:51], a[200:203], v[80:83], v[48:51]
    s_nop 4
    v_cvt_pk_bf16_f32 v224, v224, v228
    v_cvt_pk_bf16_f32 v225, v225, v229
    v_mfma_f32_16x16x32_bf16 v[52:55], a[204:207], v[80:83], v[52:55]
    s_waitcnt lgkmcnt(4)
    ds_read_b128 v[80:83], v240 offset:1216
    v_cvt_pk_bf16_f32 v226, v226, v230
    v_mfma_f32_16x16x32_bf16 v[56:59], a[200:203], v[84:87], v[56:59]
    ds_read2_b32 a[192:193], v241 offset0:64 offset1:65
    v_cvt_pk_bf16_f32 v227, v227, v231
    v_mfma_f32_16x16x32_bf16 v[60:63], a[204:207], v[84:87], v[60:63]
    s_waitcnt lgkmcnt(5)
    ds_read_b128 v[84:87], v240 offset:192
    ds_read2_b32 a[194:195], v241 offset0:66 offset1:67
    v_mfma_f32_16x16x32_bf16 v[64:67], a[200:203], v[88:91], v[64:67]
    v_cvt_pk_bf16_f32 v234, v234, v238
    v_cvt_pk_bf16_f32 v235, v235, v239
    v_mfma_f32_16x16x32_bf16 v[228:231], v[108:111], v[220:223], 0
    v_cvt_pk_bf16_f32 v233, v233, v237
    v_cvt_pk_bf16_f32 v232, v232, v236
    v_mfma_f32_16x16x32_bf16 v[236:239], v[104:107], v[216:219], 0
    ds_read2_b32 a[196:197], v242 offset0:64 offset1:65
    v_mfma_f32_16x16x32_bf16 v[68:71], a[204:207], v[88:91], v[68:71]
    ds_read_b128 v[104:107], v240 offset:2560
    ds_read_b128 v[88:91], v240 offset:3840
    v_mfma_f32_16x16x32_bf16 v[64:67], v[224:227], a[224:227], v[64:67]
    ds_read2_b32 a[198:199], v242 offset0:66 offset1:67
    s_waitcnt lgkmcnt(10)
    v_mfma_f32_16x16x32_bf16 v[72:75], a[200:203], v[92:95], v[72:75]
    ds_read_b128 v[108:111], v240 offset:2576
    v_mfma_f32_16x16x32_bf16 v[68:71], v[224:227], a[232:235], v[68:71]
    v_cvt_pk_bf16_f32 v228, v228, v236
    v_cvt_pk_bf16_f32 v231, v231, v239
    v_mfma_f32_16x16x32_bf16 v[76:79], a[204:207], v[92:95], v[76:79]
    ds_read_b128 v[92:95], v240 offset:2816
    v_cvt_pk_bf16_f32 v229, v229, v237
    v_mfma_f32_16x16x32_bf16 v[64:67], v[232:235], a[228:231], v[64:67]
    v_cvt_pk_bf16_f32 v230, v230, v238
    s_waitcnt lgkmcnt(11)
    v_mfma_f32_16x16x32_bf16 v[52:55], a[200:203], v[96:99], v[52:55]
    v_mfma_f32_16x16x32_bf16 v[68:71], v[232:235], a[236:239], v[68:71]
    v_mfma_f32_16x16x32_bf16 v[56:59], a[204:207], v[96:99], v[56:59]
    s_waitcnt lgkmcnt(10)
    v_mfma_f32_16x16x32_bf16 v[60:63], a[200:203], v[100:103], v[60:63]
    ds_read_b128 v[96:99], v240 offset:1792
    v_mfma_f32_16x16x32_bf16 v[64:67], a[204:207], v[100:103], v[64:67]
    s_waitcnt lgkmcnt(10)
    v_mfma_f32_16x16x32_bf16 v[68:71], a[200:203], v[80:83], v[68:71]
    ds_read_b128 v[100:103], v240 offset:768
    v_mfma_f32_16x16x32_bf16 v[60:63], v[224:227], a[216:219], v[60:63]
    v_mfma_f32_16x16x32_bf16 v[72:75], a[204:207], v[80:83], v[72:75]
    s_waitcnt lgkmcnt(9)
    v_mfma_f32_16x16x32_bf16 v[76:79], a[200:203], v[84:87], v[76:79]
    ds_read_b128 v[80:83], v240 offset:3328
    v_mfma_f32_16x16x32_bf16 v[60:63], v[232:235], a[220:223], v[60:63]
    ds_read_b128 v[84:87], v240 offset:2304
    v_mfma_f32_16x16x32_bf16 v[72:75], v[228:231], a[244:247], v[72:75]
    v_mfma_f32_16x16x32_bf16 v[76:79], v[228:231], a[248:251], v[76:79]
    buffer_load_dword v46, v247, s[16:19], 0 offen offset:0
    v_mfma_f32_16x16x32_bf16 v[68:71], v[228:231], a[240:243], v[68:71]
    s_waitcnt lgkmcnt(5)
    v_mfma_f32_16x16x32_bf16 v[224:227], v[104:107], v[208:211], 0
    v_mfma_f32_16x16x32_bf16 v[228:231], v[104:107], v[212:215], 0
    v_mfma_f32_16x16x32_bf16 v[232:235], v[108:111], v[208:211], 0
    v_mfma_f32_16x16x32_bf16 v[236:239], v[108:111], v[212:215], 0
    v_mfma_f32_16x16x32_bf16 v[48:51], a[192:195], v[88:91], v[48:51]
    s_nop 4
    v_cvt_pk_bf16_f32 v224, v224, v228
    v_cvt_pk_bf16_f32 v225, v225, v229
    v_mfma_f32_16x16x32_bf16 v[52:55], a[196:199], v[88:91], v[52:55]
    s_waitcnt lgkmcnt(4)
    ds_read_b128 v[88:91], v240 offset:1280
    ds_read2_b32 a[200:201], v241 offset0:80 offset1:81
    v_mfma_f32_16x16x32_bf16 v[56:59], a[192:195], v[92:95], v[56:59]
    v_cvt_pk_bf16_f32 v226, v226, v230
    v_cvt_pk_bf16_f32 v227, v227, v231
    v_mfma_f32_16x16x32_bf16 v[60:63], a[196:199], v[92:95], v[60:63]
    s_waitcnt lgkmcnt(5)
    ds_read_b128 v[92:95], v240 offset:256
    v_cvt_pk_bf16_f32 v234, v234, v238
    v_mfma_f32_16x16x32_bf16 v[64:67], a[192:195], v[96:99], v[64:67]
    ds_read2_b32 a[202:203], v241 offset0:82 offset1:83
    v_cvt_pk_bf16_f32 v235, v235, v239
    v_mfma_f32_16x16x32_bf16 v[228:231], v[108:111], v[220:223], 0
    v_cvt_pk_bf16_f32 v233, v233, v237
    v_cvt_pk_bf16_f32 v232, v232, v236
    v_mfma_f32_16x16x32_bf16 v[236:239], v[104:107], v[216:219], 0
    ds_read2_b32 a[204:205], v242 offset0:80 offset1:81
    v_mfma_f32_16x16x32_bf16 v[68:71], a[196:199], v[96:99], v[68:71]
    ds_read_b128 v[104:107], v240 offset:2048
    v_mfma_f32_16x16x32_bf16 v[64:67], v[224:227], a[216:219], v[64:67]
    s_waitcnt lgkmcnt(8)
    ds_read_b128 v[96:99], v240 offset:3904
    ds_read2_b32 a[206:207], v242 offset0:82 offset1:83
    v_mfma_f32_16x16x32_bf16 v[72:75], a[192:195], v[100:103], v[72:75]
    ds_read_b128 v[108:111], v240 offset:2064
    v_cvt_pk_bf16_f32 v229, v229, v237
    v_mfma_f32_16x16x32_bf16 v[68:71], v[224:227], a[224:227], v[68:71]
    v_cvt_pk_bf16_f32 v231, v231, v239
    v_cvt_pk_bf16_f32 v228, v228, v236
    v_mfma_f32_16x16x32_bf16 v[76:79], a[196:199], v[100:103], v[76:79]
    v_mfma_f32_16x16x32_bf16 v[72:75], v[224:227], a[232:235], v[72:75]
    ds_read_b128 v[100:103], v240 offset:2880
    s_waitcnt lgkmcnt(11)
    v_mfma_f32_16x16x32_bf16 v[52:55], a[192:195], v[80:83], v[52:55]
    v_cvt_pk_bf16_f32 v230, v230, v238
    v_mfma_f32_16x16x32_bf16 v[68:71], v[232:235], a[228:231], v[68:71]
    v_mfma_f32_16x16x32_bf16 v[56:59], a[196:199], v[80:83], v[56:59]
    v_mfma_f32_16x16x32_bf16 v[72:75], v[232:235], a[236:239], v[72:75]
    s_waitcnt lgkmcnt(10)
    ds_read_b128 v[80:83], v240 offset:1856
    v_mfma_f32_16x16x32_bf16 v[60:63], a[192:195], v[84:87], v[60:63]
    v_mfma_f32_16x16x32_bf16 v[64:67], a[196:199], v[84:87], v[64:67]
    s_waitcnt lgkmcnt(10)
    v_mfma_f32_16x16x32_bf16 v[68:71], a[192:195], v[88:91], v[68:71]
    ds_read_b128 v[84:87], v240 offset:832
    v_mfma_f32_16x16x32_bf16 v[72:75], a[196:199], v[88:91], v[72:75]
    v_mfma_f32_16x16x32_bf16 v[64:67], v[232:235], a[220:223], v[64:67]
    s_waitcnt lgkmcnt(9)
    ds_read_b128 v[88:91], v240 offset:3392
    v_mfma_f32_16x16x32_bf16 v[76:79], a[192:195], v[92:95], v[76:79]
    ds_read_b128 v[92:95], v240 offset:2368
    v_mfma_f32_16x16x32_bf16 v[72:75], v[228:231], a[240:243], v[72:75]
    v_mfma_f32_16x16x32_bf16 v[76:79], v[228:231], a[244:247], v[76:79]
    s_waitcnt lgkmcnt(5)
    v_mfma_f32_16x16x32_bf16 v[224:227], v[104:107], v[208:211], 0
    v_mfma_f32_16x16x32_bf16 v[228:231], v[104:107], v[212:215], 0
    v_mfma_f32_16x16x32_bf16 v[232:235], v[108:111], v[208:211], 0
    v_mfma_f32_16x16x32_bf16 v[236:239], v[108:111], v[212:215], 0
    v_mfma_f32_16x16x32_bf16 v[48:51], a[200:203], v[96:99], v[48:51]
    s_nop 4
    v_cvt_pk_bf16_f32 v225, v225, v229
    v_cvt_pk_bf16_f32 v224, v224, v228
    v_mfma_f32_16x16x32_bf16 v[52:55], a[204:207], v[96:99], v[52:55]
    s_waitcnt lgkmcnt(4)
    ds_read_b128 v[96:99], v240 offset:1344
    v_cvt_pk_bf16_f32 v226, v226, v230
    v_mfma_f32_16x16x32_bf16 v[56:59], a[200:203], v[100:103], v[56:59]
    ds_read2_b32 a[192:193], v241 offset0:96 offset1:97
    v_cvt_pk_bf16_f32 v227, v227, v231
    v_mfma_f32_16x16x32_bf16 v[60:63], a[204:207], v[100:103], v[60:63]
    s_waitcnt lgkmcnt(5)
    ds_read_b128 v[100:103], v240 offset:320
    ds_read2_b32 a[194:195], v241 offset0:98 offset1:99
    v_mfma_f32_16x16x32_bf16 v[64:67], a[200:203], v[80:83], v[64:67]
    v_cvt_pk_bf16_f32 v235, v235, v239
    v_cvt_pk_bf16_f32 v234, v234, v238
    v_mfma_f32_16x16x32_bf16 v[228:231], v[108:111], v[220:223], 0
    v_cvt_pk_bf16_f32 v233, v233, v237
    v_cvt_pk_bf16_f32 v232, v232, v236
    v_mfma_f32_16x16x32_bf16 v[236:239], v[104:107], v[216:219], 0
    ds_read2_b32 a[196:197], v242 offset0:96 offset1:97
    buffer_load_dword v46, v247, s[16:19], 0 offen offset:3072
    ds_read_b128 v[104:107], v240 offset:1536
    v_mfma_f32_16x16x32_bf16 v[68:71], a[204:207], v[80:83], v[68:71]
    ds_read_b128 v[80:83], v240 offset:3968
    s_waitcnt lgkmcnt(9)
    v_mfma_f32_16x16x32_bf16 v[72:75], a[200:203], v[84:87], v[72:75]
    ds_read2_b32 a[198:199], v242 offset0:98 offset1:99
    v_cvt_pk_bf16_f32 v228, v228, v236
    v_mfma_f32_16x16x32_bf16 v[76:79], a[204:207], v[84:87], v[76:79]
    ds_read_b128 v[108:111], v240 offset:1552
    v_cvt_pk_bf16_f32 v231, v231, v239
    v_mfma_f32_16x16x32_bf16 v[68:71], v[224:227], a[216:219], v[68:71]
    ds_read_b128 v[84:87], v240 offset:2944
    s_waitcnt lgkmcnt(11)
    v_mfma_f32_16x16x32_bf16 v[52:55], a[200:203], v[88:91], v[52:55]
    v_cvt_pk_bf16_f32 v230, v230, v238
    v_cvt_pk_bf16_f32 v229, v229, v237
    v_mfma_f32_16x16x32_bf16 v[76:79], v[224:227], a[232:235], v[76:79]
    v_mfma_f32_16x16x32_bf16 v[56:59], a[204:207], v[88:91], v[56:59]
    v_mfma_f32_16x16x32_bf16 v[72:75], v[224:227], a[224:227], v[72:75]
    s_waitcnt lgkmcnt(10)
    ds_read_b128 v[88:91], v240 offset:1920
    v_mfma_f32_16x16x32_bf16 v[60:63], a[200:203], v[92:95], v[60:63]
    v_mfma_f32_16x16x32_bf16 v[76:79], v[232:235], a[236:239], v[76:79]
    v_mfma_f32_16x16x32_bf16 v[64:67], a[204:207], v[92:95], v[64:67]
    s_waitcnt lgkmcnt(10)
    ds_read_b128 v[92:95], v240 offset:896
    v_mfma_f32_16x16x32_bf16 v[68:71], a[200:203], v[96:99], v[68:71]
    v_mfma_f32_16x16x32_bf16 v[72:75], a[204:207], v[96:99], v[72:75]
    s_waitcnt lgkmcnt(9)
    v_mfma_f32_16x16x32_bf16 v[76:79], a[200:203], v[100:103], v[76:79]
    ds_read_b128 v[96:99], v240 offset:3456
    v_mfma_f32_16x16x32_bf16 v[68:71], v[232:235], a[220:223], v[68:71]
    ds_read_b128 v[100:103], v240 offset:2432
    v_mfma_f32_16x16x32_bf16 v[72:75], v[232:235], a[228:231], v[72:75]
    v_mfma_f32_16x16x32_bf16 v[76:79], v[228:231], a[240:243], v[76:79]
    s_waitcnt lgkmcnt(5)
    v_mfma_f32_16x16x32_bf16 v[224:227], v[104:107], v[208:211], 0
    v_mfma_f32_16x16x32_bf16 v[228:231], v[104:107], v[212:215], 0
    v_mfma_f32_16x16x32_bf16 v[232:235], v[108:111], v[208:211], 0
    v_mfma_f32_16x16x32_bf16 v[236:239], v[108:111], v[212:215], 0
    ds_read_b128 v[104:107], v240 offset:1024
    v_mfma_f32_16x16x32_bf16 v[48:51], a[192:195], v[80:83], v[48:51]
    s_nop 3
    v_cvt_pk_bf16_f32 v225, v225, v229
    v_cvt_pk_bf16_f32 v224, v224, v228
    v_mfma_f32_16x16x32_bf16 v[52:55], a[196:199], v[80:83], v[52:55]
    s_waitcnt lgkmcnt(5)
    ds_read_b128 v[80:83], v240 offset:1408
    v_cvt_pk_bf16_f32 v226, v226, v230
    v_mfma_f32_16x16x32_bf16 v[56:59], a[192:195], v[84:87], v[56:59]
    ds_read_b128 v[108:111], v240 offset:1040
    v_cvt_pk_bf16_f32 v227, v227, v231
    v_mfma_f32_16x16x32_bf16 v[60:63], a[196:199], v[84:87], v[60:63]
    s_waitcnt lgkmcnt(6)
    ds_read2_b32 a[200:201], v241 offset0:112 offset1:113
    v_cvt_pk_bf16_f32 v235, v235, v239
    v_mfma_f32_16x16x32_bf16 v[64:67], a[192:195], v[88:91], v[64:67]
    ds_read_b128 v[84:87], v240 offset:384
    ds_read2_b32 a[202:203], v241 offset0:114 offset1:115
    v_mfma_f32_16x16x32_bf16 v[68:71], a[196:199], v[88:91], v[68:71]
    s_waitcnt lgkmcnt(8)
    ds_read_b128 v[88:91], v240 offset:4032
    v_cvt_pk_bf16_f32 v233, v233, v237
    v_mfma_f32_16x16x32_bf16 v[72:75], a[192:195], v[92:95], v[72:75]
    ds_read2_b32 a[204:205], v242 offset0:112 offset1:113
    v_mfma_f32_16x16x32_bf16 v[76:79], a[196:199], v[92:95], v[76:79]
    s_waitcnt lgkmcnt(9)
    v_cvt_pk_bf16_f32 v232, v232, v236
    v_mfma_f32_16x16x32_bf16 v[52:55], a[192:195], v[96:99], v[52:55]
    ds_read_b128 v[92:95], v240 offset:3008
    v_cvt_pk_bf16_f32 v234, v234, v238
    v_mfma_f32_16x16x32_bf16 v[72:75], v[224:227], a[216:219], v[72:75]
    ds_read2_b32 a[206:207], v242 offset0:114 offset1:115
    v_mfma_f32_16x16x32_bf16 v[56:59], a[196:199], v[96:99], v[56:59]
    v_mfma_f32_16x16x32_bf16 v[76:79], v[224:227], a[224:227], v[76:79]
    s_waitcnt lgkmcnt(10)
    ds_read_b128 v[96:99], v240 offset:1984
    v_mfma_f32_16x16x32_bf16 v[60:63], a[192:195], v[100:103], v[60:63]
    v_mfma_f32_16x16x32_bf16 v[72:75], v[232:235], a[220:223], v[72:75]
    v_mfma_f32_16x16x32_bf16 v[64:67], a[196:199], v[100:103], v[64:67]
    v_mfma_f32_16x16x32_bf16 v[76:79], v[232:235], a[228:231], v[76:79]
    s_waitcnt lgkmcnt(9)
    ds_read_b128 v[100:103], v240 offset:960
    v_mfma_f32_16x16x32_bf16 v[68:71], a[192:195], v[80:83], v[68:71]
    v_mfma_f32_16x16x32_bf16 v[72:75], a[196:199], v[80:83], v[72:75]
    ds_read_b128 v[80:83], v240 offset:3520
    s_waitcnt lgkmcnt(8)
    v_mfma_f32_16x16x32_bf16 v[76:79], a[192:195], v[84:87], v[76:79]
    buffer_load_dword v46, v247, s[16:19], s80 offen offset:2048
    v_mfma_f32_16x16x32_bf16 v[224:227], v[104:107], v[208:211], 0
    ds_read_b128 v[84:87], v240 offset:2496
    v_mfma_f32_16x16x32_bf16 v[228:231], v[104:107], v[212:215], 0
    v_mfma_f32_16x16x32_bf16 v[232:235], v[108:111], v[208:211], 0
    v_mfma_f32_16x16x32_bf16 v[236:239], v[108:111], v[212:215], 0
    s_waitcnt lgkmcnt(7)
    v_mfma_f32_16x16x32_bf16 v[48:51], a[200:203], v[88:91], v[48:51]
    s_waitcnt lgkmcnt(4)
    s_nop 2
    v_cvt_pk_bf16_f32 v224, v224, v228
    v_cvt_pk_bf16_f32 v225, v225, v229
    v_mfma_f32_16x16x32_bf16 v[52:55], a[204:207], v[88:91], v[52:55]
    ds_read_b128 v[88:91], v240 offset:1472
    v_cvt_pk_bf16_f32 v232, v232, v236
    v_mfma_f32_16x16x32_bf16 v[56:59], a[200:203], v[92:95], v[56:59]
    v_cvt_pk_bf16_f32 v226, v226, v230
    v_mfma_f32_16x16x32_bf16 v[60:63], a[204:207], v[92:95], v[60:63]
    ds_read_b128 v[92:95], v240 offset:448
    s_waitcnt lgkmcnt(5)
    v_mfma_f32_16x16x32_bf16 v[64:67], a[200:203], v[96:99], v[64:67]
    v_mfma_f32_16x16x32_bf16 v[68:71], a[204:207], v[96:99], v[68:71]
    s_waitcnt lgkmcnt(4)
    v_cvt_pk_bf16_f32 v227, v227, v231
    v_mfma_f32_16x16x32_bf16 v[72:75], a[200:203], v[100:103], v[72:75]
    v_cvt_pk_bf16_f32 v235, v235, v239
    v_cvt_pk_bf16_f32 v234, v234, v238
    v_mfma_f32_16x16x32_bf16 v[76:79], a[204:207], v[100:103], v[76:79]
    v_cvt_pk_bf16_f32 v233, v233, v237
    s_waitcnt lgkmcnt(3)
    v_mfma_f32_16x16x32_bf16 v[52:55], a[200:203], v[80:83], v[52:55]
    v_mfma_f32_16x16x32_bf16 v[56:59], a[204:207], v[80:83], v[56:59]
    v_mfma_f32_16x16x32_bf16 v[76:79], v[224:227], a[216:219], v[76:79]
    s_waitcnt lgkmcnt(2)
    v_mfma_f32_16x16x32_bf16 v[60:63], a[200:203], v[84:87], v[60:63]
    v_mfma_f32_16x16x32_bf16 v[64:67], a[204:207], v[84:87], v[64:67]
    v_mfma_f32_16x16x32_bf16 v[76:79], v[232:235], a[220:223], v[76:79]
    s_waitcnt lgkmcnt(1)
    v_mfma_f32_16x16x32_bf16 v[68:71], a[200:203], v[88:91], v[68:71]
    v_mfma_f32_16x16x32_bf16 v[72:75], a[204:207], v[88:91], v[72:75]
    s_waitcnt lgkmcnt(0)
    v_mfma_f32_16x16x32_bf16 v[76:79], a[200:203], v[92:95], v[76:79]
    s_nop 4
    v_cvt_pk_bf16_f32 v96, v48, v49
    v_cvt_pk_bf16_f32 v106, v68, v69
    v_cvt_pk_bf16_f32 v105, v66, v67
    v_cvt_pk_bf16_f32 v107, v70, v71
    v_cvt_pk_bf16_f32 v97, v50, v51
    v_cvt_pk_bf16_f32 v98, v52, v53
    v_cvt_pk_bf16_f32 v108, v72, v73
    v_cvt_pk_bf16_f32 v99, v54, v55
    v_cvt_pk_bf16_f32 v100, v56, v57
    v_cvt_pk_bf16_f32 v101, v58, v59
    v_cvt_pk_bf16_f32 v104, v64, v65
    v_cvt_pk_bf16_f32 v109, v74, v75
    v_cvt_pk_bf16_f32 v102, v60, v61
    v_cvt_pk_bf16_f32 v103, v62, v63
    v_permlane16_swap_b32 v97, v99
    v_cvt_pk_bf16_f32 v110, v76, v77
    v_permlane16_swap_b32 v104, v106
    v_cvt_pk_bf16_f32 v111, v78, v79
    v_permlane16_swap_b32 v96, v98
    v_permlane16_swap_b32 v105, v107
    v_permlane16_swap_b32 v108, v110
    v_permlane16_swap_b32 v109, v111
    v_permlane16_swap_b32 v100, v102
    v_permlane16_swap_b32 v101, v103
    s_waitcnt lgkmcnt(0)
NOCONV:
    v_mfma_f32_16x16x32_bf16 v[112:115], a[144:147], a[120:123], v[112:115]
    ds_read_b64_tr_b16 a[176:177], v9 offset:28672
    v_mfma_f32_16x16x32_bf16 v[116:119], a[144:147], a[124:127], v[116:119]
    ds_read_b64_tr_b16 a[178:179], v9 offset:29184
    v_mfma_f32_16x16x32_bf16 v[124:127], a[148:151], a[124:127], v[124:127]
    ds_read_b64_tr_b16 a[180:181], v9 offset:40960
    v_mfma_f32_16x16x32_bf16 v[120:123], a[148:151], a[120:123], v[120:123]
    s_mov_b32 s62, 589824
    ds_read_b64_tr_b16 a[182:183], v9 offset:41472
    v_mfma_f32_16x16x32_bf16 v[112:115], a[152:155], a[128:131], v[112:115]
    buffer_store_dwordx4 v[96:99], v45, s[24:27], 0 offen sc1
    buffer_store_dwordx4 v[100:103], v45, s[24:27], s62 offen sc1
    buffer_load_dwordx4 v3, s[12:15], s60 offen offset:1024 lds
    ds_read_b64_tr_b16 a[184:185], v9 offset:32768
    v_mfma_f32_16x16x32_bf16 v[116:119], a[152:155], a[132:135], v[116:119]
    ds_read_b64_tr_b16 a[186:187], v9 offset:33280
    v_mfma_f32_16x16x32_bf16 v[124:127], a[156:159], a[132:135], v[124:127]
    ds_read_b64_tr_b16 a[188:189], v9 offset:45056
    v_mfma_f32_16x16x32_bf16 v[120:123], a[156:159], a[128:131], v[120:123]
    ds_read_b64_tr_b16 a[190:191], v9 offset:45568
    s_waitcnt lgkmcnt(8)
    v_mfma_f32_16x16x32_bf16 v[112:115], a[160:163], a[136:139], v[112:115]
    ds_read_b64_tr_b16 a[144:145], v10 offset:24576
    s_mov_b32 s62, 1179648
    v_mfma_f32_16x16x32_bf16 v[116:119], a[160:163], a[140:143], v[116:119]
    buffer_store_dwordx4 v[104:107], v45, s[24:27], s62 offen sc1
    ds_read_b64_tr_b16 a[146:147], v10 offset:25088
    buffer_load_dwordx4 v4, s[12:15], s60 offen offset:2048 lds
    v_mfma_f32_16x16x32_bf16 v[124:127], a[164:167], a[140:143], v[124:127]
    s_mov_b32 s62, 1769472
    ds_read_b64_tr_b16 a[148:149], v10 offset:36864
    v_mfma_f32_16x16x32_bf16 v[120:123], a[164:167], a[136:139], v[120:123]
    ds_read_b64_tr_b16 a[150:151], v10 offset:37376
    v_mfma_f32_16x16x32_bf16 v[128:131], a[168:171], a[120:123], v[128:131]
    ds_read_b64_tr_b16 a[152:153], v10 offset:28672
    v_mfma_f32_16x16x32_bf16 v[132:135], a[168:171], a[124:127], v[132:135]
    ds_read_b64_tr_b16 a[154:155], v10 offset:29184
    v_mul_f32 v50, s68, v114
    v_mfma_f32_16x16x32_bf16 v[140:143], a[172:175], a[124:127], v[140:143]
    buffer_store_dwordx4 v[108:111], v45, s[24:27], s62 offen sc1
    ds_read_b64_tr_b16 a[156:157], v10 offset:40960
    v_mul_f32 v48, s68, v112
    v_mul_f32 v49, s68, v113
    v_mfma_f32_16x16x32_bf16 v[136:139], a[172:175], a[120:123], v[136:139]
    s_waitcnt lgkmcnt(7)
    ds_read_b64_tr_b16 a[158:159], v10 offset:41472
    ds_read_b64_tr_b16 a[160:161], v10 offset:32768
    v_mfma_f32_16x16x32_bf16 v[128:131], a[176:179], a[128:131], v[128:131]
    s_waitcnt vmcnt(11)
    s_barrier
    v_mfma_f32_16x16x32_bf16 v[132:135], a[176:179], a[132:135], v[132:135]
    ds_read_b64_tr_b16 a[162:163], v10 offset:33280
    v_mul_f32 v51, s68, v115
    v_mfma_f32_16x16x32_bf16 v[140:143], a[180:183], a[132:135], v[140:143]
    ds_read_b64_tr_b16 a[164:165], v10 offset:45056
    v_mul_f32 v53, s68, v117
    v_mfma_f32_16x16x32_bf16 v[136:139], a[180:183], a[128:131], v[136:139]
    ds_read_b64_tr_b16 a[166:167], v10 offset:45568
    v_mul_f32 v54, s68, v118
    v_mfma_f32_16x16x32_bf16 v[128:131], a[184:187], a[136:139], v[128:131]
    s_add_u32 s60, s58, 0x1b0180
    ds_read_b64_tr_b16 a[168:169], v11 offset:24576
    v_mul_f32 v52, s68, v116
    v_mul_f32 v56, v112, v120
    v_mfma_f32_16x16x32_bf16 v[132:135], a[184:187], a[140:143], v[132:135]
    ds_read_b64_tr_b16 a[170:171], v11 offset:25088
    v_mul_f32 v57, v113, v121
    v_mfma_f32_16x16x32_bf16 v[140:143], a[188:191], a[140:143], v[140:143]
    s_add_u32 m0, s61, 0x0
    ds_read_b64_tr_b16 a[172:173], v11 offset:36864
    v_mul_f32 v58, v114, v122
    v_mul_f32 v55, s68, v119
    v_mfma_f32_16x16x32_bf16 v[136:139], a[188:191], a[136:139], v[136:139]
    s_waitcnt lgkmcnt(7)
    ds_read_b64_tr_b16 a[174:175], v11 offset:37376
    v_mul_f32 v60, v116, v124
    v_mul_f32 v62, v118, v126
    v_mfma_f32_16x16x32_bf16 v[144:147], a[144:147], a[120:123], v[144:147]
    ds_read_b64_tr_b16 a[176:177], v11 offset:28672
    v_mul_f32 v61, v117, v125
    v_mfma_f32_16x16x32_bf16 v[148:151], a[144:147], a[124:127], v[148:151]
    ds_read_b64_tr_b16 a[178:179], v11 offset:29184
    v_mul_f32 v64, s68, v128
    v_mfma_f32_16x16x32_bf16 v[156:159], a[148:151], a[124:127], v[156:159]
    ds_read_b64_tr_b16 a[180:181], v11 offset:40960
    v_mul_f32 v67, s68, v131
    v_mfma_f32_16x16x32_bf16 v[152:155], a[148:151], a[120:123], v[152:155]
    ds_read_b64_tr_b16 a[182:183], v11 offset:41472
    buffer_load_dwordx4 v2, s[8:11], s60 offen offset:0 lds
    ds_read_b64_tr_b16 a[184:185], v11 offset:32768
    v_mfma_f32_16x16x32_bf16 v[144:147], a[152:155], a[128:131], v[144:147]
    v_mul_f32 v59, v115, v123
    v_mul_f32 v63, v119, v127
    v_mfma_f32_16x16x32_bf16 v[148:151], a[152:155], a[132:135], v[148:151]
    ds_read_b64_tr_b16 a[186:187], v11 offset:33280
    v_mul_f32 v68, s68, v132
    v_mfma_f32_16x16x32_bf16 v[156:159], a[156:159], a[132:135], v[156:159]
    ds_read_b64_tr_b16 a[188:189], v11 offset:45056
    v_mul_f32 v66, s68, v130
    v_mfma_f32_16x16x32_bf16 v[152:155], a[156:159], a[128:131], v[152:155]
    s_waitcnt lgkmcnt(7)
    ds_read_b64_tr_b16 a[190:191], v11 offset:45568
    v_mul_f32 v75, v131, v139
    v_mfma_f32_16x16x32_bf16 v[144:147], a[160:163], a[136:139], v[144:147]
    ds_read_b64_tr_b16 a[144:145], v12 offset:0
    buffer_load_dwordx4 v3, s[8:11], s60 offen offset:1024 lds
    ds_read_b64_tr_b16 a[146:147], v12 offset:512
    v_mul_f32 v73, v129, v137
    v_mfma_f32_16x16x32_bf16 v[148:151], a[160:163], a[140:143], v[148:151]
    v_mul_f32 v76, v132, v140
    v_mul_f32 v72, v128, v136
    v_mul_f32 v70, s68, v134
    v_mul_f32 v77, v133, v141
    v_mul_f32 v74, v130, v138
    v_mul_f32 v69, s68, v133
    v_mfma_f32_16x16x32_bf16 v[156:159], a[164:167], a[140:143], v[156:159]
    ds_read_b64_tr_b16 a[148:149], v12 offset:12288
    v_mul_f32 v65, s68, v129
    v_mfma_f32_16x16x32_bf16 v[152:155], a[164:167], a[136:139], v[152:155]
    ds_read_b64_tr_b16 a[150:151], v12 offset:12800
    v_mul_f32 v78, v134, v142
    v_mfma_f32_16x16x32_bf16 v[160:163], a[168:171], a[120:123], v[160:163]
    ds_read_b64_tr_b16 a[152:153], v12 offset:4096
    v_mul_f32 v71, s68, v135
    v_mfma_f32_16x16x32_bf16 v[164:167], a[168:171], a[124:127], v[164:167]
    buffer_load_dwordx4 v4, s[8:11], s60 offen offset:2048 lds
    ds_read_b64_tr_b16 a[154:155], v12 offset:4608
    v_mfma_f32_16x16x32_bf16 v[172:175], a[172:175], a[124:127], v[172:175]
    ds_read_b64_tr_b16 a[156:157], v12 offset:16384
    v_mul_f32 v80, s68, v144
    v_mfma_f32_16x16x32_bf16 v[168:171], a[172:175], a[120:123], v[168:171]
    s_waitcnt lgkmcnt(7)
    ds_read_b64_tr_b16 a[158:159], v12 offset:16896
    v_mul_f32 v79, v135, v143
    v_mfma_f32_16x16x32_bf16 v[160:163], a[176:179], a[128:131], v[160:163]
    ds_read_b64_tr_b16 a[160:161], v12 offset:8192
    v_mul_f32 v83, s68, v147
    v_mfma_f32_16x16x32_bf16 v[164:167], a[176:179], a[132:135], v[164:167]
    ds_read_b64_tr_b16 a[162:163], v12 offset:8704
    v_mul_f32 v81, s68, v145
    v_mul_f32 v90, v146, v154
    v_mul_f32 v86, s68, v150
    v_mfma_f32_16x16x32_bf16 v[172:175], a[180:183], a[132:135], v[172:175]
    ds_read_b64_tr_b16 a[164:165], v12 offset:20480
    v_mul_f32 v85, s68, v149
    v_mfma_f32_16x16x32_bf16 v[168:171], a[180:183], a[128:131], v[168:171]
    ds_read_b64_tr_b16 a[166:167], v12 offset:20992
    v_mul_f32 v82, s68, v146
    v_mfma_f32_16x16x32_bf16 v[160:163], a[184:187], a[136:139], v[160:163]
    s_add_u32 m0, s61, 0x3000
    ds_read_b64_tr_b16 a[168:169], v13 offset:0
    v_mul_f32 v88, v144, v152
    v_mfma_f32_16x16x32_bf16 v[164:167], a[184:187], a[140:143], v[164:167]
    ds_read_b64_tr_b16 a[170:171], v13 offset:512
    v_mul_f32 v92, v148, v156
    v_mfma_f32_16x16x32_bf16 v[172:175], a[188:191], a[140:143], v[172:175]
    ds_read_b64_tr_b16 a[172:173], v13 offset:12288
    v_mul_f32 v87, s68, v151
    v_mfma_f32_16x16x32_bf16 v[168:171], a[188:191], a[136:139], v[168:171]
    s_waitcnt lgkmcnt(7)
    ds_read_b64_tr_b16 a[174:175], v13 offset:12800
    buffer_load_dwordx4 v2, s[12:15], s60 offen offset:0 lds
    v_mfma_f32_16x16x32_bf16 v[112:115], a[144:147], a[0:3], 0
    ds_read_b64_tr_b16 a[176:177], v13 offset:4096
    v_mul_f32 v95, v151, v159
    v_mul_f32 v93, v149, v157
    v_mul_f32 v91, v147, v155
    v_mfma_f32_16x16x32_bf16 v[116:119], a[144:147], a[4:7], 0
    ds_read_b64_tr_b16 a[178:179], v13 offset:4608
    v_mul_f32 v84, s68, v148
    v_mfma_f32_16x16x32_bf16 v[124:127], a[148:151], a[4:7], 0
    ds_read_b64_tr_b16 a[180:181], v13 offset:16384
    v_mul_f32 v97, s68, v161
    v_mfma_f32_16x16x32_bf16 v[120:123], a[148:151], a[0:3], 0
    ds_read_b64_tr_b16 a[182:183], v13 offset:16896
    v_mul_f32 v94, v150, v158
    v_mfma_f32_16x16x32_bf16 v[112:115], a[152:155], a[8:11], v[112:115]
    buffer_load_dwordx4 v3, s[12:15], s60 offen offset:1024 lds
    ds_read_b64_tr_b16 a[184:185], v13 offset:8192
    v_mul_f32 v89, v145, v153
    v_mul_f32 v96, s68, v160
    v_mfma_f32_16x16x32_bf16 v[116:119], a[152:155], a[12:15], v[116:119]
    ds_read_b64_tr_b16 a[186:187], v13 offset:8704
    v_mul_f32 v99, s68, v163
    v_mul_f32 v98, s68, v162
    v_mfma_f32_16x16x32_bf16 v[124:127], a[156:159], a[12:15], v[124:127]
    ds_read_b64_tr_b16 a[188:189], v13 offset:20480
    v_mul_f32 v100, s68, v164
    v_mfma_f32_16x16x32_bf16 v[120:123], a[156:159], a[8:11], v[120:123]
    s_waitcnt lgkmcnt(7)
    ds_read_b64_tr_b16 a[190:191], v13 offset:20992
    v_mul_f32 v103, s68, v167
    v_mfma_f32_16x16x32_bf16 v[112:115], a[160:163], a[16:19], v[112:115]
    ds_read_b64_tr_b16 a[144:145], v14 offset:0
    v_mul_f32 v101, s68, v165
    v_mul_f32 v104, v160, v168
    v_mul_f32 v105, v161, v169
    v_mfma_f32_16x16x32_bf16 v[116:119], a[160:163], a[20:23], v[116:119]
    buffer_load_dwordx4 v4, s[12:15], s60 offen offset:2048 lds
    ds_read_b64_tr_b16 a[146:147], v14 offset:512
    v_mfma_f32_16x16x32_bf16 v[124:127], a[164:167], a[20:23], v[124:127]
    ds_read_b64_tr_b16 a[148:149], v14 offset:12288
    v_mul_f32 v106, v162, v170
    v_mfma_f32_16x16x32_bf16 v[120:123], a[164:167], a[16:19], v[120:123]
    ds_read_b64_tr_b16 a[150:151], v14 offset:12800
    v_mul_f32 v102, s68, v166
    v_mfma_f32_16x16x32_bf16 v[128:131], a[168:171], a[0:3], 0
    ds_read_b64_tr_b16 a[152:153], v14 offset:4096
    v_mul_f32 v109, v165, v173
    v_mfma_f32_16x16x32_bf16 v[132:135], a[168:171], a[4:7], 0
    ds_read_b64_tr_b16 a[154:155], v14 offset:4608
    v_mul_f32 v110, v166, v174
    v_mul_f32 v111, v167, v175
    v_mfma_f32_16x16x32_bf16 v[140:143], a[172:175], a[4:7], 0
    ds_read_b64_tr_b16 a[156:157], v14 offset:16384
    v_mul_f32 v107, v163, v171
    v_mfma_f32_16x16x32_bf16 v[136:139], a[172:175], a[0:3], 0
    s_waitcnt lgkmcnt(7)
    ds_read_b64_tr_b16 a[158:159], v14 offset:16896
    v_exp_f32 v48, v48
    v_mfma_f32_16x16x32_bf16 v[128:131], a[176:179], a[8:11], v[128:131]
    s_waitcnt vmcnt(7)
    ds_read_b64_tr_b16 a[160:161], v14 offset:8192
    s_barrier
    v_mfma_f32_16x16x32_bf16 v[132:135], a[176:179], a[12:15], v[132:135]
    ds_read_b64_tr_b16 a[162:163], v14 offset:8704
    v_exp_f32 v49, v49
    v_mfma_f32_16x16x32_bf16 v[140:143], a[180:183], a[12:15], v[140:143]
    ds_read_b64_tr_b16 a[164:165], v14 offset:20480
    v_mul_f32 v108, v164, v172
    v_mfma_f32_16x16x32_bf16 v[136:139], a[180:183], a[8:11], v[136:139]
    v_exp_f32 v50, v50
    v_mfma_f32_16x16x32_bf16 v[128:131], a[184:187], a[16:19], v[128:131]
    ds_read_b64_tr_b16 a[166:167], v14 offset:20992
    ds_read_b64_tr_b16 a[168:169], v15 offset:0
    v_mfma_f32_16x16x32_bf16 v[132:135], a[184:187], a[20:23], v[132:135]
    v_exp_f32 v51, v51
    v_mfma_f32_16x16x32_bf16 v[140:143], a[188:191], a[20:23], v[140:143]
    s_add_u32 s60, s58, 0x288180
    ds_read_b64_tr_b16 a[170:171], v15 offset:512
    ds_read_b64_tr_b16 a[172:173], v15 offset:12288
    v_mfma_f32_16x16x32_bf16 v[136:139], a[188:191], a[16:19], v[136:139]
    s_waitcnt lgkmcnt(7)
    ds_read_b64_tr_b16 a[174:175], v15 offset:12800
    v_add_f32 v48, 1.0, v48
    v_mfma_f32_16x16x32_bf16 v[144:147], a[144:147], a[0:3], 0
    ds_read_b64_tr_b16 a[176:177], v15 offset:4096
    v_add_f32 v49, 1.0, v49
    v_mfma_f32_16x16x32_bf16 v[148:151], a[144:147], a[4:7], 0
    ds_read_b64_tr_b16 a[178:179], v15 offset:4608
    v_add_f32 v50, 1.0, v50
    v_mfma_f32_16x16x32_bf16 v[156:159], a[148:151], a[4:7], 0
    s_add_u32 m0, s61, 0x6000
    ds_read_b64_tr_b16 a[180:181], v15 offset:16384
    v_add_f32 v51, 1.0, v51
    v_mfma_f32_16x16x32_bf16 v[152:155], a[148:151], a[0:3], 0
    ds_read_b64_tr_b16 a[182:183], v15 offset:16896
    buffer_load_dwordx4 v2, s[8:11], s60 offen offset:0 lds
    v_mfma_f32_16x16x32_bf16 v[144:147], a[152:155], a[8:11], v[144:147]
    v_rcp_f32 v48, v48
    v_mfma_f32_16x16x32_bf16 v[148:151], a[152:155], a[12:15], v[148:151]
    ds_read_b64_tr_b16 a[184:185], v15 offset:8192
    ds_read_b64_tr_b16 a[186:187], v15 offset:8704
    v_mfma_f32_16x16x32_bf16 v[156:159], a[156:159], a[12:15], v[156:159]
    ds_read_b64_tr_b16 a[188:189], v15 offset:20480
    v_rcp_f32 v49, v49
    v_mfma_f32_16x16x32_bf16 v[152:155], a[156:159], a[8:11], v[152:155]
    s_waitcnt lgkmcnt(7)
    ds_read_b64_tr_b16 a[190:191], v15 offset:20992
    ds_read_b64_tr_b16 a[144:145], v12 offset:24576
    v_mfma_f32_16x16x32_bf16 v[144:147], a[160:163], a[16:19], v[144:147]
    buffer_load_dwordx4 v3, s[8:11], s60 offen offset:1024 lds
    v_mfma_f32_16x16x32_bf16 v[148:151], a[160:163], a[20:23], v[148:151]
    v_rcp_f32 v50, v50
    v_mfma_f32_16x16x32_bf16 v[156:159], a[164:167], a[20:23], v[156:159]
    ds_read_b64_tr_b16 a[146:147], v12 offset:25088
    ds_read_b64_tr_b16 a[148:149], v12 offset:36864
    v_mfma_f32_16x16x32_bf16 v[152:155], a[164:167], a[16:19], v[152:155]
    ds_read_b64_tr_b16 a[150:151], v12 offset:37376
    v_rcp_f32 v51, v51
    v_mfma_f32_16x16x32_bf16 v[160:163], a[168:171], a[0:3], 0
    ds_read_b64_tr_b16 a[152:153], v13 offset:24576
    v_mul_f32 v56, v56, v48
    v_mfma_f32_16x16x32_bf16 v[164:167], a[168:171], a[4:7], 0
    ds_read_b64_tr_b16 a[154:155], v13 offset:25088
    buffer_load_dwordx4 v4, s[8:11], s60 offen offset:2048 lds
    v_mfma_f32_16x16x32_bf16 v[172:175], a[172:175], a[4:7], 0
    ds_read_b64_tr_b16 a[156:157], v13 offset:36864
    v_mul_f32 v57, v57, v49
    v_mfma_f32_16x16x32_bf16 v[168:171], a[172:175], a[0:3], 0
    s_waitcnt lgkmcnt(7)
    ds_read_b64_tr_b16 a[158:159], v13 offset:37376
    v_mul_f32 v58, v58, v50
    v_mfma_f32_16x16x32_bf16 v[160:163], a[176:179], a[8:11], v[160:163]
    ds_read_b64_tr_b16 a[160:161], v14 offset:24576
    v_mul_f32 v59, v59, v51
    v_mfma_f32_16x16x32_bf16 v[164:167], a[176:179], a[12:15], v[164:167]
    ds_read_b64_tr_b16 a[162:163], v14 offset:25088
    v_cvt_pk_bf16_f32 v208, v56, v57
    v_mfma_f32_16x16x32_bf16 v[172:175], a[180:183], a[12:15], v[172:175]
    s_add_u32 m0, s61, 0x9000
    ds_read_b64_tr_b16 a[164:165], v14 offset:36864
    v_cvt_pk_bf16_f32 v209, v58, v59
    v_mfma_f32_16x16x32_bf16 v[168:171], a[180:183], a[8:11], v[168:171]
    v_exp_f32 v52, v52
    v_mfma_f32_16x16x32_bf16 v[160:163], a[184:187], a[16:19], v[160:163]
    ds_read_b64_tr_b16 a[166:167], v14 offset:37376
    ds_read_b64_tr_b16 a[168:169], v15 offset:24576
    v_mfma_f32_16x16x32_bf16 v[164:167], a[184:187], a[20:23], v[164:167]
    v_exp_f32 v53, v53
    v_mfma_f32_16x16x32_bf16 v[172:175], a[188:191], a[20:23], v[172:175]
    ds_read_b64_tr_b16 a[170:171], v15 offset:25088
    ds_read_b64_tr_b16 a[172:173], v15 offset:36864
    v_mfma_f32_16x16x32_bf16 v[168:171], a[188:191], a[16:19], v[168:171]
    s_waitcnt lgkmcnt(7)
    ds_read_b64_tr_b16 a[174:175], v15 offset:37376
    ds_read_b64_tr_b16 a[176:177], v12 offset:28672
    v_mfma_f32_16x16x32_bf16 v[112:115], a[144:147], a[24:27], v[112:115]
    v_exp_f32 v54, v54
    v_mfma_f32_16x16x32_bf16 v[116:119], a[144:147], a[28:31], v[116:119]
    buffer_load_dwordx4 v2, s[12:15], s60 offen offset:0 lds
    ds_read_b64_tr_b16 a[178:179], v12 offset:29184
    v_mfma_f32_16x16x32_bf16 v[124:127], a[148:151], a[28:31], v[124:127]
    ds_read_b64_tr_b16 a[180:181], v12 offset:40960
    v_exp_f32 v55, v55
    v_mfma_f32_16x16x32_bf16 v[120:123], a[148:151], a[24:27], v[120:123]
    ds_read_b64_tr_b16 a[182:183], v12 offset:41472
    v_add_f32 v52, 1.0, v52
    v_mfma_f32_16x16x32_bf16 v[128:131], a[152:155], a[24:27], v[128:131]
    buffer_load_dwordx4 v3, s[12:15], s60 offen offset:1024 lds
    ds_read_b64_tr_b16 a[184:185], v13 offset:28672
    v_mfma_f32_16x16x32_bf16 v[132:135], a[152:155], a[28:31], v[132:135]
    ds_read_b64_tr_b16 a[186:187], v13 offset:29184
    v_add_f32 v53, 1.0, v53
    v_mfma_f32_16x16x32_bf16 v[140:143], a[156:159], a[28:31], v[140:143]
    ds_read_b64_tr_b16 a[188:189], v13 offset:40960
    v_add_f32 v54, 1.0, v54
    v_mfma_f32_16x16x32_bf16 v[136:139], a[156:159], a[24:27], v[136:139]
    s_waitcnt lgkmcnt(7)
    ds_read_b64_tr_b16 a[190:191], v13 offset:41472
    ds_read_b64_tr_b16 a[144:145], v14 offset:28672
    v_mfma_f32_16x16x32_bf16 v[144:147], a[160:163], a[24:27], v[144:147]
    v_rcp_f32 v52, v52
    v_mfma_f32_16x16x32_bf16 v[148:151], a[160:163], a[28:31], v[148:151]
    buffer_load_dwordx4 v4, s[12:15], s60 offen offset:2048 lds
    ds_read_b64_tr_b16 a[146:147], v14 offset:29184
    v_mfma_f32_16x16x32_bf16 v[156:159], a[164:167], a[28:31], v[156:159]
    ds_read_b64_tr_b16 a[148:149], v14 offset:40960
    v_add_f32 v55, 1.0, v55
    v_mfma_f32_16x16x32_bf16 v[152:155], a[164:167], a[24:27], v[152:155]
    v_rcp_f32 v53, v53
    v_mfma_f32_16x16x32_bf16 v[160:163], a[168:171], a[24:27], v[160:163]
    ds_read_b64_tr_b16 a[150:151], v14 offset:41472
    ds_read_b64_tr_b16 a[152:153], v15 offset:28672
    v_mfma_f32_16x16x32_bf16 v[164:167], a[168:171], a[28:31], v[164:167]
    v_rcp_f32 v54, v54
    v_mfma_f32_16x16x32_bf16 v[172:175], a[172:175], a[28:31], v[172:175]
    ds_read_b64_tr_b16 a[154:155], v15 offset:29184
    ds_read_b64_tr_b16 a[156:157], v15 offset:40960
    v_mfma_f32_16x16x32_bf16 v[168:171], a[172:175], a[24:27], v[168:171]
    s_waitcnt lgkmcnt(7)
    ds_read_b64_tr_b16 a[158:159], v15 offset:41472
    v_rcp_f32 v55, v55
    v_mfma_f32_16x16x32_bf16 v[112:115], a[176:179], a[32:35], v[112:115]
    s_waitcnt vmcnt(6)
    ds_read_b64_tr_b16 a[160:161], v12 offset:32768
    s_barrier
    v_mfma_f32_16x16x32_bf16 v[116:119], a[176:179], a[36:39], v[116:119]
    ds_read_b64_tr_b16 a[162:163], v12 offset:33280
    buffer_store_dword v43, v42, s[24:27], s42 offen offset:0 sc1
    v_mfma_f32_16x16x32_bf16 v[124:127], a[180:183], a[36:39], v[124:127]
    ds_read_b64_tr_b16 a[164:165], v12 offset:45056
    v_mul_f32 v60, v60, v52
    v_mfma_f32_16x16x32_bf16 v[120:123], a[180:183], a[32:35], v[120:123]
    ds_read_b64_tr_b16 a[166:167], v12 offset:45568
    v_mul_f32 v61, v61, v53
    v_mfma_f32_16x16x32_bf16 v[128:131], a[184:187], a[32:35], v[128:131]
    ds_read_b64_tr_b16 a[168:169], v13 offset:32768
    v_mul_f32 v62, v62, v54
    v_mfma_f32_16x16x32_bf16 v[132:135], a[184:187], a[36:39], v[132:135]
    s_add_u32 s60, s58, 0x360180
    ds_read_b64_tr_b16 a[170:171], v13 offset:33280
    v_mul_f32 v63, v63, v55
    v_mfma_f32_16x16x32_bf16 v[140:143], a[188:191], a[36:39], v[140:143]
    ds_read_b64_tr_b16 a[172:173], v13 offset:45056
    v_cvt_pk_bf16_f32 v212, v60, v61
    v_mfma_f32_16x16x32_bf16 v[136:139], a[188:191], a[32:35], v[136:139]
    v_cvt_pk_bf16_f32 v213, v62, v63
    s_waitcnt lgkmcnt(7)
    v_mfma_f32_16x16x32_bf16 v[144:147], a[144:147], a[32:35], v[144:147]
    ds_read_b64_tr_b16 a[174:175], v13 offset:45568
    ds_read_b64_tr_b16 a[176:177], v14 offset:32768
    v_mfma_f32_16x16x32_bf16 v[148:151], a[144:147], a[36:39], v[148:151]
    ds_read_b64_tr_b16 a[178:179], v14 offset:33280
    v_exp_f32 v64, v64
    v_mfma_f32_16x16x32_bf16 v[156:159], a[148:151], a[36:39], v[156:159]
    s_add_u32 m0, s61, 0xc000
    v_exp_f32 v65, v65
    v_mfma_f32_16x16x32_bf16 v[152:155], a[148:151], a[32:35], v[152:155]
    ds_read_b64_tr_b16 a[180:181], v14 offset:45056
    buffer_load_dwordx4 v2, s[8:11], s60 offen offset:0 lds
    v_mfma_f32_16x16x32_bf16 v[160:163], a[152:155], a[32:35], v[160:163]
    ds_read_b64_tr_b16 a[182:183], v14 offset:45568
    ds_read_b64_tr_b16 a[184:185], v15 offset:32768
    v_mfma_f32_16x16x32_bf16 v[164:167], a[152:155], a[36:39], v[164:167]
    v_exp_f32 v66, v66
    v_mfma_f32_16x16x32_bf16 v[172:175], a[156:159], a[36:39], v[172:175]
    ds_read_b64_tr_b16 a[186:187], v15 offset:33280
    ds_read_b64_tr_b16 a[188:189], v15 offset:45056
    v_mfma_f32_16x16x32_bf16 v[168:171], a[156:159], a[32:35], v[168:171]
    s_waitcnt lgkmcnt(7)
    ds_read_b64_tr_b16 a[190:191], v15 offset:45568
    ds_read_b64_tr_b16 a[144:145], v8 offset:0
    v_mfma_f32_16x16x32_bf16 v[112:115], a[160:163], a[40:43], v[112:115]
    buffer_load_dwordx4 v3, s[8:11], s60 offen offset:1024 lds
    v_mfma_f32_16x16x32_bf16 v[116:119], a[160:163], a[44:47], v[116:119]
    ds_read_b64_tr_b16 a[146:147], v8 offset:512
    v_exp_f32 v67, v67
    v_mfma_f32_16x16x32_bf16 v[124:127], a[164:167], a[44:47], v[124:127]
    ds_read_b64_tr_b16 a[148:149], v8 offset:12288
    v_add_f32 v65, 1.0, v65
    v_mfma_f32_16x16x32_bf16 v[120:123], a[164:167], a[40:43], v[120:123]
    ds_read_b64_tr_b16 a[150:151], v8 offset:12800
    v_add_f32 v66, 1.0, v66
    v_mfma_f32_16x16x32_bf16 v[128:131], a[168:171], a[40:43], v[128:131]
    ds_read_b64_tr_b16 a[152:153], v9 offset:0
    v_add_f32 v67, 1.0, v67
    v_mfma_f32_16x16x32_bf16 v[132:135], a[168:171], a[44:47], v[132:135]
    ds_read_b64_tr_b16 a[154:155], v9 offset:512
    buffer_load_dwordx4 v4, s[8:11], s60 offen offset:2048 lds
    v_mfma_f32_16x16x32_bf16 v[140:143], a[172:175], a[44:47], v[140:143]
    ds_read_b64_tr_b16 a[156:157], v9 offset:12288
    v_add_f32 v64, 1.0, v64
    v_mfma_f32_16x16x32_bf16 v[136:139], a[172:175], a[40:43], v[136:139]
    s_waitcnt lgkmcnt(7)
    ds_read_b64_tr_b16 a[158:159], v9 offset:12800
    ds_read_b64_tr_b16 a[160:161], v10 offset:0
    v_mfma_f32_16x16x32_bf16 v[144:147], a[176:179], a[40:43], v[144:147]
    ds_read_b64_tr_b16 a[162:163], v10 offset:512
    v_rcp_f32 v65, v65
    v_mfma_f32_16x16x32_bf16 v[148:151], a[176:179], a[44:47], v[148:151]
    v_rcp_f32 v64, v64
    v_mfma_f32_16x16x32_bf16 v[156:159], a[180:183], a[44:47], v[156:159]
    ds_read_b64_tr_b16 a[164:165], v10 offset:12288
    ds_read_b64_tr_b16 a[166:167], v10 offset:12800
    v_mfma_f32_16x16x32_bf16 v[152:155], a[180:183], a[40:43], v[152:155]
    s_add_u32 m0, s61, 0xf000
    v_rcp_f32 v66, v66
    v_mfma_f32_16x16x32_bf16 v[160:163], a[184:187], a[40:43], v[160:163]
    v_rcp_f32 v67, v67
    v_mfma_f32_16x16x32_bf16 v[164:167], a[184:187], a[44:47], v[164:167]
    ds_read_b64_tr_b16 a[168:169], v11 offset:0
    buffer_load_dwordx4 v2, s[12:15], s60 offen offset:0 lds
    ds_read_b64_tr_b16 a[170:171], v11 offset:512
    v_mfma_f32_16x16x32_bf16 v[172:175], a[188:191], a[44:47], v[172:175]
    ds_read_b64_tr_b16 a[172:173], v11 offset:12288
    v_mul_f32 v72, v72, v64
    v_mfma_f32_16x16x32_bf16 v[168:171], a[188:191], a[40:43], v[168:171]
    s_waitcnt lgkmcnt(7)
    ds_read_b64_tr_b16 a[174:175], v11 offset:12800
    ds_read_b64_tr_b16 a[176:177], v8 offset:4096
    v_mfma_f32_16x16x32_bf16 v[112:115], a[144:147], a[48:51], v[112:115]
    v_mul_f32 v74, v74, v66
    v_mul_f32 v73, v73, v65
    v_mfma_f32_16x16x32_bf16 v[116:119], a[144:147], a[52:55], v[116:119]
    ds_read_b64_tr_b16 a[178:179], v8 offset:4608
    v_mul_f32 v75, v75, v67
    v_mfma_f32_16x16x32_bf16 v[124:127], a[148:151], a[52:55], v[124:127]
    ds_read_b64_tr_b16 a[180:181], v8 offset:16384
    v_cvt_pk_bf16_f32 v210, v72, v73
    v_mfma_f32_16x16x32_bf16 v[120:123], a[148:151], a[48:51], v[120:123]
    ds_read_b64_tr_b16 a[182:183], v8 offset:16896
    v_cvt_pk_bf16_f32 v211, v74, v75
    v_mfma_f32_16x16x32_bf16 v[128:131], a[152:155], a[48:51], v[128:131]
    buffer_load_dwordx4 v3, s[12:15], s60 offen offset:1024 lds
    v_mfma_f32_16x16x32_bf16 v[132:135], a[152:155], a[52:55], v[132:135]
    ds_read_b64_tr_b16 a[184:185], v9 offset:4096
    v_mfma_f32_16x16x32_bf16 v[140:143], a[156:159], a[52:55], v[140:143]
    ds_read_b64_tr_b16 a[186:187], v9 offset:4608
    ds_read_b64_tr_b16 a[188:189], v9 offset:16384
    v_mfma_f32_16x16x32_bf16 v[136:139], a[156:159], a[48:51], v[136:139]
    ds_read_b64_tr_b16 a[190:191], v9 offset:16896
    s_waitcnt lgkmcnt(8)
    v_mfma_f32_16x16x32_bf16 v[144:147], a[160:163], a[48:51], v[144:147]
    buffer_store_dwordx4 v[208:211], v40, s[24:27], s81 offen offset:0 sc1
    ds_read_b64_tr_b16 a[144:145], v10 offset:4096
    v_exp_f32 v68, v68
    v_mfma_f32_16x16x32_bf16 v[148:151], a[160:163], a[52:55], v[148:151]
    buffer_load_dwordx4 v4, s[12:15], s60 offen offset:2048 lds
    v_mfma_f32_16x16x32_bf16 v[156:159], a[164:167], a[52:55], v[156:159]
    ds_read_b64_tr_b16 a[146:147], v10 offset:4608
    ds_read_b64_tr_b16 a[148:149], v10 offset:16384
    v_mfma_f32_16x16x32_bf16 v[152:155], a[164:167], a[48:51], v[152:155]
    v_exp_f32 v69, v69
    v_mfma_f32_16x16x32_bf16 v[160:163], a[168:171], a[48:51], v[160:163]
    ds_read_b64_tr_b16 a[150:151], v10 offset:16896
    ds_read_b64_tr_b16 a[152:153], v11 offset:4096
    v_mfma_f32_16x16x32_bf16 v[164:167], a[168:171], a[52:55], v[164:167]
    ds_read_b64_tr_b16 a[154:155], v11 offset:4608
    v_exp_f32 v70, v70
    v_mfma_f32_16x16x32_bf16 v[172:175], a[172:175], a[52:55], v[172:175]
    ds_read_b64_tr_b16 a[156:157], v11 offset:16384
    v_exp_f32 v71, v71
    v_mfma_f32_16x16x32_bf16 v[168:171], a[172:175], a[48:51], v[168:171]
    s_waitcnt lgkmcnt(7)
    ds_read_b64_tr_b16 a[158:159], v11 offset:16896
    ds_read_b64_tr_b16 a[160:161], v8 offset:8192
    v_mfma_f32_16x16x32_bf16 v[112:115], a[176:179], a[56:59], v[112:115]
    s_waitcnt vmcnt(8)
    s_barrier
    v_mfma_f32_16x16x32_bf16 v[116:119], a[176:179], a[60:63], v[116:119]
    ds_read_b64_tr_b16 a[162:163], v8 offset:8704
    v_add_f32 v68, 1.0, v68
    v_mfma_f32_16x16x32_bf16 v[124:127], a[180:183], a[60:63], v[124:127]
    ds_read_b64_tr_b16 a[164:165], v8 offset:20480
    v_add_f32 v69, 1.0, v69
    v_mfma_f32_16x16x32_bf16 v[120:123], a[180:183], a[56:59], v[120:123]
    ds_read_b64_tr_b16 a[166:167], v8 offset:20992
    v_add_f32 v70, 1.0, v70
    v_mfma_f32_16x16x32_bf16 v[128:131], a[184:187], a[56:59], v[128:131]
    ds_read_b64_tr_b16 a[168:169], v9 offset:8192
    v_add_f32 v71, 1.0, v71
    v_mfma_f32_16x16x32_bf16 v[132:135], a[184:187], a[60:63], v[132:135]
    s_add_u32 s60, s58, 0x438180
    ds_read_b64_tr_b16 a[170:171], v9 offset:8704
    v_rcp_f32 v68, v68
    v_mfma_f32_16x16x32_bf16 v[140:143], a[188:191], a[60:63], v[140:143]
    ds_read_b64_tr_b16 a[172:173], v9 offset:20480
    s_add_u32 m0, s61, 0x12000
    v_mfma_f32_16x16x32_bf16 v[136:139], a[188:191], a[56:59], v[136:139]
    s_waitcnt lgkmcnt(7)
    v_rcp_f32 v69, v69
    v_mfma_f32_16x16x32_bf16 v[144:147], a[144:147], a[56:59], v[144:147]
    ds_read_b64_tr_b16 a[174:175], v9 offset:20992
    ds_read_b64_tr_b16 a[176:177], v10 offset:8192
    v_mfma_f32_16x16x32_bf16 v[148:151], a[144:147], a[60:63], v[148:151]
    v_rcp_f32 v70, v70
    v_mfma_f32_16x16x32_bf16 v[156:159], a[148:151], a[60:63], v[156:159]
    ds_read_b64_tr_b16 a[178:179], v10 offset:8704
    ds_read_b64_tr_b16 a[180:181], v10 offset:20480
    v_mfma_f32_16x16x32_bf16 v[152:155], a[148:151], a[56:59], v[152:155]
    buffer_load_dwordx4 v2, s[8:11], s60 offen offset:0 lds
    ds_read_b64_tr_b16 a[182:183], v10 offset:20992
    v_mfma_f32_16x16x32_bf16 v[160:163], a[152:155], a[56:59], v[160:163]
    ds_read_b64_tr_b16 a[184:185], v11 offset:8192
    v_rcp_f32 v71, v71
    v_mfma_f32_16x16x32_bf16 v[164:167], a[152:155], a[60:63], v[164:167]
    ds_read_b64_tr_b16 a[186:187], v11 offset:8704
    v_mul_f32 v76, v76, v68
    v_mfma_f32_16x16x32_bf16 v[172:175], a[156:159], a[60:63], v[172:175]
    ds_read_b64_tr_b16 a[188:189], v11 offset:20480
    v_mul_f32 v77, v77, v69
    v_mfma_f32_16x16x32_bf16 v[168:171], a[156:159], a[56:59], v[168:171]
    s_waitcnt lgkmcnt(7)
    ds_read_b64_tr_b16 a[190:191], v11 offset:20992
    v_mul_f32 v78, v78, v70
    v_mfma_f32_16x16x32_bf16 v[112:115], a[160:163], a[64:67], v[112:115]
    buffer_load_dwordx4 v3, s[8:11], s60 offen offset:1024 lds
    v_mfma_f32_16x16x32_bf16 v[116:119], a[160:163], a[68:71], v[116:119]
    ds_read_b64_tr_b16 a[144:145], v8 offset:24576
    ds_read_b64_tr_b16 a[146:147], v8 offset:25088
    v_mfma_f32_16x16x32_bf16 v[124:127], a[164:167], a[68:71], v[124:127]
    ds_read_b64_tr_b16 a[148:149], v8 offset:36864
    v_cvt_pk_bf16_f32 v214, v76, v77
    v_mfma_f32_16x16x32_bf16 v[120:123], a[164:167], a[64:67], v[120:123]
    ds_read_b64_tr_b16 a[150:151], v8 offset:37376
    ds_read_b64_tr_b16 a[152:153], v9 offset:24576
    v_mfma_f32_16x16x32_bf16 v[128:131], a[168:171], a[64:67], v[128:131]
    ds_read_b64_tr_b16 a[154:155], v9 offset:25088
    v_mul_f32 v79, v79, v71
    v_mfma_f32_16x16x32_bf16 v[132:135], a[168:171], a[68:71], v[132:135]
    buffer_load_dwordx4 v4, s[8:11], s60 offen offset:2048 lds
    v_mfma_f32_16x16x32_bf16 v[140:143], a[172:175], a[68:71], v[140:143]
    ds_read_b64_tr_b16 a[156:157], v9 offset:36864
    v_mfma_f32_16x16x32_bf16 v[136:139], a[172:175], a[64:67], v[136:139]
    s_waitcnt lgkmcnt(7)
    ds_read_b64_tr_b16 a[158:159], v9 offset:37376
    v_cvt_pk_bf16_f32 v215, v78, v79
    v_mfma_f32_16x16x32_bf16 v[144:147], a[176:179], a[64:67], v[144:147]
    buffer_store_dwordx4 v[212:215], v40, s[24:27], s81 offen offset:1024 sc1
    ds_read_b64_tr_b16 a[160:161], v10 offset:24576
    v_exp_f32 v80, v80
    v_mfma_f32_16x16x32_bf16 v[148:151], a[176:179], a[68:71], v[148:151]
    ds_read_b64_tr_b16 a[162:163], v10 offset:25088
    ds_read_b64_tr_b16 a[164:165], v10 offset:36864
    v_mfma_f32_16x16x32_bf16 v[156:159], a[180:183], a[68:71], v[156:159]
    v_exp_f32 v81, v81
    v_mfma_f32_16x16x32_bf16 v[152:155], a[180:183], a[64:67], v[152:155]
    s_add_u32 m0, s61, 0x15000
    ds_read_b64_tr_b16 a[166:167], v10 offset:37376
    ds_read_b64_tr_b16 a[168:169], v11 offset:24576
    v_mfma_f32_16x16x32_bf16 v[160:163], a[184:187], a[64:67], v[160:163]
    ds_read_b64_tr_b16 a[170:171], v11 offset:25088
    v_exp_f32 v82, v82
    v_mfma_f32_16x16x32_bf16 v[164:167], a[184:187], a[68:71], v[164:167]
    ds_read_b64_tr_b16 a[172:173], v11 offset:36864
    v_exp_f32 v83, v83
    v_mfma_f32_16x16x32_bf16 v[172:175], a[188:191], a[68:71], v[172:175]
    buffer_load_dwordx4 v2, s[12:15], s60 offen offset:0 lds
    v_mfma_f32_16x16x32_bf16 v[168:171], a[188:191], a[64:67], v[168:171]
    s_waitcnt lgkmcnt(7)
    ds_read_b64_tr_b16 a[174:175], v11 offset:37376
    v_add_f32 v83, 1.0, v83
    v_mfma_f32_16x16x32_bf16 v[112:115], a[144:147], a[72:75], v[112:115]
    ds_read_b64_tr_b16 a[176:177], v8 offset:28672
    v_add_f32 v80, 1.0, v80
    v_mfma_f32_16x16x32_bf16 v[116:119], a[144:147], a[76:79], v[116:119]
    ds_read_b64_tr_b16 a[178:179], v8 offset:29184
    v_add_f32 v81, 1.0, v81
    v_mfma_f32_16x16x32_bf16 v[124:127], a[148:151], a[76:79], v[124:127]
    ds_read_b64_tr_b16 a[180:181], v8 offset:40960
    v_add_f32 v82, 1.0, v82
    v_mfma_f32_16x16x32_bf16 v[120:123], a[148:151], a[72:75], v[120:123]
    ds_read_b64_tr_b16 a[182:183], v8 offset:41472
    ds_read_b64_tr_b16 a[184:185], v9 offset:28672
    v_mfma_f32_16x16x32_bf16 v[128:131], a[152:155], a[72:75], v[128:131]
    buffer_load_dwordx4 v3, s[12:15], s60 offen offset:1024 lds
    v_mfma_f32_16x16x32_bf16 v[132:135], a[152:155], a[76:79], v[132:135]
    v_rcp_f32 v80, v80
    v_mfma_f32_16x16x32_bf16 v[140:143], a[156:159], a[76:79], v[140:143]
    ds_read_b64_tr_b16 a[186:187], v9 offset:29184
    ds_read_b64_tr_b16 a[188:189], v9 offset:40960
    v_mfma_f32_16x16x32_bf16 v[136:139], a[156:159], a[72:75], v[136:139]
    s_waitcnt lgkmcnt(7)
    v_rcp_f32 v81, v81
    v_mfma_f32_16x16x32_bf16 v[144:147], a[160:163], a[72:75], v[144:147]
    ds_read_b64_tr_b16 a[190:191], v9 offset:41472
    ds_read_b64_tr_b16 a[144:145], v10 offset:28672
    v_mfma_f32_16x16x32_bf16 v[148:151], a[160:163], a[76:79], v[148:151]
    buffer_load_dwordx4 v4, s[12:15], s60 offen offset:2048 lds
    ds_read_b64_tr_b16 a[146:147], v10 offset:29184
    v_mfma_f32_16x16x32_bf16 v[156:159], a[164:167], a[76:79], v[156:159]
    v_rcp_f32 v82, v82
    v_mfma_f32_16x16x32_bf16 v[152:155], a[164:167], a[72:75], v[152:155]
    ds_read_b64_tr_b16 a[148:149], v10 offset:40960
    v_rcp_f32 v83, v83
    v_mfma_f32_16x16x32_bf16 v[160:163], a[168:171], a[72:75], v[160:163]
    ds_read_b64_tr_b16 a[150:151], v10 offset:41472
    ds_read_b64_tr_b16 a[152:153], v11 offset:28672
    v_mfma_f32_16x16x32_bf16 v[164:167], a[168:171], a[76:79], v[164:167]
    ds_read_b64_tr_b16 a[154:155], v11 offset:29184
    v_mul_f32 v88, v88, v80
    v_mfma_f32_16x16x32_bf16 v[172:175], a[172:175], a[76:79], v[172:175]
    ds_read_b64_tr_b16 a[156:157], v11 offset:40960
    v_mul_f32 v89, v89, v81
    v_mfma_f32_16x16x32_bf16 v[168:171], a[172:175], a[72:75], v[168:171]
    s_waitcnt lgkmcnt(7)
    ds_read_b64_tr_b16 a[158:159], v11 offset:41472
    v_mul_f32 v90, v90, v82
    v_mfma_f32_16x16x32_bf16 v[112:115], a[176:179], a[80:83], v[112:115]
    s_waitcnt vmcnt(7)
    ds_read_b64_tr_b16 a[160:161], v8 offset:32768
    s_barrier
    v_mfma_f32_16x16x32_bf16 v[116:119], a[176:179], a[84:87], v[116:119]
    ds_read_b64_tr_b16 a[162:163], v8 offset:33280
    v_mul_f32 v91, v91, v83
    v_mfma_f32_16x16x32_bf16 v[124:127], a[180:183], a[84:87], v[124:127]
    ds_read_b64_tr_b16 a[164:165], v8 offset:45056
    v_cvt_pk_bf16_f32 v217, v90, v91
    v_mfma_f32_16x16x32_bf16 v[120:123], a[180:183], a[80:83], v[120:123]
    ds_read_b64_tr_b16 a[166:167], v8 offset:45568
    ds_read_b64_tr_b16 a[168:169], v9 offset:32768
    v_mfma_f32_16x16x32_bf16 v[128:131], a[184:187], a[80:83], v[128:131]
    s_add_u32 s60, s59, 0x0
    v_exp_f32 v84, v84
    v_mfma_f32_16x16x32_bf16 v[132:135], a[184:187], a[84:87], v[132:135]
    ds_read_b64_tr_b16 a[170:171], v9 offset:33280
    v_cvt_pk_bf16_f32 v216, v88, v89
    v_mfma_f32_16x16x32_bf16 v[140:143], a[188:191], a[84:87], v[140:143]
    ds_read_b64_tr_b16 a[172:173], v9 offset:45056
    v_exp_f32 v85, v85
    v_mfma_f32_16x16x32_bf16 v[136:139], a[188:191], a[80:83], v[136:139]
    ds_read_b64_tr_b16 a[174:175], v9 offset:45568
    s_waitcnt lgkmcnt(8)
    v_mfma_f32_16x16x32_bf16 v[144:147], a[144:147], a[80:83], v[144:147]
    v_exp_f32 v86, v86
    v_mfma_f32_16x16x32_bf16 v[148:151], a[144:147], a[84:87], v[148:151]
    ds_read_b64_tr_b16 a[176:177], v10 offset:32768
    ds_read_b64_tr_b16 a[178:179], v10 offset:33280
    v_mfma_f32_16x16x32_bf16 v[156:159], a[148:151], a[84:87], v[156:159]
    s_add_u32 m0, s61, 0x0
    ds_read_b64_tr_b16 a[180:181], v10 offset:45056
    v_exp_f32 v87, v87
    v_mfma_f32_16x16x32_bf16 v[152:155], a[148:151], a[80:83], v[152:155]
    ds_read_b64_tr_b16 a[182:183], v10 offset:45568
    buffer_load_dwordx4 v5, s[8:11], s60 offen offset:0 lds
    v_mfma_f32_16x16x32_bf16 v[160:163], a[152:155], a[80:83], v[160:163]
    ds_read_b64_tr_b16 a[184:185], v11 offset:32768
    v_add_f32 v84, 1.0, v84
    v_mfma_f32_16x16x32_bf16 v[164:167], a[152:155], a[84:87], v[164:167]
    ds_read_b64_tr_b16 a[186:187], v11 offset:33280
    v_add_f32 v85, 1.0, v85
    v_mfma_f32_16x16x32_bf16 v[172:175], a[156:159], a[84:87], v[172:175]
    ds_read_b64_tr_b16 a[188:189], v11 offset:45056
    v_add_f32 v86, 1.0, v86
    v_mfma_f32_16x16x32_bf16 v[168:171], a[156:159], a[80:83], v[168:171]
    s_waitcnt lgkmcnt(7)
    ds_read_b64_tr_b16 a[190:191], v11 offset:45568
    ds_read_b64_tr_b16 a[144:145], v12 offset:0
    v_mfma_f32_16x16x32_bf16 v[112:115], a[160:163], a[88:91], v[112:115]
    ds_read_b64_tr_b16 a[146:147], v12 offset:512
    buffer_load_dwordx4 v6, s[8:11], s60 offen offset:1024 lds
    v_mfma_f32_16x16x32_bf16 v[116:119], a[160:163], a[92:95], v[116:119]
    v_rcp_f32 v84, v84
    v_mfma_f32_16x16x32_bf16 v[124:127], a[164:167], a[92:95], v[124:127]
    ds_read_b64_tr_b16 a[148:149], v12 offset:12288
    v_add_f32 v87, 1.0, v87
    v_mfma_f32_16x16x32_bf16 v[120:123], a[164:167], a[88:91], v[120:123]
    v_rcp_f32 v85, v85
    v_mfma_f32_16x16x32_bf16 v[128:131], a[168:171], a[88:91], v[128:131]
    ds_read_b64_tr_b16 a[150:151], v12 offset:12800
    ds_read_b64_tr_b16 a[152:153], v13 offset:0
    v_mfma_f32_16x16x32_bf16 v[132:135], a[168:171], a[92:95], v[132:135]
    ds_read_b64_tr_b16 a[154:155], v13 offset:512
    buffer_load_dwordx4 v7, s[8:11], s60 offen offset:2048 lds
    v_mfma_f32_16x16x32_bf16 v[140:143], a[172:175], a[92:95], v[140:143]
    ds_read_b64_tr_b16 a[156:157], v13 offset:12288
    v_rcp_f32 v86, v86
    v_mfma_f32_16x16x32_bf16 v[136:139], a[172:175], a[88:91], v[136:139]
    s_waitcnt lgkmcnt(7)
    ds_read_b64_tr_b16 a[158:159], v13 offset:12800
    ds_read_b64_tr_b16 a[160:161], v14 offset:0
    v_mfma_f32_16x16x32_bf16 v[144:147], a[176:179], a[88:91], v[144:147]
    v_rcp_f32 v87, v87
    v_mfma_f32_16x16x32_bf16 v[148:151], a[176:179], a[92:95], v[148:151]
    ds_read_b64_tr_b16 a[162:163], v14 offset:512
    v_mul_f32 v92, v92, v84
    v_mfma_f32_16x16x32_bf16 v[156:159], a[180:183], a[92:95], v[156:159]
    ds_read_b64_tr_b16 a[164:165], v14 offset:12288
    v_mul_f32 v93, v93, v85
    v_mfma_f32_16x16x32_bf16 v[152:155], a[180:183], a[88:91], v[152:155]
    ds_read_b64_tr_b16 a[166:167], v14 offset:12800
    v_mul_f32 v94, v94, v86
    v_mfma_f32_16x16x32_bf16 v[160:163], a[184:187], a[88:91], v[160:163]
    s_add_u32 m0, s61, 0x3000
    ds_read_b64_tr_b16 a[168:169], v15 offset:0
    v_mul_f32 v95, v95, v87
    v_mfma_f32_16x16x32_bf16 v[164:167], a[184:187], a[92:95], v[164:167]
    ds_read_b64_tr_b16 a[170:171], v15 offset:512
    v_cvt_pk_bf16_f32 v220, v92, v93
    v_mfma_f32_16x16x32_bf16 v[172:175], a[188:191], a[92:95], v[172:175]
    ds_read_b64_tr_b16 a[172:173], v15 offset:12288
    v_cvt_pk_bf16_f32 v221, v94, v95
    v_mfma_f32_16x16x32_bf16 v[168:171], a[188:191], a[88:91], v[168:171]
    s_waitcnt lgkmcnt(7)
    ds_read_b64_tr_b16 a[174:175], v15 offset:12800
    ds_read_b64_tr_b16 a[176:177], v12 offset:4096
    v_mfma_f32_16x16x32_bf16 v[112:115], a[144:147], a[96:99], v[112:115]
    v_exp_f32 v96, v96
    v_mfma_f32_16x16x32_bf16 v[116:119], a[144:147], a[100:103], v[116:119]
    buffer_load_dwordx4 v5, s[12:15], s60 offen offset:0 lds
    ds_read_b64_tr_b16 a[178:179], v12 offset:4608
    v_mfma_f32_16x16x32_bf16 v[124:127], a[148:151], a[100:103], v[124:127]
    v_exp_f32 v97, v97
    v_mfma_f32_16x16x32_bf16 v[120:123], a[148:151], a[96:99], v[120:123]
    ds_read_b64_tr_b16 a[180:181], v12 offset:16384
    ds_read_b64_tr_b16 a[182:183], v12 offset:16896
    v_mfma_f32_16x16x32_bf16 v[128:131], a[152:155], a[96:99], v[128:131]
    buffer_load_dwordx4 v6, s[12:15], s60 offen offset:1024 lds
    v_mfma_f32_16x16x32_bf16 v[132:135], a[152:155], a[100:103], v[132:135]
    ds_read_b64_tr_b16 a[184:185], v13 offset:4096
    v_exp_f32 v98, v98
    v_mfma_f32_16x16x32_bf16 v[140:143], a[156:159], a[100:103], v[140:143]
    ds_read_b64_tr_b16 a[186:187], v13 offset:4608
    ds_read_b64_tr_b16 a[188:189], v13 offset:16384
    v_mfma_f32_16x16x32_bf16 v[136:139], a[156:159], a[96:99], v[136:139]
    s_waitcnt lgkmcnt(7)
    ds_read_b64_tr_b16 a[190:191], v13 offset:16896
    v_exp_f32 v99, v99
    v_mfma_f32_16x16x32_bf16 v[144:147], a[160:163], a[96:99], v[144:147]
    ds_read_b64_tr_b16 a[144:145], v14 offset:4096
    v_add_f32 v96, 1.0, v96
    v_mfma_f32_16x16x32_bf16 v[148:151], a[160:163], a[100:103], v[148:151]
    buffer_load_dwordx4 v7, s[12:15], s60 offen offset:2048 lds
    ds_read_b64_tr_b16 a[146:147], v14 offset:4608
    v_mfma_f32_16x16x32_bf16 v[156:159], a[164:167], a[100:103], v[156:159]
    ds_read_b64_tr_b16 a[148:149], v14 offset:16384
    v_add_f32 v97, 1.0, v97
    v_mfma_f32_16x16x32_bf16 v[152:155], a[164:167], a[96:99], v[152:155]
    ds_read_b64_tr_b16 a[150:151], v14 offset:16896
    v_add_f32 v98, 1.0, v98
    v_mfma_f32_16x16x32_bf16 v[160:163], a[168:171], a[96:99], v[160:163]
    ds_read_b64_tr_b16 a[152:153], v15 offset:4096
    v_add_f32 v99, 1.0, v99
    v_mfma_f32_16x16x32_bf16 v[164:167], a[168:171], a[100:103], v[164:167]
    v_rcp_f32 v96, v96
    v_mfma_f32_16x16x32_bf16 v[172:175], a[172:175], a[100:103], v[172:175]
    ds_read_b64_tr_b16 a[154:155], v15 offset:4608
    ds_read_b64_tr_b16 a[156:157], v15 offset:16384
    v_mfma_f32_16x16x32_bf16 v[168:171], a[172:175], a[96:99], v[168:171]
    s_waitcnt lgkmcnt(7)
    ds_read_b64_tr_b16 a[158:159], v15 offset:16896
    ds_read_b64_tr_b16 a[160:161], v12 offset:8192
    v_mfma_f32_16x16x32_bf16 v[112:115], a[176:179], a[104:107], v[112:115]
    s_waitcnt vmcnt(6)
    s_barrier
    v_mfma_f32_16x16x32_bf16 v[116:119], a[176:179], a[108:111], v[116:119]
    v_rcp_f32 v97, v97
    v_mfma_f32_16x16x32_bf16 v[124:127], a[180:183], a[108:111], v[124:127]
    ds_read_b64_tr_b16 a[162:163], v12 offset:8704
    v_rcp_f32 v98, v98
    v_mfma_f32_16x16x32_bf16 v[120:123], a[180:183], a[104:107], v[120:123]
    ds_read_b64_tr_b16 a[164:165], v12 offset:20480
    ds_read_b64_tr_b16 a[166:167], v12 offset:20992
    v_mfma_f32_16x16x32_bf16 v[128:131], a[184:187], a[104:107], v[128:131]
    s_add_u32 s60, s59, 0x1b0000
    v_rcp_f32 v99, v99
    v_mfma_f32_16x16x32_bf16 v[132:135], a[184:187], a[108:111], v[132:135]
    ds_read_b64_tr_b16 a[168:169], v13 offset:8192
    ds_read_b64_tr_b16 a[170:171], v13 offset:8704
    v_mfma_f32_16x16x32_bf16 v[140:143], a[188:191], a[108:111], v[140:143]
    s_add_u32 m0, s61, 0x6000
    ds_read_b64_tr_b16 a[172:173], v13 offset:20480
    v_mul_f32 v104, v104, v96
    v_mfma_f32_16x16x32_bf16 v[136:139], a[188:191], a[104:107], v[136:139]
    s_waitcnt lgkmcnt(7)
    ds_read_b64_tr_b16 a[174:175], v13 offset:20992
    v_mul_f32 v105, v105, v97
    v_mfma_f32_16x16x32_bf16 v[144:147], a[144:147], a[104:107], v[144:147]
    ds_read_b64_tr_b16 a[176:177], v14 offset:8192
    v_mul_f32 v106, v106, v98
    v_mfma_f32_16x16x32_bf16 v[148:151], a[144:147], a[108:111], v[148:151]
    ds_read_b64_tr_b16 a[178:179], v14 offset:8704
    v_mul_f32 v107, v107, v99
    v_mfma_f32_16x16x32_bf16 v[156:159], a[148:151], a[108:111], v[156:159]
    ds_read_b64_tr_b16 a[180:181], v14 offset:20480
    v_cvt_pk_bf16_f32 v219, v106, v107
    v_mfma_f32_16x16x32_bf16 v[152:155], a[148:151], a[104:107], v[152:155]
    ds_read_b64_tr_b16 a[182:183], v14 offset:20992
    buffer_load_dwordx4 v5, s[8:11], s60 offen offset:0 lds
    v_mfma_f32_16x16x32_bf16 v[160:163], a[152:155], a[104:107], v[160:163]
    ds_read_b64_tr_b16 a[184:185], v15 offset:8192
    v_cvt_pk_bf16_f32 v218, v104, v105
    v_mfma_f32_16x16x32_bf16 v[164:167], a[152:155], a[108:111], v[164:167]
    ds_read_b64_tr_b16 a[186:187], v15 offset:8704
    ds_read_b64_tr_b16 a[188:189], v15 offset:20480
    v_mfma_f32_16x16x32_bf16 v[172:175], a[156:159], a[108:111], v[172:175]
    ds_read_b64_tr_b16 a[190:191], v15 offset:20992
    v_mfma_f32_16x16x32_bf16 v[168:171], a[156:159], a[104:107], v[168:171]
    buffer_store_dwordx4 v[216:219], v40, s[24:27], s81 offen offset:2048 sc1
    v_exp_f32 v100, v100
    s_waitcnt lgkmcnt(8)
    v_mfma_f32_16x16x32_bf16 v[112:115], a[160:163], a[112:115], v[112:115]
    buffer_load_dwordx4 v6, s[8:11], s60 offen offset:1024 lds
    v_mfma_f32_16x16x32_bf16 v[116:119], a[160:163], a[116:119], v[116:119]
    ds_read_b64_tr_b16 a[144:145], v12 offset:24576
    ds_read_b64_tr_b16 a[146:147], v12 offset:25088
    v_mfma_f32_16x16x32_bf16 v[124:127], a[164:167], a[116:119], v[124:127]
    v_exp_f32 v101, v101
    v_mfma_f32_16x16x32_bf16 v[120:123], a[164:167], a[112:115], v[120:123]
    ds_read_b64_tr_b16 a[148:149], v12 offset:36864
    ds_read_b64_tr_b16 a[150:151], v12 offset:37376
    v_mfma_f32_16x16x32_bf16 v[128:131], a[168:171], a[112:115], v[128:131]
    v_exp_f32 v102, v102
    v_mfma_f32_16x16x32_bf16 v[132:135], a[168:171], a[116:119], v[132:135]
    buffer_load_dwordx4 v7, s[8:11], s60 offen offset:2048 lds
    ds_read_b64_tr_b16 a[152:153], v12 offset:28672
    v_mfma_f32_16x16x32_bf16 v[140:143], a[172:175], a[116:119], v[140:143]
    ds_read_b64_tr_b16 a[154:155], v12 offset:29184
    ds_read_b64_tr_b16 a[156:157], v12 offset:40960
    v_mfma_f32_16x16x32_bf16 v[136:139], a[172:175], a[112:115], v[136:139]
    s_waitcnt lgkmcnt(7)
    ds_read_b64_tr_b16 a[158:159], v12 offset:41472
    v_exp_f32 v103, v103
    v_mfma_f32_16x16x32_bf16 v[144:147], a[176:179], a[112:115], v[144:147]
    ds_read_b64_tr_b16 a[160:161], v12 offset:32768
    v_add_f32 v100, 1.0, v100
    v_mfma_f32_16x16x32_bf16 v[148:151], a[176:179], a[116:119], v[148:151]
    ds_read_b64_tr_b16 a[162:163], v12 offset:33280
    v_add_f32 v101, 1.0, v101
    v_mfma_f32_16x16x32_bf16 v[156:159], a[180:183], a[116:119], v[156:159]
    ds_read_b64_tr_b16 a[164:165], v12 offset:45056
    v_add_f32 v102, 1.0, v102
    v_mfma_f32_16x16x32_bf16 v[152:155], a[180:183], a[112:115], v[152:155]
    ds_read_b64_tr_b16 a[166:167], v12 offset:45568
    v_add_f32 v103, 1.0, v103
    v_mfma_f32_16x16x32_bf16 v[160:163], a[184:187], a[112:115], v[160:163]
    v_rcp_f32 v100, v100
    v_mfma_f32_16x16x32_bf16 v[164:167], a[184:187], a[116:119], v[164:167]
    ds_read_b64_tr_b16 a[168:169], v13 offset:24576
    ds_read_b64_tr_b16 a[170:171], v13 offset:25088
    v_mfma_f32_16x16x32_bf16 v[172:175], a[188:191], a[116:119], v[172:175]
    s_add_u32 m0, s61, 0x9000
    v_rcp_f32 v101, v101
    v_mfma_f32_16x16x32_bf16 v[168:171], a[188:191], a[112:115], v[168:171]
    s_waitcnt lgkmcnt(6)
    ds_read_b64_tr_b16 a[172:173], v13 offset:36864
    buffer_load_dwordx4 v5, s[12:15], s60 offen offset:0 lds
    v_mfma_f32_16x16x32_bf16 v[112:115], a[144:147], a[120:123], v[112:115]
    ds_read_b64_tr_b16 a[174:175], v13 offset:37376
    ds_read_b64_tr_b16 a[176:177], v13 offset:28672
    v_mfma_f32_16x16x32_bf16 v[116:119], a[144:147], a[124:127], v[116:119]
    v_rcp_f32 v102, v102
    v_mfma_f32_16x16x32_bf16 v[124:127], a[148:151], a[124:127], v[124:127]
    ds_read_b64_tr_b16 a[178:179], v13 offset:29184
    ds_read_b64_tr_b16 a[180:181], v13 offset:40960
    v_mfma_f32_16x16x32_bf16 v[120:123], a[148:151], a[120:123], v[120:123]
    ds_read_b64_tr_b16 a[182:183], v13 offset:41472
    v_rcp_f32 v103, v103
    v_mfma_f32_16x16x32_bf16 v[112:115], a[152:155], a[128:131], v[112:115]
    ds_read_b64_tr_b16 a[184:185], v13 offset:32768
    buffer_load_dwordx4 v6, s[12:15], s60 offen offset:1024 lds
    v_mfma_f32_16x16x32_bf16 v[116:119], a[152:155], a[132:135], v[116:119]
    ds_read_b64_tr_b16 a[186:187], v13 offset:33280
    v_mul_f32 v108, v108, v100
    v_mfma_f32_16x16x32_bf16 v[124:127], a[156:159], a[132:135], v[124:127]
    ds_read_b64_tr_b16 a[188:189], v13 offset:45056
    v_mul_f32 v109, v109, v101
    v_mfma_f32_16x16x32_bf16 v[120:123], a[156:159], a[128:131], v[120:123]
    s_waitcnt lgkmcnt(7)
    ds_read_b64_tr_b16 a[190:191], v13 offset:45568
    v_mul_f32 v110, v110, v102
    v_mfma_f32_16x16x32_bf16 v[112:115], a[160:163], a[136:139], v[112:115]
    ds_read_b64_tr_b16 a[144:145], v14 offset:24576
    v_mul_f32 v111, v111, v103
    v_mfma_f32_16x16x32_bf16 v[116:119], a[160:163], a[140:143], v[116:119]
    ds_read_b64_tr_b16 a[146:147], v14 offset:25088
    buffer_load_dwordx4 v7, s[12:15], s60 offen offset:2048 lds
    v_mfma_f32_16x16x32_bf16 v[124:127], a[164:167], a[140:143], v[124:127]
    ds_read_b64_tr_b16 a[148:149], v14 offset:36864
    v_cvt_pk_bf16_f32 v222, v108, v109
    v_mfma_f32_16x16x32_bf16 v[120:123], a[164:167], a[136:139], v[120:123]
    ds_read_b64_tr_b16 a[150:151], v14 offset:37376
    v_cvt_pk_bf16_f32 v223, v110, v111
    v_mfma_f32_16x16x32_bf16 v[128:131], a[168:171], a[120:123], v[128:131]
    ds_read_b64_tr_b16 a[152:153], v14 offset:28672
    v_mfma_f32_16x16x32_bf16 v[132:135], a[168:171], a[124:127], v[132:135]
    ds_read_b64_tr_b16 a[154:155], v14 offset:29184
    v_mul_f32 v50, s68, v114
    v_mfma_f32_16x16x32_bf16 v[140:143], a[172:175], a[124:127], v[140:143]
    buffer_store_dwordx4 v[220:223], v40, s[24:27], s81 offen offset:3072 sc1
    ds_read_b64_tr_b16 a[156:157], v14 offset:40960
    v_mul_f32 v48, s68, v112
    v_mul_f32 v49, s68, v113
    v_mfma_f32_16x16x32_bf16 v[136:139], a[172:175], a[120:123], v[136:139]
    s_waitcnt lgkmcnt(7)
    ds_read_b64_tr_b16 a[158:159], v14 offset:41472
    ds_read_b64_tr_b16 a[160:161], v14 offset:32768
    v_mfma_f32_16x16x32_bf16 v[128:131], a[176:179], a[128:131], v[128:131]
    s_waitcnt vmcnt(8)
    s_barrier
    v_mfma_f32_16x16x32_bf16 v[132:135], a[176:179], a[132:135], v[132:135]
    ds_read_b64_tr_b16 a[162:163], v14 offset:33280
    v_mul_f32 v52, s68, v116
    v_mfma_f32_16x16x32_bf16 v[140:143], a[180:183], a[132:135], v[140:143]
    ds_read_b64_tr_b16 a[164:165], v14 offset:45056
    v_mul_f32 v53, s68, v117
    v_mfma_f32_16x16x32_bf16 v[136:139], a[180:183], a[128:131], v[136:139]
    ds_read_b64_tr_b16 a[166:167], v14 offset:45568
    v_mul_f32 v54, s68, v118
    v_mfma_f32_16x16x32_bf16 v[128:131], a[184:187], a[136:139], v[128:131]
    ds_read_b64_tr_b16 a[168:169], v15 offset:24576
    v_mul_f32 v55, s68, v119
    v_mfma_f32_16x16x32_bf16 v[132:135], a[184:187], a[140:143], v[132:135]
    s_add_u32 s60, s59, 0x360000
    ds_read_b64_tr_b16 a[170:171], v15 offset:25088
    v_mul_f32 v56, v112, v120
    v_mfma_f32_16x16x32_bf16 v[140:143], a[188:191], a[140:143], v[140:143]
    ds_read_b64_tr_b16 a[172:173], v15 offset:36864
    v_mul_f32 v51, s68, v115
    v_mfma_f32_16x16x32_bf16 v[136:139], a[188:191], a[136:139], v[136:139]
    s_waitcnt lgkmcnt(7)
    ds_read_b64_tr_b16 a[174:175], v15 offset:37376
    v_mul_f32 v59, v115, v123
    v_mfma_f32_16x16x32_bf16 v[144:147], a[144:147], a[120:123], v[144:147]
    ds_read_b64_tr_b16 a[176:177], v15 offset:28672
    v_mul_f32 v66, s68, v130
    v_mul_f32 v57, v113, v121
    v_mul_f32 v65, s68, v129
    v_mul_f32 v62, v118, v126
    v_mul_f32 v58, v114, v122
    v_mfma_f32_16x16x32_bf16 v[148:151], a[144:147], a[124:127], v[148:151]
    s_add_u32 m0, s61, 0xc000
    ds_read_b64_tr_b16 a[178:179], v15 offset:29184
    v_mul_f32 v60, v116, v124
    v_mfma_f32_16x16x32_bf16 v[156:159], a[148:151], a[124:127], v[156:159]
    ds_read_b64_tr_b16 a[180:181], v15 offset:40960
    v_mul_f32 v61, v117, v125
    v_mfma_f32_16x16x32_bf16 v[152:155], a[148:151], a[120:123], v[152:155]
    buffer_load_dwordx4 v5, s[8:11], s60 offen offset:0 lds
    ds_read_b64_tr_b16 a[182:183], v15 offset:41472
    v_mfma_f32_16x16x32_bf16 v[144:147], a[152:155], a[128:131], v[144:147]
    ds_read_b64_tr_b16 a[184:185], v15 offset:32768
    v_mul_f32 v67, s68, v131
    v_mfma_f32_16x16x32_bf16 v[148:151], a[152:155], a[132:135], v[148:151]
    ds_read_b64_tr_b16 a[186:187], v15 offset:33280
    v_mul_f32 v64, s68, v128
    v_mfma_f32_16x16x32_bf16 v[156:159], a[156:159], a[132:135], v[156:159]
    ds_read_b64_tr_b16 a[188:189], v15 offset:45056
    v_mul_f32 v70, s68, v134
    v_mfma_f32_16x16x32_bf16 v[152:155], a[156:159], a[128:131], v[152:155]
    s_waitcnt lgkmcnt(7)
    ds_read_b64_tr_b16 a[190:191], v15 offset:45568
    v_mul_f32 v63, v119, v127
    v_mul_f32 v74, v130, v138
    v_mul_f32 v79, v135, v143
    v_mul_f32 v76, v132, v140
    v_mfma_f32_16x16x32_bf16 v[144:147], a[160:163], a[136:139], v[144:147]
    buffer_load_dwordx4 v6, s[8:11], s60 offen offset:1024 lds
    ds_read_b64_tr_b16 a[144:145], v16 offset:0
    v_mfma_f32_16x16x32_bf16 v[148:151], a[160:163], a[140:143], v[148:151]
    ds_read_b64_tr_b16 a[146:147], v16 offset:256
    v_mul_f32 v72, v128, v136
    v_mfma_f32_16x16x32_bf16 v[156:159], a[164:167], a[140:143], v[156:159]
    ds_read_b64_tr_b16 a[148:149], v16 offset:12288
    v_mul_f32 v78, v134, v142
    v_mul_f32 v68, s68, v132
    v_mfma_f32_16x16x32_bf16 v[152:155], a[164:167], a[136:139], v[152:155]
    ds_read_b64_tr_b16 a[150:151], v16 offset:12544
    v_mul_f32 v73, v129, v137
    v_mul_f32 v75, v131, v139
    v_mfma_f32_16x16x32_bf16 v[160:163], a[168:171], a[120:123], v[160:163]
    ds_read_b64_tr_b16 a[152:153], v16 offset:2048
    v_mul_f32 v69, s68, v133
    v_mul_f32 v71, s68, v135
    v_mfma_f32_16x16x32_bf16 v[164:167], a[168:171], a[124:127], v[164:167]
    ds_read_b64_tr_b16 a[154:155], v16 offset:2304
    buffer_load_dwordx4 v7, s[8:11], s60 offen offset:2048 lds
    v_mul_f32 v77, v133, v141
    v_mfma_f32_16x16x32_bf16 v[172:175], a[172:175], a[124:127], v[172:175]
    ds_read_b64_tr_b16 a[156:157], v16 offset:14336
    v_mul_f32 v80, s68, v144
    v_mfma_f32_16x16x32_bf16 v[168:171], a[172:175], a[120:123], v[168:171]
    s_waitcnt lgkmcnt(7)
    ds_read_b64_tr_b16 a[158:159], v16 offset:14592
    v_mul_f32 v82, s68, v146
    v_mfma_f32_16x16x32_bf16 v[160:163], a[176:179], a[128:131], v[160:163]
    ds_read_b64_tr_b16 a[160:161], v16 offset:4096
    v_mul_f32 v83, s68, v147
    v_mfma_f32_16x16x32_bf16 v[164:167], a[176:179], a[132:135], v[164:167]
    ds_read_b64_tr_b16 a[162:163], v16 offset:4352
    v_mul_f32 v85, s68, v149
    v_mfma_f32_16x16x32_bf16 v[172:175], a[180:183], a[132:135], v[172:175]
    ds_read_b64_tr_b16 a[164:165], v16 offset:16384
    v_mul_f32 v81, s68, v145
    v_mfma_f32_16x16x32_bf16 v[168:171], a[180:183], a[128:131], v[168:171]
    ds_read_b64_tr_b16 a[166:167], v16 offset:16640
    v_mul_f32 v84, s68, v148
    v_mfma_f32_16x16x32_bf16 v[160:163], a[184:187], a[136:139], v[160:163]
    s_add_u32 m0, s61, 0xf000
    ds_read_b64_tr_b16 a[168:169], v16 offset:6144
    v_mul_f32 v86, s68, v150
    v_mfma_f32_16x16x32_bf16 v[164:167], a[184:187], a[140:143], v[164:167]
    ds_read_b64_tr_b16 a[170:171], v16 offset:6400
    v_mul_f32 v90, v146, v154
    v_mfma_f32_16x16x32_bf16 v[172:175], a[188:191], a[140:143], v[172:175]
    ds_read_b64_tr_b16 a[172:173], v16 offset:18432
    v_mul_f32 v89, v145, v153
    v_mfma_f32_16x16x32_bf16 v[168:171], a[188:191], a[136:139], v[168:171]
    s_waitcnt lgkmcnt(7)
    buffer_load_dwordx4 v5, s[12:15], s60 offen offset:0 lds
    ds_read_b64_tr_b16 a[174:175], v16 offset:18688
    v_mul_f32 v92, v148, v156
    v_mfma_f32_16x16x32_bf16 v[112:115], a[144:147], a[0:3], 0
    ds_read_b64_tr_b16 a[176:177], v16 offset:8192
    v_mul_f32 v96, s68, v160
    v_mfma_f32_16x16x32_bf16 v[116:119], a[144:147], a[4:7], 0
    ds_read_b64_tr_b16 a[178:179], v16 offset:8448
    v_mul_f32 v87, s68, v151
    v_mfma_f32_16x16x32_bf16 v[124:127], a[148:151], a[4:7], 0
    ds_read_b64_tr_b16 a[180:181], v16 offset:20480
    v_mul_f32 v88, v144, v152
    v_mfma_f32_16x16x32_bf16 v[120:123], a[148:151], a[0:3], 0
    ds_read_b64_tr_b16 a[182:183], v16 offset:20736
    v_mul_f32 v94, v150, v158
    v_mul_f32 v91, v147, v155
    v_mul_f32 v95, v151, v159
    v_mul_f32 v93, v149, v157
    v_mul_f32 v97, s68, v161
    v_mfma_f32_16x16x32_bf16 v[112:115], a[152:155], a[8:11], v[112:115]
    ds_read_b64_tr_b16 a[184:185], v16 offset:10240
    buffer_load_dwordx4 v6, s[12:15], s60 offen offset:1024 lds
    v_mfma_f32_16x16x32_bf16 v[116:119], a[152:155], a[12:15], v[116:119]
    ds_read_b64_tr_b16 a[186:187], v16 offset:10496
    v_mul_f32 v100, s68, v164
    v_mfma_f32_16x16x32_bf16 v[124:127], a[156:159], a[12:15], v[124:127]
    ds_read_b64_tr_b16 a[188:189], v16 offset:22528
    v_mul_f32 v101, s68, v165
    v_mfma_f32_16x16x32_bf16 v[120:123], a[156:159], a[8:11], v[120:123]
    s_waitcnt lgkmcnt(7)
    ds_read_b64_tr_b16 a[190:191], v16 offset:22784
    v_mul_f32 v103, s68, v167
    v_mfma_f32_16x16x32_bf16 v[112:115], a[160:163], a[16:19], v[112:115]
    ds_read_b64_tr_b16 a[144:145], v17 offset:0
    v_mul_f32 v98, s68, v162
    v_mfma_f32_16x16x32_bf16 v[116:119], a[160:163], a[20:23], v[116:119]
    ds_read_b64_tr_b16 a[146:147], v17 offset:256
    buffer_load_dwordx4 v7, s[12:15], s60 offen offset:2048 lds
    v_mfma_f32_16x16x32_bf16 v[124:127], a[164:167], a[20:23], v[124:127]
    ds_read_b64_tr_b16 a[148:149], v17 offset:12288
    v_mul_f32 v107, v163, v171
    v_mfma_f32_16x16x32_bf16 v[120:123], a[164:167], a[16:19], v[120:123]
    ds_read_b64_tr_b16 a[150:151], v17 offset:12544
    v_mul_f32 v104, v160, v168
    v_mul_f32 v105, v161, v169
    v_mfma_f32_16x16x32_bf16 v[112:115], a[168:171], a[24:27], v[112:115]
    ds_read_b64_tr_b16 a[152:153], v17 offset:2048
    v_mul_f32 v106, v162, v170
    v_mul_f32 v108, v164, v172
    v_mul_f32 v102, s68, v166
    v_mul_f32 v109, v165, v173
    v_mul_f32 v99, s68, v163
    v_mfma_f32_16x16x32_bf16 v[116:119], a[168:171], a[28:31], v[116:119]
    ds_read_b64_tr_b16 a[154:155], v17 offset:2304
    v_mul_f32 v111, v167, v175
    v_mfma_f32_16x16x32_bf16 v[124:127], a[172:175], a[28:31], v[124:127]
    ds_read_b64_tr_b16 a[156:157], v17 offset:14336
    v_exp_f32 v48, v48
    v_mfma_f32_16x16x32_bf16 v[120:123], a[172:175], a[24:27], v[120:123]
    s_waitcnt lgkmcnt(7)
    ds_read_b64_tr_b16 a[158:159], v17 offset:14592
    ds_read_b64_tr_b16 a[160:161], v17 offset:4096
    v_mfma_f32_16x16x32_bf16 v[112:115], a[176:179], a[32:35], v[112:115]
    s_waitcnt vmcnt(7)
    s_barrier
    v_mfma_f32_16x16x32_bf16 v[116:119], a[176:179], a[36:39], v[116:119]
    ds_read_b64_tr_b16 a[162:163], v17 offset:4352
    v_exp_f32 v49, v49
    v_mfma_f32_16x16x32_bf16 v[124:127], a[180:183], a[36:39], v[124:127]
    s_add_u32 s60, s64, s0
    ds_read_b64_tr_b16 a[164:165], v17 offset:16384
    v_exp_f32 v50, v50
    v_mul_f32 v110, v166, v174
    v_mfma_f32_16x16x32_bf16 v[120:123], a[180:183], a[32:35], v[120:123]
    ds_read_b64_tr_b16 a[166:167], v17 offset:16640
    v_exp_f32 v51, v51
    v_mfma_f32_16x16x32_bf16 v[112:115], a[184:187], a[40:43], v[112:115]
    ds_read_b64_tr_b16 a[168:169], v17 offset:6144
    v_add_f32 v48, 1.0, v48
    v_mfma_f32_16x16x32_bf16 v[116:119], a[184:187], a[44:47], v[116:119]
    ds_read_b64_tr_b16 a[170:171], v17 offset:6400
    v_add_f32 v49, 1.0, v49
    v_mfma_f32_16x16x32_bf16 v[124:127], a[188:191], a[44:47], v[124:127]
    s_add_u32 m0, s74, 0x12000
    ds_read_b64_tr_b16 a[172:173], v17 offset:18432
    v_add_f32 v50, 1.0, v50
    v_mfma_f32_16x16x32_bf16 v[120:123], a[188:191], a[40:43], v[120:123]
    s_waitcnt lgkmcnt(7)
    ds_read_b64_tr_b16 a[174:175], v17 offset:18688
    v_add_f32 v51, 1.0, v51
    v_mfma_f32_16x16x32_bf16 v[128:131], a[144:147], a[0:3], 0
    ds_read_b64_tr_b16 a[176:177], v17 offset:8192
    v_rcp_f32 v48, v48
    v_mfma_f32_16x16x32_bf16 v[132:135], a[144:147], a[4:7], 0
    v_rcp_f32 v49, v49
    v_mfma_f32_16x16x32_bf16 v[140:143], a[148:151], a[4:7], 0
    ds_read_b64_tr_b16 a[178:179], v17 offset:8448
    buffer_load_dwordx4 v20, s[16:19], s60 offen offset:0 lds
    ds_read_b64_tr_b16 a[180:181], v17 offset:20480
    v_mfma_f32_16x16x32_bf16 v[136:139], a[148:151], a[0:3], 0
    ds_read_b64_tr_b16 a[182:183], v17 offset:20736
    v_rcp_f32 v50, v50
    v_mfma_f32_16x16x32_bf16 v[128:131], a[152:155], a[8:11], v[128:131]
    s_waitcnt vmcnt(7)
    ds_read_b64_tr_b16 a[184:185], v17 offset:10240
    buffer_store_dword v43, v42, s[24:27], s38 offen offset:0 sc1
    v_mfma_f32_16x16x32_bf16 v[132:135], a[152:155], a[12:15], v[132:135]
    ds_read_b64_tr_b16 a[186:187], v17 offset:10496
    v_rcp_f32 v51, v51
    v_mfma_f32_16x16x32_bf16 v[140:143], a[156:159], a[12:15], v[140:143]
    ds_read_b64_tr_b16 a[188:189], v17 offset:22528
    v_mul_f32 v56, v56, v48
    v_mfma_f32_16x16x32_bf16 v[136:139], a[156:159], a[8:11], v[136:139]
    s_waitcnt lgkmcnt(7)
    ds_read_b64_tr_b16 a[190:191], v17 offset:22784
    buffer_load_dwordx4 v21, s[16:19], s60 offen offset:1024 lds
    v_mfma_f32_16x16x32_bf16 v[128:131], a[160:163], a[16:19], v[128:131]
    ds_read_b64_tr_b16 a[144:145], v16 offset:24576
    v_mul_f32 v57, v57, v49
    v_mfma_f32_16x16x32_bf16 v[132:135], a[160:163], a[20:23], v[132:135]
    s_add_u32 s38, s38, 0x10000
    ds_read_b64_tr_b16 a[146:147], v16 offset:24832
    v_mul_f32 v58, v58, v50
    v_mfma_f32_16x16x32_bf16 v[140:143], a[164:167], a[20:23], v[140:143]
    ds_read_b64_tr_b16 a[148:149], v16 offset:36864
    v_exp_f32 v52, v52
    v_mfma_f32_16x16x32_bf16 v[136:139], a[164:167], a[16:19], v[136:139]
    buffer_load_dwordx4 v22, s[16:19], s60 offen offset:2048 lds
    ds_read_b64_tr_b16 a[150:151], v16 offset:37120
    v_mfma_f32_16x16x32_bf16 v[128:131], a[168:171], a[24:27], v[128:131]
    ds_read_b64_tr_b16 a[152:153], v16 offset:26624
    v_mul_f32 v59, v59, v51
    v_mfma_f32_16x16x32_bf16 v[132:135], a[168:171], a[28:31], v[132:135]
    ds_read_b64_tr_b16 a[154:155], v16 offset:26880
    v_cvt_pk_bf16_f32 v224, v56, v57
    v_mfma_f32_16x16x32_bf16 v[140:143], a[172:175], a[28:31], v[140:143]
    ds_read_b64_tr_b16 a[156:157], v16 offset:38912
    v_cvt_pk_bf16_f32 v225, v58, v59
    v_exp_f32 v53, v53
    v_mfma_f32_16x16x32_bf16 v[136:139], a[172:175], a[24:27], v[136:139]
    s_waitcnt lgkmcnt(7)
    ds_read_b64_tr_b16 a[158:159], v16 offset:39168
    v_exp_f32 v54, v54
    v_mfma_f32_16x16x32_bf16 v[128:131], a[176:179], a[32:35], v[128:131]
    ds_read_b64_tr_b16 a[160:161], v16 offset:28672
    buffer_load_dwordx4 v23, s[16:19], s60 offen offset:3072 lds
    v_mfma_f32_16x16x32_bf16 v[132:135], a[176:179], a[36:39], v[132:135]
    ds_read_b64_tr_b16 a[162:163], v16 offset:28928
    v_exp_f32 v55, v55
    v_mfma_f32_16x16x32_bf16 v[140:143], a[180:183], a[36:39], v[140:143]
    ds_read_b64_tr_b16 a[164:165], v16 offset:40960
    v_add_f32 v52, 1.0, v52
    v_mfma_f32_16x16x32_bf16 v[136:139], a[180:183], a[32:35], v[136:139]
    ds_read_b64_tr_b16 a[166:167], v16 offset:41216
    v_add_f32 v53, 1.0, v53
    v_mfma_f32_16x16x32_bf16 v[128:131], a[184:187], a[40:43], v[128:131]
    ds_read_b64_tr_b16 a[168:169], v16 offset:30720
    v_add_f32 v54, 1.0, v54
    v_mfma_f32_16x16x32_bf16 v[132:135], a[184:187], a[44:47], v[132:135]
    ds_read_b64_tr_b16 a[170:171], v16 offset:30976
    v_add_f32 v55, 1.0, v55
    v_mfma_f32_16x16x32_bf16 v[140:143], a[188:191], a[44:47], v[140:143]
    ds_read_b64_tr_b16 a[172:173], v16 offset:43008
    v_rcp_f32 v52, v52
    v_mfma_f32_16x16x32_bf16 v[136:139], a[188:191], a[40:43], v[136:139]
    s_waitcnt lgkmcnt(7)
    ds_read_b64_tr_b16 a[174:175], v16 offset:43264
    v_rcp_f32 v53, v53
    v_mfma_f32_16x16x32_bf16 v[112:115], a[144:147], a[48:51], v[112:115]
    ds_read_b64_tr_b16 a[176:177], v16 offset:32768
    ds_read_b64_tr_b16 a[178:179], v16 offset:33024
    v_mfma_f32_16x16x32_bf16 v[116:119], a[144:147], a[52:55], v[116:119]
    v_rcp_f32 v54, v54
    v_mfma_f32_16x16x32_bf16 v[124:127], a[148:151], a[52:55], v[124:127]
    s_add_u32 s60, s65, s0
    ds_read_b64_tr_b16 a[180:181], v16 offset:45056
    v_rcp_f32 v55, v55
    v_mfma_f32_16x16x32_bf16 v[120:123], a[148:151], a[48:51], v[120:123]
    s_add_u32 m0, s75, 0x12000
    ds_read_b64_tr_b16 a[182:183], v16 offset:45312
    v_mul_f32 v60, v60, v52
    v_mfma_f32_16x16x32_bf16 v[112:115], a[152:155], a[56:59], v[112:115]
    ds_read_b64_tr_b16 a[184:185], v16 offset:34816
    v_mul_f32 v61, v61, v53
    v_mfma_f32_16x16x32_bf16 v[116:119], a[152:155], a[60:63], v[116:119]
    buffer_load_dwordx4 v20, s[16:19], s60 offen offset:0 lds
    ds_read_b64_tr_b16 a[186:187], v16 offset:35072
    v_mfma_f32_16x16x32_bf16 v[124:127], a[156:159], a[60:63], v[124:127]
    ds_read_b64_tr_b16 a[188:189], v16 offset:47104
    v_mul_f32 v62, v62, v54
    v_mfma_f32_16x16x32_bf16 v[120:123], a[156:159], a[56:59], v[120:123]
    s_waitcnt lgkmcnt(7)
    ds_read_b64_tr_b16 a[190:191], v16 offset:47360
    buffer_load_dwordx4 v21, s[16:19], s60 offen offset:1024 lds
    ds_read_b64_tr_b16 a[144:145], v17 offset:24576
    v_mfma_f32_16x16x32_bf16 v[112:115], a[160:163], a[64:67], v[112:115]
    v_exp_f32 v64, v64
    v_mfma_f32_16x16x32_bf16 v[116:119], a[160:163], a[68:71], v[116:119]
    ds_read_b64_tr_b16 a[146:147], v17 offset:24832
    v_mul_f32 v63, v63, v55
    v_cvt_pk_bf16_f32 v228, v60, v61
    v_mfma_f32_16x16x32_bf16 v[124:127], a[164:167], a[68:71], v[124:127]
    ds_read_b64_tr_b16 a[148:149], v17 offset:36864
    v_exp_f32 v65, v65
    v_mfma_f32_16x16x32_bf16 v[120:123], a[164:167], a[64:67], v[120:123]
    ds_read_b64_tr_b16 a[150:151], v17 offset:37120
    v_cvt_pk_bf16_f32 v229, v62, v63
    v_mfma_f32_16x16x32_bf16 v[112:115], a[168:171], a[72:75], v[112:115]
    ds_read_b64_tr_b16 a[152:153], v17 offset:26624
    v_exp_f32 v66, v66
    v_mfma_f32_16x16x32_bf16 v[116:119], a[168:171], a[76:79], v[116:119]
    ds_read_b64_tr_b16 a[154:155], v17 offset:26880
    v_exp_f32 v67, v67
    v_mfma_f32_16x16x32_bf16 v[124:127], a[172:175], a[76:79], v[124:127]
    ds_read_b64_tr_b16 a[156:157], v17 offset:38912
    v_add_f32 v64, 1.0, v64
    v_mfma_f32_16x16x32_bf16 v[120:123], a[172:175], a[72:75], v[120:123]
    s_waitcnt lgkmcnt(7)
    ds_read_b64_tr_b16 a[158:159], v17 offset:39168
    v_add_f32 v66, 1.0, v66
    v_mfma_f32_16x16x32_bf16 v[112:115], a[176:179], a[80:83], v[112:115]
    s_waitcnt vmcnt(7)
    ds_read_b64_tr_b16 a[160:161], v17 offset:28672
    s_barrier
    v_mfma_f32_16x16x32_bf16 v[116:119], a[176:179], a[84:87], v[116:119]
    ds_read_b64_tr_b16 a[162:163], v17 offset:28928
    v_add_f32 v65, 1.0, v65
    v_mfma_f32_16x16x32_bf16 v[124:127], a[180:183], a[84:87], v[124:127]
    v_rcp_f32 v64, v64
    v_mfma_f32_16x16x32_bf16 v[120:123], a[180:183], a[80:83], v[120:123]
    ds_read_b64_tr_b16 a[164:165], v17 offset:40960
    v_rcp_f32 v65, v65
    v_mfma_f32_16x16x32_bf16 v[112:115], a[184:187], a[88:91], v[112:115]
    ds_read_b64_tr_b16 a[166:167], v17 offset:41216
    ds_read_b64_tr_b16 a[168:169], v17 offset:30720
    v_mfma_f32_16x16x32_bf16 v[116:119], a[184:187], a[92:95], v[116:119]
    s_add_u32 s60, s64, s1
    ds_read_b64_tr_b16 a[170:171], v17 offset:30976
    v_add_f32 v67, 1.0, v67
    v_mfma_f32_16x16x32_bf16 v[124:127], a[188:191], a[92:95], v[124:127]
    s_add_u32 m0, s74, 0x0
    ds_read_b64_tr_b16 a[172:173], v17 offset:43008
    v_rcp_f32 v67, v67
    v_mfma_f32_16x16x32_bf16 v[120:123], a[188:191], a[88:91], v[120:123]
    s_waitcnt lgkmcnt(7)
    ds_read_b64_tr_b16 a[174:175], v17 offset:43264
    v_rcp_f32 v66, v66
    v_mul_f32 v72, v72, v64
    v_mfma_f32_16x16x32_bf16 v[128:131], a[144:147], a[48:51], v[128:131]
    ds_read_b64_tr_b16 a[176:177], v17 offset:32768
    v_mul_f32 v73, v73, v65
    v_mfma_f32_16x16x32_bf16 v[132:135], a[144:147], a[52:55], v[132:135]
    ds_read_b64_tr_b16 a[178:179], v17 offset:33024
    v_mul_f32 v74, v74, v66
    v_mfma_f32_16x16x32_bf16 v[140:143], a[148:151], a[52:55], v[140:143]
    buffer_load_dwordx4 v20, s[16:19], s60 offen offset:0 lds
    ds_read_b64_tr_b16 a[180:181], v17 offset:45056
    v_mfma_f32_16x16x32_bf16 v[136:139], a[148:151], a[48:51], v[136:139]
    ds_read_b64_tr_b16 a[182:183], v17 offset:45312
    v_cvt_pk_bf16_f32 v226, v72, v73
    v_mfma_f32_16x16x32_bf16 v[128:131], a[152:155], a[56:59], v[128:131]
    v_mul_f32 v75, v75, v67
    v_cvt_pk_bf16_f32 v227, v74, v75
    v_mfma_f32_16x16x32_bf16 v[132:135], a[152:155], a[60:63], v[132:135]
    ds_read_b64_tr_b16 a[184:185], v17 offset:34816
    ds_read_b64_tr_b16 a[186:187], v17 offset:35072
    v_mfma_f32_16x16x32_bf16 v[140:143], a[156:159], a[60:63], v[140:143]
    buffer_store_dwordx4 v[224:227], v40, s[24:27], s82 offen offset:0 sc1
    ds_read_b64_tr_b16 a[188:189], v17 offset:47104
    v_exp_f32 v68, v68
    v_mfma_f32_16x16x32_bf16 v[136:139], a[156:159], a[56:59], v[136:139]
    s_waitcnt lgkmcnt(7)
    ds_read_b64_tr_b16 a[190:191], v17 offset:47360
    ds_read_b64_tr_b16 a[144:145], v18 offset:0
    v_mfma_f32_16x16x32_bf16 v[128:131], a[160:163], a[64:67], v[128:131]
    v_exp_f32 v69, v69
    v_mfma_f32_16x16x32_bf16 v[132:135], a[160:163], a[68:71], v[132:135]
    buffer_load_dwordx4 v21, s[16:19], s60 offen offset:1024 lds
    ds_read_b64_tr_b16 a[146:147], v18 offset:256
    v_mfma_f32_16x16x32_bf16 v[140:143], a[164:167], a[68:71], v[140:143]
    ds_read_b64_tr_b16 a[148:149], v18 offset:12288
    v_exp_f32 v70, v70
    v_mfma_f32_16x16x32_bf16 v[136:139], a[164:167], a[64:67], v[136:139]
    buffer_load_dwordx4 v22, s[16:19], s60 offen offset:2048 lds
    ds_read_b64_tr_b16 a[150:151], v18 offset:12544
    v_mfma_f32_16x16x32_bf16 v[128:131], a[168:171], a[72:75], v[128:131]
    ds_read_b64_tr_b16 a[152:153], v18 offset:2048
    v_exp_f32 v71, v71
    v_mfma_f32_16x16x32_bf16 v[132:135], a[168:171], a[76:79], v[132:135]
    ds_read_b64_tr_b16 a[154:155], v18 offset:2304
    v_add_f32 v68, 1.0, v68
    v_mfma_f32_16x16x32_bf16 v[140:143], a[172:175], a[76:79], v[140:143]
    ds_read_b64_tr_b16 a[156:157], v18 offset:14336
    v_add_f32 v70, 1.0, v70
    v_mfma_f32_16x16x32_bf16 v[136:139], a[172:175], a[72:75], v[136:139]
    s_waitcnt lgkmcnt(7)
    ds_read_b64_tr_b16 a[158:159], v18 offset:14592
    v_add_f32 v69, 1.0, v69
    v_mfma_f32_16x16x32_bf16 v[128:131], a[176:179], a[80:83], v[128:131]
    buffer_load_dwordx4 v23, s[16:19], s60 offen offset:3072 lds
    ds_read_b64_tr_b16 a[160:161], v18 offset:4096
    v_mfma_f32_16x16x32_bf16 v[132:135], a[176:179], a[84:87], v[132:135]
    ds_read_b64_tr_b16 a[162:163], v18 offset:4352
    v_add_f32 v71, 1.0, v71
    v_mfma_f32_16x16x32_bf16 v[140:143], a[180:183], a[84:87], v[140:143]
    ds_read_b64_tr_b16 a[164:165], v18 offset:16384
    v_rcp_f32 v69, v69
    v_mfma_f32_16x16x32_bf16 v[136:139], a[180:183], a[80:83], v[136:139]
    s_add_u32 s60, s65, s1
    ds_read_b64_tr_b16 a[166:167], v18 offset:16640
    v_rcp_f32 v70, v70
    v_mfma_f32_16x16x32_bf16 v[128:131], a[184:187], a[88:91], v[128:131]
    ds_read_b64_tr_b16 a[168:169], v18 offset:6144
    v_rcp_f32 v68, v68
    v_mfma_f32_16x16x32_bf16 v[132:135], a[184:187], a[92:95], v[132:135]
    ds_read_b64_tr_b16 a[170:171], v18 offset:6400
    v_rcp_f32 v71, v71
    v_mfma_f32_16x16x32_bf16 v[140:143], a[188:191], a[92:95], v[140:143]
    ds_read_b64_tr_b16 a[172:173], v18 offset:18432
    v_mul_f32 v76, v76, v68
    v_mfma_f32_16x16x32_bf16 v[136:139], a[188:191], a[88:91], v[136:139]
    s_waitcnt lgkmcnt(7)
    ds_read_b64_tr_b16 a[174:175], v18 offset:18688
    v_mul_f32 v77, v77, v69
    v_mfma_f32_16x16x32_bf16 v[112:115], a[144:147], a[96:99], v[112:115]
    ds_read_b64_tr_b16 a[176:177], v18 offset:8192
    v_mul_f32 v78, v78, v70
    v_mfma_f32_16x16x32_bf16 v[116:119], a[144:147], a[100:103], v[116:119]
    ds_read_b64_tr_b16 a[178:179], v18 offset:8448
    v_mul_f32 v79, v79, v71
    v_mfma_f32_16x16x32_bf16 v[124:127], a[148:151], a[100:103], v[124:127]
    buffer_load_dword v46, off, s[24:27], s39 sc1
    ds_read_b64_tr_b16 a[180:181], v18 offset:20480
    v_mfma_f32_16x16x32_bf16 v[120:123], a[148:151], a[96:99], v[120:123]
    ds_read_b64_tr_b16 a[182:183], v18 offset:20736
    v_cvt_pk_bf16_f32 v231, v78, v79
    v_cvt_pk_bf16_f32 v230, v76, v77
    v_mfma_f32_16x16x32_bf16 v[112:115], a[152:155], a[104:107], v[112:115]
    s_add_u32 m0, s75, 0x0
    v_exp_f32 v81, v81
    v_mfma_f32_16x16x32_bf16 v[116:119], a[152:155], a[108:111], v[116:119]
    ds_read_b64_tr_b16 a[184:185], v18 offset:10240
    buffer_store_dwordx4 v[228:231], v40, s[24:27], s82 offen offset:1024 sc1
    buffer_load_dwordx4 v20, s[16:19], s60 offen offset:0 lds
    ds_read_b64_tr_b16 a[186:187], v18 offset:10496
    v_mfma_f32_16x16x32_bf16 v[124:127], a[156:159], a[108:111], v[124:127]
    ds_read_b64_tr_b16 a[188:189], v18 offset:22528
    v_exp_f32 v80, v80
    v_mfma_f32_16x16x32_bf16 v[120:123], a[156:159], a[104:107], v[120:123]
    s_waitcnt lgkmcnt(7)
    ds_read_b64_tr_b16 a[190:191], v18 offset:22784
    buffer_load_dwordx4 v21, s[16:19], s60 offen offset:1024 lds
    ds_read_b64_tr_b16 a[144:145], v19 offset:0
    v_mfma_f32_16x16x32_bf16 v[112:115], a[160:163], a[112:115], v[112:115]
    v_exp_f32 v82, v82
    v_mfma_f32_16x16x32_bf16 v[116:119], a[160:163], a[116:119], v[116:119]
    ds_read_b64_tr_b16 a[146:147], v19 offset:256
    v_add_f32 v82, 1.0, v82
    v_add_f32 v81, 1.0, v81
    v_mfma_f32_16x16x32_bf16 v[124:127], a[164:167], a[116:119], v[124:127]
    ds_read_b64_tr_b16 a[148:149], v19 offset:12288
    v_rcp_f32 v81, v81
    v_add_f32 v80, 1.0, v80
    v_mfma_f32_16x16x32_bf16 v[120:123], a[164:167], a[112:115], v[120:123]
    ds_read_b64_tr_b16 a[150:151], v19 offset:12544
    v_exp_f32 v83, v83
    v_mfma_f32_16x16x32_bf16 v[112:115], a[168:171], a[120:123], v[112:115]
    ds_read_b64_tr_b16 a[152:153], v19 offset:2048
    v_add_f32 v83, 1.0, v83
    v_mfma_f32_16x16x32_bf16 v[116:119], a[168:171], a[124:127], v[116:119]
    ds_read_b64_tr_b16 a[154:155], v19 offset:2304
    v_rcp_f32 v80, v80
    v_mfma_f32_16x16x32_bf16 v[124:127], a[172:175], a[124:127], v[124:127]
    ds_read_b64_tr_b16 a[156:157], v19 offset:14336
    v_rcp_f32 v82, v82
    v_mfma_f32_16x16x32_bf16 v[120:123], a[172:175], a[120:123], v[120:123]
    s_waitcnt lgkmcnt(7)
    ds_read_b64_tr_b16 a[158:159], v19 offset:14592
    v_rcp_f32 v83, v83
    v_mfma_f32_16x16x32_bf16 v[112:115], a[176:179], a[128:131], v[112:115]
    s_waitcnt vmcnt(9)
    ds_read_b64_tr_b16 a[160:161], v19 offset:4096
    s_barrier
    v_mfma_f32_16x16x32_bf16 v[116:119], a[176:179], a[132:135], v[116:119]
    s_add_u32 s60, s64, s3
    ds_read_b64_tr_b16 a[162:163], v19 offset:4352
    v_mul_f32 v91, v91, v83
    v_mfma_f32_16x16x32_bf16 v[124:127], a[180:183], a[132:135], v[124:127]
    ds_read_b64_tr_b16 a[164:165], v19 offset:16384
    v_mul_f32 v90, v90, v82
    v_mul_f32 v88, v88, v80
    v_cvt_pk_bf16_f32 v233, v90, v91
    v_mfma_f32_16x16x32_bf16 v[120:123], a[180:183], a[128:131], v[120:123]
    ds_read_b64_tr_b16 a[166:167], v19 offset:16640
    v_mul_f32 v89, v89, v81
    v_mfma_f32_16x16x32_bf16 v[112:115], a[184:187], a[136:139], v[112:115]
    ds_read_b64_tr_b16 a[168:169], v19 offset:6144
    v_exp_f32 v84, v84
    v_mfma_f32_16x16x32_bf16 v[116:119], a[184:187], a[140:143], v[116:119]
    ds_read_b64_tr_b16 a[170:171], v19 offset:6400
    v_cvt_pk_bf16_f32 v232, v88, v89
    v_mfma_f32_16x16x32_bf16 v[124:127], a[188:191], a[140:143], v[124:127]
    s_add_u32 m0, s74, 0x6000
    ds_read_b64_tr_b16 a[172:173], v19 offset:18432
    v_exp_f32 v86, v86
    v_mfma_f32_16x16x32_bf16 v[120:123], a[188:191], a[136:139], v[120:123]
    s_waitcnt lgkmcnt(7)
    ds_read_b64_tr_b16 a[174:175], v19 offset:18688
    v_exp_f32 v85, v85
    v_mfma_f32_16x16x32_bf16 v[128:131], a[144:147], a[96:99], v[128:131]
    ds_read_b64_tr_b16 a[176:177], v19 offset:8192
    v_add_f32 v85, 1.0, v85
    v_mfma_f32_16x16x32_bf16 v[132:135], a[144:147], a[100:103], v[132:135]
    ds_read_b64_tr_b16 a[178:179], v19 offset:8448
    v_add_f32 v86, 1.0, v86
    v_mfma_f32_16x16x32_bf16 v[140:143], a[148:151], a[100:103], v[140:143]
    ds_read_b64_tr_b16 a[180:181], v19 offset:20480
    buffer_load_dwordx4 v20, s[16:19], s60 offen offset:0 lds
    v_exp_f32 v87, v87
    v_mfma_f32_16x16x32_bf16 v[136:139], a[148:151], a[96:99], v[136:139]
    ds_read_b64_tr_b16 a[182:183], v19 offset:20736
    v_add_f32 v84, 1.0, v84
    v_mul_f32 v48, s68, v112
    v_mfma_f32_16x16x32_bf16 v[128:131], a[152:155], a[104:107], v[128:131]
    ds_read_b64_tr_b16 a[184:185], v19 offset:10240
    v_rcp_f32 v84, v84
    v_mfma_f32_16x16x32_bf16 v[132:135], a[152:155], a[108:111], v[132:135]
    ds_read_b64_tr_b16 a[186:187], v19 offset:10496
    v_mul_f32 v51, s68, v115
    v_mul_f32 v52, s68, v116
    v_mfma_f32_16x16x32_bf16 v[140:143], a[156:159], a[108:111], v[140:143]
    ds_read_b64_tr_b16 a[188:189], v19 offset:22528
    v_mul_f32 v50, s68, v114
    v_rcp_f32 v85, v85
    v_add_f32 v87, 1.0, v87
    v_mul_f32 v49, s68, v113
    v_mfma_f32_16x16x32_bf16 v[136:139], a[156:159], a[104:107], v[136:139]
    s_waitcnt lgkmcnt(7)
    buffer_load_dwordx4 v21, s[16:19], s60 offen offset:1024 lds
    ds_read_b64_tr_b16 a[190:191], v19 offset:22784
    v_mfma_f32_16x16x32_bf16 v[128:131], a[160:163], a[112:115], v[128:131]
    ds_read_b64_tr_b16 a[144:145], v32 offset:24576
    v_mul_f32 v59, v115, v123
    v_mul_f32 v58, v114, v122
    v_mfma_f32_16x16x32_bf16 v[132:135], a[160:163], a[116:119], v[132:135]
    ds_read_b64_tr_b16 a[146:147], v32 offset:26624
    v_mul_f32 v54, s68, v118
    v_mfma_f32_16x16x32_bf16 v[140:143], a[164:167], a[116:119], v[140:143]
    ds_read_b64_tr_b16 a[148:149], v33 offset:24576
    v_mul_f32 v56, v112, v120
    v_mfma_f32_16x16x32_bf16 v[136:139], a[164:167], a[112:115], v[136:139]
    buffer_load_dwordx4 v22, s[16:19], s60 offen offset:2048 lds
    ds_read_b64_tr_b16 a[150:151], v33 offset:26624
    v_mfma_f32_16x16x32_bf16 v[128:131], a[168:171], a[120:123], v[128:131]
    ds_read_b64_tr_b16 a[152:153], v32 offset:28672
    v_rcp_f32 v86, v86
    v_mfma_f32_16x16x32_bf16 v[132:135], a[168:171], a[124:127], v[132:135]
    ds_read_b64_tr_b16 a[154:155], v32 offset:30720
    v_mul_f32 v53, s68, v117
    v_mul_f32 v55, s68, v119
    v_mfma_f32_16x16x32_bf16 v[140:143], a[172:175], a[124:127], v[140:143]
    ds_read_b64_tr_b16 a[156:157], v33 offset:28672
    v_rcp_f32 v87, v87
    v_mfma_f32_16x16x32_bf16 v[136:139], a[172:175], a[120:123], v[136:139]
    s_waitcnt lgkmcnt(7)
    ds_read_b64_tr_b16 a[158:159], v33 offset:30720
    v_mul_f32 v92, v92, v84
    v_mul_f32 v93, v93, v85
    v_mfma_f32_16x16x32_bf16 v[128:131], a[176:179], a[128:131], v[128:131]
    ds_read_b64_tr_b16 a[160:161], v32 offset:32768
    buffer_load_dwordx4 v23, s[16:19], s60 offen offset:3072 lds
    ds_read_b64_tr_b16 a[162:163], v32 offset:34816
    v_mfma_f32_16x16x32_bf16 v[132:135], a[176:179], a[132:135], v[132:135]
    v_exp_f32 v97, v97
    v_mul_f32 v62, v118, v126
    v_mul_f32 v60, v116, v124
    v_exp_f32 v96, v96
    v_mul_f32 v61, v117, v125
    v_cvt_pk_bf16_f32 v236, v92, v93
    v_mfma_f32_16x16x32_bf16 v[140:143], a[180:183], a[132:135], v[140:143]
    ds_read_b64_tr_b16 a[164:165], v33 offset:32768
    v_mul_f32 v57, v113, v121
    v_mfma_f32_16x16x32_bf16 v[136:139], a[180:183], a[128:131], v[136:139]
    ds_read_b64_tr_b16 a[166:167], v33 offset:34816
    v_mul_f32 v94, v94, v86
    v_mfma_f32_16x16x32_bf16 v[128:131], a[184:187], a[136:139], v[128:131]
    s_add_u32 s60, s65, s3
    ds_read_b64_tr_b16 a[168:169], v32 offset:36864
    v_mul_f32 v63, v119, v127
    v_mfma_f32_16x16x32_bf16 v[132:135], a[184:187], a[140:143], v[132:135]
    ds_read_b64_tr_b16 a[170:171], v32 offset:38912
    v_mul_f32 v95, v95, v87
    v_mfma_f32_16x16x32_bf16 v[140:143], a[188:191], a[140:143], v[140:143]
    ds_read_b64_tr_b16 a[172:173], v33 offset:36864
    v_exp_f32 v98, v98
    v_mfma_f32_16x16x32_bf16 v[136:139], a[188:191], a[136:139], v[136:139]
    s_waitcnt lgkmcnt(7)
    ds_read_b64_tr_b16 a[174:175], v33 offset:38912
    v_cvt_pk_bf16_f32 v237, v94, v95
    v_mfma_f32_16x16x32_bf16 v[144:147], a[144:147], v[176:179], 0
    s_add_u32 m0, s75, 0x6000
    ds_read_b64_tr_b16 a[176:177], v32 offset:40960
    v_add_f32 v96, 1.0, v96
    v_mfma_f32_16x16x32_bf16 v[152:155], a[144:147], v[180:183], 0
    ds_read_b64_tr_b16 a[178:179], v32 offset:43008
    v_rcp_f32 v96, v96
    v_add_f32 v97, 1.0, v97
    v_mfma_f32_16x16x32_bf16 v[156:159], a[148:151], v[180:183], 0
    ds_read_b64_tr_b16 a[180:181], v33 offset:40960
    v_mul_f32 v65, s68, v129
    v_mfma_f32_16x16x32_bf16 v[148:151], a[148:151], v[176:179], 0
    ds_read_b64_tr_b16 a[182:183], v33 offset:43008
    v_exp_f32 v99, v99
    v_mfma_f32_16x16x32_bf16 v[144:147], a[152:155], v[184:187], v[144:147]
    ds_read_b64_tr_b16 a[184:185], v32 offset:45056
    v_mul_f32 v64, s68, v128
    v_mul_f32 v66, s68, v130
    v_mfma_f32_16x16x32_bf16 v[152:155], a[152:155], v[188:191], v[152:155]
    ds_read_b64_tr_b16 a[186:187], v32 offset:47104
    buffer_load_dwordx4 v20, s[16:19], s60 offen offset:0 lds
    v_add_f32 v99, 1.0, v99
    v_mfma_f32_16x16x32_bf16 v[156:159], a[156:159], v[188:191], v[156:159]
    ds_read_b64_tr_b16 a[188:189], v33 offset:45056
    v_rcp_f32 v97, v97
    v_mfma_f32_16x16x32_bf16 v[148:151], a[156:159], v[184:187], v[148:151]
    s_waitcnt lgkmcnt(7)
    ds_read_b64_tr_b16 a[190:191], v33 offset:47104
    v_mul_f32 v67, s68, v131
    v_mfma_f32_16x16x32_bf16 v[144:147], a[160:163], v[192:195], v[144:147]
    ds_read_b64_tr_b16 a[144:145], v34 offset:24576
    v_add_f32 v98, 1.0, v98
    v_mul_f32 v68, s68, v132
    v_mul_f32 v105, v105, v97
    v_mul_f32 v72, v128, v136
    v_mfma_f32_16x16x32_bf16 v[152:155], a[160:163], v[196:199], v[152:155]
    buffer_load_dwordx4 v21, s[16:19], s60 offen offset:1024 lds
    ds_read_b64_tr_b16 a[146:147], v34 offset:26624
    v_mfma_f32_16x16x32_bf16 v[156:159], a[164:167], v[196:199], v[156:159]
    ds_read_b64_tr_b16 a[148:149], v35 offset:24576
    v_mul_f32 v69, s68, v133
    v_mfma_f32_16x16x32_bf16 v[148:151], a[164:167], v[192:195], v[148:151]
    ds_read_b64_tr_b16 a[150:151], v35 offset:26624
    v_rcp_f32 v98, v98
    v_rcp_f32 v99, v99
    v_mfma_f32_16x16x32_bf16 v[144:147], a[168:171], v[200:203], v[144:147]
    ds_read_b64_tr_b16 a[152:153], v34 offset:28672
    v_mul_f32 v106, v106, v98
    v_mfma_f32_16x16x32_bf16 v[152:155], a[168:171], v[204:207], v[152:155]
    ds_read_b64_tr_b16 a[154:155], v34 offset:30720
    v_mul_f32 v70, s68, v134
    v_mul_f32 v107, v107, v99
    v_mfma_f32_16x16x32_bf16 v[156:159], a[172:175], v[204:207], v[156:159]
    ds_read_b64_tr_b16 a[156:157], v35 offset:28672
    v_mul_f32 v73, v129, v137
    v_mfma_f32_16x16x32_bf16 v[148:151], a[172:175], v[200:203], v[148:151]
    s_waitcnt lgkmcnt(7)
    ds_read_b64_tr_b16 a[158:159], v35 offset:30720
    v_mul_f32 v71, s68, v135
    v_mfma_f32_16x16x32_bf16 v[144:147], a[176:179], v[208:211], v[144:147]
    s_waitcnt vmcnt(6)
    ds_read_b64_tr_b16 a[160:161], v34 offset:32768
    v_cvt_pk_bf16_f32 v235, v106, v107
    v_mul_f32 v104, v104, v96
    s_barrier
    v_cvt_pk_bf16_f32 v234, v104, v105
    v_mfma_f32_16x16x32_bf16 v[152:155], a[176:179], v[212:215], v[152:155]
    buffer_store_dwordx4 v[232:235], v40, s[24:27], s82 offen offset:2048 sc1
    ds_read_b64_tr_b16 a[162:163], v34 offset:34816
    v_mul_f32 v75, v131, v139
    v_mul_f32 v74, v130, v138
    v_mfma_f32_16x16x32_bf16 v[156:159], a[180:183], v[212:215], v[156:159]
    ds_read_b64_tr_b16 a[164:165], v35 offset:32768
    v_mul_f32 v76, v132, v140
    v_mfma_f32_16x16x32_bf16 v[148:151], a[180:183], v[208:211], v[148:151]
    s_add_u32 m0, s76, 0xc000
    ds_read_b64_tr_b16 a[166:167], v35 offset:34816
    v_mul_f32 v77, v133, v141
    v_mfma_f32_16x16x32_bf16 v[144:147], a[184:187], v[216:219], v[144:147]
    ds_read_b64_tr_b16 a[168:169], v34 offset:36864
    v_mul_f32 v78, v134, v142
    v_mfma_f32_16x16x32_bf16 v[152:155], a[184:187], v[220:223], v[152:155]
    ds_read_b64_tr_b16 a[170:171], v34 offset:38912
    v_mul_f32 v79, v135, v143
    v_mfma_f32_16x16x32_bf16 v[156:159], a[188:191], v[220:223], v[156:159]
    ds_read_b64_tr_b16 a[172:173], v35 offset:36864
    ds_read_b64_tr_b16 a[174:175], v35 offset:38912
    v_mfma_f32_16x16x32_bf16 v[148:151], a[188:191], v[216:219], v[148:151]
    s_waitcnt lgkmcnt(8)
    v_exp_f32 v101, v101
    v_mfma_f32_16x16x32_bf16 v[160:163], a[144:147], v[176:179], 0
    buffer_load_dwordx4 v24, s[16:19], s71 offen offset:0 lds
    ds_read_b64_tr_b16 a[176:177], v34 offset:40960
    v_cmp_ne_u32 vcc, v46, v43
    v_exp_f32 v102, v102
    v_exp_f32 v100, v100
    v_exp_f32 v103, v103
    v_add_f32 v101, 1.0, v101
    v_mfma_f32_16x16x32_bf16 v[168:171], a[144:147], v[180:183], 0
    s_cbranch_vccnz SLOW3
BACK3:
    ds_read_b64_tr_b16 a[178:179], v34 offset:43008
    v_mfma_f32_16x16x32_bf16 v[172:175], a[148:151], v[180:183], 0
    ds_read_b64_tr_b16 a[180:181], v35 offset:40960
    buffer_load_dwordx4 a[192:195], v41, s[24:27], 0 offen offset:0 sc1
    v_mfma_f32_16x16x32_bf16 v[164:167], a[148:151], v[176:179], 0
    ds_read_b64_tr_b16 a[182:183], v35 offset:43008
    buffer_load_dwordx4 v25, s[16:19], s71 offen offset:1024 lds
    v_mfma_f32_16x16x32_bf16 v[160:163], a[152:155], v[184:187], v[160:163]
    s_add_u32 s39, s39, 0x10000
    ds_read_b64_tr_b16 a[184:185], v34 offset:45056
    v_add_f32 v100, 1.0, v100
    v_mfma_f32_16x16x32_bf16 v[168:171], a[152:155], v[188:191], v[168:171]
    ds_read_b64_tr_b16 a[186:187], v34 offset:47104
    v_add_f32 v102, 1.0, v102
    v_mfma_f32_16x16x32_bf16 v[172:175], a[156:159], v[188:191], v[172:175]
    ds_read_b64_tr_b16 a[188:189], v35 offset:45056
    v_rcp_f32 v100, v100
    v_mfma_f32_16x16x32_bf16 v[164:167], a[156:159], v[184:187], v[164:167]
    s_waitcnt lgkmcnt(7)
    ds_read_b64_tr_b16 a[190:191], v35 offset:47104
    v_mul_f32 v108, v108, v100
    v_add_f32 v103, 1.0, v103
    v_rcp_f32 v101, v101
    v_mfma_f32_16x16x32_bf16 v[160:163], a[160:163], v[192:195], v[160:163]
    ds_read_b64_tr_b16 a[144:145], v28 offset:0
    buffer_load_dwordx4 a[196:199], v41, s[24:27], 0 offen offset:1024 sc1
    buffer_load_dwordx4 v26, s[16:19], s71 offen offset:2048 lds
    ds_read_b64_tr_b16 a[146:147], v28 offset:2048
    v_mfma_f32_16x16x32_bf16 v[168:171], a[160:163], v[196:199], v[168:171]
    v_rcp_f32 v102, v102
    v_mfma_f32_16x16x32_bf16 v[172:175], a[164:167], v[196:199], v[172:175]
    ds_read_b64_tr_b16 a[148:149], v29 offset:0
    v_rcp_f32 v103, v103
    v_mfma_f32_16x16x32_bf16 v[164:167], a[164:167], v[192:195], v[164:167]
    ds_read_b64_tr_b16 a[150:151], v29 offset:2048
    v_mul_f32 v109, v109, v101
    v_mfma_f32_16x16x32_bf16 v[160:163], a[168:171], v[200:203], v[160:163]
    ds_read_b64_tr_b16 a[152:153], v28 offset:4096
    v_mul_f32 v110, v110, v102
    v_mfma_f32_16x16x32_bf16 v[168:171], a[168:171], v[204:207], v[168:171]
    ds_read_b64_tr_b16 a[154:155], v28 offset:6144
    buffer_load_dwordx4 v27, s[16:19], s71 offen offset:3072 lds
    v_mfma_f32_16x16x32_bf16 v[172:175], a[172:175], v[204:207], v[172:175]
    ds_read_b64_tr_b16 a[156:157], v29 offset:4096
    v_mul_f32 v111, v111, v103
    v_mfma_f32_16x16x32_bf16 v[164:167], a[172:175], v[200:203], v[164:167]
    s_waitcnt lgkmcnt(7)
    buffer_load_dwordx4 a[200:203], v41, s[24:27], 0 offen offset:2048 sc1
    ds_read_b64_tr_b16 a[158:159], v29 offset:6144
    v_mfma_f32_16x16x32_bf16 v[160:163], a[176:179], v[208:211], v[160:163]
    v_cvt_pk_bf16_f32 v239, v110, v111
    v_cvt_pk_bf16_f32 v238, v108, v109
    v_mfma_f32_16x16x32_bf16 v[168:171], a[176:179], v[212:215], v[168:171]
    ds_read_b64_tr_b16 a[160:161], v28 offset:8192
    buffer_store_dwordx4 v[236:239], v40, s[24:27], s82 offen offset:3072 sc1
    ds_read_b64_tr_b16 a[162:163], v28 offset:10240
    v_exp_f32 v48, v48
    v_mfma_f32_16x16x32_bf16 v[172:175], a[180:183], v[212:215], v[172:175]
    ds_read_b64_tr_b16 a[164:165], v29 offset:8192
    v_exp_f32 v49, v49
    v_mfma_f32_16x16x32_bf16 v[164:167], a[180:183], v[208:211], v[164:167]
    ds_read_b64_tr_b16 a[166:167], v29 offset:10240
    v_exp_f32 v50, v50
    v_mfma_f32_16x16x32_bf16 v[160:163], a[184:187], v[216:219], v[160:163]
    s_add_u32 s60, s71, 73728
    ds_read_b64_tr_b16 a[168:169], v28 offset:12288
    v_exp_f32 v51, v51
    v_mfma_f32_16x16x32_bf16 v[168:171], a[184:187], v[220:223], v[168:171]
    ds_read_b64_tr_b16 a[170:171], v28 offset:14336
    buffer_load_dwordx4 a[204:207], v41, s[24:27], 0 offen offset:3072 sc1
    v_mfma_f32_16x16x32_bf16 v[172:175], a[188:191], v[220:223], v[172:175]
    ds_read_b64_tr_b16 a[172:173], v29 offset:12288
    v_add_f32 v48, 1.0, v48
    v_mfma_f32_16x16x32_bf16 v[164:167], a[188:191], v[216:219], v[164:167]
    s_waitcnt lgkmcnt(7)
    ds_read_b64_tr_b16 a[174:175], v29 offset:14336
    ds_read_b64_tr_b16 a[176:177], v28 offset:16384
    v_mfma_f32_16x16x32_bf16 v[80:83], a[144:147], v[176:179], 0
    s_add_u32 m0, s76, 0xd000
    v_add_f32 v51, 1.0, v51
    v_add_f32 v50, 1.0, v50
    v_rcp_f32 v48, v48
    v_mfma_f32_16x16x32_bf16 v[88:91], a[144:147], v[180:183], 0
    ds_read_b64_tr_b16 a[178:179], v28 offset:18432
    v_add_f32 v49, 1.0, v49
    v_rcp_f32 v51, v51
    v_mfma_f32_16x16x32_bf16 v[92:95], a[148:151], v[180:183], 0
    ds_read_b64_tr_b16 a[180:181], v29 offset:16384
    v_rcp_f32 v50, v50
    v_mfma_f32_16x16x32_bf16 v[84:87], a[148:151], v[176:179], 0
    v_rcp_f32 v49, v49
    v_mfma_f32_16x16x32_bf16 v[80:83], a[152:155], v[184:187], v[80:83]
    ds_read_b64_tr_b16 a[182:183], v29 offset:18432
    buffer_load_dwordx4 a[208:211], v41, s[24:27], s80 offen offset:0 sc1
    buffer_load_dwordx4 v24, s[16:19], s60 offen offset:0 lds
    ds_read_b64_tr_b16 a[184:185], v28 offset:20480
    v_mfma_f32_16x16x32_bf16 v[88:91], a[152:155], v[188:191], v[88:91]
    ds_read_b64_tr_b16 a[186:187], v28 offset:22528
    v_mul_f32 v57, v57, v49
    v_mfma_f32_16x16x32_bf16 v[92:95], a[156:159], v[188:191], v[92:95]
    ds_read_b64_tr_b16 a[188:189], v29 offset:20480
    v_mul_f32 v59, v59, v51
    v_mul_f32 v56, v56, v48
    v_mfma_f32_16x16x32_bf16 v[84:87], a[156:159], v[184:187], v[84:87]
    s_waitcnt lgkmcnt(7)
    ds_read_b64_tr_b16 a[190:191], v29 offset:22528
    v_mul_f32 v58, v58, v50
    v_mfma_f32_16x16x32_bf16 v[80:83], a[160:163], v[192:195], v[80:83]
    ds_read_b64_tr_b16 a[144:145], v30 offset:0
    v_exp_f32 v52, v52
    v_exp_f32 v54, v54
    v_mfma_f32_16x16x32_bf16 v[88:91], a[160:163], v[196:199], v[88:91]
    buffer_load_dwordx4 v25, s[16:19], s60 offen offset:1024 lds
    ds_read_b64_tr_b16 a[146:147], v30 offset:2048
    v_mfma_f32_16x16x32_bf16 v[92:95], a[164:167], v[196:199], v[92:95]
    buffer_load_dwordx4 a[212:215], v41, s[24:27], s80 offen offset:1024 sc1
    ds_read_b64_tr_b16 a[148:149], v31 offset:0
    v_mfma_f32_16x16x32_bf16 v[84:87], a[164:167], v[192:195], v[84:87]
    ds_read_b64_tr_b16 a[150:151], v31 offset:2048
    v_exp_f32 v53, v53
    v_mfma_f32_16x16x32_bf16 v[80:83], a[168:171], v[200:203], v[80:83]
    ds_read_b64_tr_b16 a[152:153], v30 offset:4096
    v_cvt_pk_bf16_f32 v241, v58, v59
    v_mfma_f32_16x16x32_bf16 v[88:91], a[168:171], v[204:207], v[88:91]
    ds_read_b64_tr_b16 a[154:155], v30 offset:6144
    v_cvt_pk_bf16_f32 v240, v56, v57
    v_mfma_f32_16x16x32_bf16 v[92:95], a[172:175], v[204:207], v[92:95]
    ds_read_b64_tr_b16 a[156:157], v31 offset:4096
    v_add_f32 v52, 1.0, v52
    v_exp_f32 v55, v55
    v_mfma_f32_16x16x32_bf16 v[84:87], a[172:175], v[200:203], v[84:87]
    s_waitcnt lgkmcnt(7)
    ds_read_b64_tr_b16 a[158:159], v31 offset:6144
    v_add_f32 v55, 1.0, v55
    v_mfma_f32_16x16x32_bf16 v[80:83], a[176:179], v[208:211], v[80:83]
    s_waitcnt vmcnt(14)
    ds_read_b64_tr_b16 a[160:161], v30 offset:8192
    v_add_f32 v54, 1.0, v54
    v_add_f32 v53, 1.0, v53
    s_barrier
    v_mfma_f32_16x16x32_bf16 v[88:91], a[176:179], v[212:215], v[88:91]
    ds_read_b64_tr_b16 a[162:163], v30 offset:10240
    buffer_load_dwordx4 a[216:219], v41, s[24:27], s80 offen offset:2048 sc1
    ds_read_b64_tr_b16 a[164:165], v31 offset:8192
    v_mfma_f32_16x16x32_bf16 v[92:95], a[180:183], v[212:215], v[92:95]
    ds_read_b64_tr_b16 a[166:167], v31 offset:10240
    v_rcp_f32 v52, v52
    v_mfma_f32_16x16x32_bf16 v[84:87], a[180:183], v[208:211], v[84:87]
    ds_read_b64_tr_b16 a[168:169], v30 offset:12288
    v_rcp_f32 v53, v53
    v_mfma_f32_16x16x32_bf16 v[80:83], a[184:187], v[216:219], v[80:83]
    s_add_u32 s60, s66, s0
    v_rcp_f32 v54, v54
    v_mfma_f32_16x16x32_bf16 v[88:91], a[184:187], v[220:223], v[88:91]
    s_add_u32 m0, s74, 0x12000
    ds_read_b64_tr_b16 a[170:171], v30 offset:14336
    v_rcp_f32 v55, v55
    v_mfma_f32_16x16x32_bf16 v[92:95], a[188:191], v[220:223], v[92:95]
    ds_read_b64_tr_b16 a[172:173], v31 offset:12288
    v_mul_f32 v61, v61, v53
    v_mfma_f32_16x16x32_bf16 v[84:87], a[188:191], v[216:219], v[84:87]
    s_waitcnt lgkmcnt(7)
    ds_read_b64_tr_b16 a[174:175], v31 offset:14336
    buffer_load_dwordx4 a[220:223], v41, s[24:27], s80 offen offset:3072 sc1
    ds_read_b64_tr_b16 a[176:177], v30 offset:16384
    v_mfma_f32_16x16x32_bf16 v[96:99], a[144:147], v[176:179], 0
    v_mul_f32 v62, v62, v54
    v_mul_f32 v63, v63, v55
    v_mfma_f32_16x16x32_bf16 v[104:107], a[144:147], v[180:183], 0
    ds_read_b64_tr_b16 a[178:179], v30 offset:18432
    v_exp_f32 v65, v65
    v_mfma_f32_16x16x32_bf16 v[108:111], a[148:151], v[180:183], 0
    buffer_load_dwordx4 v20, s[16:19], s60 offen offset:0 lds
    ds_read_b64_tr_b16 a[180:181], v31 offset:16384
    v_cvt_pk_bf16_f32 v245, v62, v63
    v_mfma_f32_16x16x32_bf16 v[100:103], a[148:151], v[176:179], 0
    ds_read_b64_tr_b16 a[182:183], v31 offset:18432
    v_mul_f32 v60, v60, v52
    v_mfma_f32_16x16x32_bf16 v[96:99], a[152:155], v[184:187], v[96:99]
    ds_read_b64_tr_b16 a[184:185], v30 offset:20480
    v_cvt_pk_bf16_f32 v244, v60, v61
    v_mfma_f32_16x16x32_bf16 v[104:107], a[152:155], v[188:191], v[104:107]
    ds_read_b64_tr_b16 a[186:187], v30 offset:22528
    v_exp_f32 v64, v64
    v_mfma_f32_16x16x32_bf16 v[108:111], a[156:159], v[188:191], v[108:111]
    buffer_load_dwordx4 a[224:227], v41, s[24:27], s81 offen offset:0 sc1
    ds_read_b64_tr_b16 a[188:189], v31 offset:20480
    v_mfma_f32_16x16x32_bf16 v[100:103], a[156:159], v[184:187], v[100:103]
    s_waitcnt lgkmcnt(7)
    buffer_load_dwordx4 v21, s[16:19], s60 offen offset:1024 lds
    ds_read_b64_tr_b16 a[190:191], v31 offset:22528
    v_mfma_f32_16x16x32_bf16 v[96:99], a[160:163], v[192:195], v[96:99]
    ds_read_b64_tr_b16 a[144:145], v28 offset:24576
    v_exp_f32 v67, v67
    v_mfma_f32_16x16x32_bf16 v[104:107], a[160:163], v[196:199], v[104:107]
    ds_read_b64_tr_b16 a[146:147], v28 offset:26624
    v_exp_f32 v66, v66
    v_mfma_f32_16x16x32_bf16 v[108:111], a[164:167], v[196:199], v[108:111]
    ds_read_b64_tr_b16 a[148:149], v29 offset:24576
    v_add_f32 v67, 1.0, v67
    v_add_f32 v65, 1.0, v65
    v_mfma_f32_16x16x32_bf16 v[100:103], a[164:167], v[192:195], v[100:103]
    buffer_load_dwordx4 v22, s[16:19], s60 offen offset:2048 lds
    ds_read_b64_tr_b16 a[150:151], v29 offset:26624
    v_add_f32 v66, 1.0, v66
    v_add_f32 v64, 1.0, v64
    v_mfma_f32_16x16x32_bf16 v[96:99], a[168:171], v[200:203], v[96:99]
    ds_read_b64_tr_b16 a[152:153], v28 offset:28672
    buffer_load_dwordx4 a[228:231], v41, s[24:27], s81 offen offset:1024 sc1
    ds_read_b64_tr_b16 a[154:155], v28 offset:30720
    v_mfma_f32_16x16x32_bf16 v[104:107], a[168:171], v[204:207], v[104:107]
    v_rcp_f32 v64, v64
    v_mfma_f32_16x16x32_bf16 v[108:111], a[172:175], v[204:207], v[108:111]
    ds_read_b64_tr_b16 a[156:157], v29 offset:28672
    v_rcp_f32 v65, v65
    v_mfma_f32_16x16x32_bf16 v[100:103], a[172:175], v[200:203], v[100:103]
    s_waitcnt lgkmcnt(7)
    ds_read_b64_tr_b16 a[158:159], v29 offset:30720
    v_rcp_f32 v66, v66
    v_mfma_f32_16x16x32_bf16 v[96:99], a[176:179], v[208:211], v[96:99]
    ds_read_b64_tr_b16 a[160:161], v28 offset:32768
    buffer_load_dwordx4 v23, s[16:19], s60 offen offset:3072 lds
    ds_read_b64_tr_b16 a[162:163], v28 offset:34816
    v_rcp_f32 v67, v67
    v_mfma_f32_16x16x32_bf16 v[104:107], a[176:179], v[212:215], v[104:107]
    v_mul_f32 v75, v75, v67
    v_mul_f32 v73, v73, v65
    v_mfma_f32_16x16x32_bf16 v[108:111], a[180:183], v[212:215], v[108:111]
    ds_read_b64_tr_b16 a[164:165], v29 offset:32768
    v_mul_f32 v72, v72, v64
    v_mfma_f32_16x16x32_bf16 v[100:103], a[180:183], v[208:211], v[100:103]
    ds_read_b64_tr_b16 a[166:167], v29 offset:34816
    buffer_load_dwordx4 a[232:235], v41, s[24:27], s81 offen offset:2048 sc1
    v_mfma_f32_16x16x32_bf16 v[96:99], a[184:187], v[216:219], v[96:99]
    s_add_u32 s60, s67, s0
    ds_read_b64_tr_b16 a[168:169], v28 offset:36864
    v_mul_f32 v74, v74, v66
    v_mfma_f32_16x16x32_bf16 v[104:107], a[184:187], v[220:223], v[104:107]
    ds_read_b64_tr_b16 a[170:171], v28 offset:38912
    v_cvt_pk_bf16_f32 v242, v72, v73
    v_mfma_f32_16x16x32_bf16 v[108:111], a[188:191], v[220:223], v[108:111]
    ds_read_b64_tr_b16 a[172:173], v29 offset:36864
    v_cvt_pk_bf16_f32 v243, v74, v75
    v_mfma_f32_16x16x32_bf16 v[100:103], a[188:191], v[216:219], v[100:103]
    ds_read_b64_tr_b16 a[174:175], v29 offset:38912
    buffer_store_dwordx4 v[240:243], v40, s[24:27], s83 offen offset:0 sc1
    v_exp_f32 v68, v68
    s_waitcnt lgkmcnt(8)
    v_mfma_f32_16x16x32_bf16 v[112:115], a[144:147], v[176:179], 0
    ds_read_b64_tr_b16 a[176:177], v28 offset:40960
    v_exp_f32 v69, v69
    v_mfma_f32_16x16x32_bf16 v[120:123], a[144:147], v[180:183], 0
    ds_read_b64_tr_b16 a[178:179], v28 offset:43008
    buffer_load_dwordx4 a[236:239], v41, s[24:27], s81 offen offset:3072 sc1
    v_mfma_f32_16x16x32_bf16 v[124:127], a[148:151], v[180:183], 0
    ds_read_b64_tr_b16 a[180:181], v29 offset:40960
    v_exp_f32 v70, v70
    v_mfma_f32_16x16x32_bf16 v[116:119], a[148:151], v[176:179], 0
    ds_read_b64_tr_b16 a[182:183], v29 offset:43008
    v_exp_f32 v71, v71
    v_mfma_f32_16x16x32_bf16 v[112:115], a[152:155], v[184:187], v[112:115]
    s_add_u32 m0, s75, 0x12000
    ds_read_b64_tr_b16 a[184:185], v28 offset:45056
    v_add_f32 v69, 1.0, v69
    v_mfma_f32_16x16x32_bf16 v[120:123], a[152:155], v[188:191], v[120:123]
    ds_read_b64_tr_b16 a[186:187], v28 offset:47104
    buffer_load_dwordx4 v20, s[16:19], s60 offen offset:0 lds
    v_add_f32 v71, 1.0, v71
    v_mfma_f32_16x16x32_bf16 v[124:127], a[156:159], v[188:191], v[124:127]
    ds_read_b64_tr_b16 a[188:189], v29 offset:45056
    v_add_f32 v68, 1.0, v68
    v_mfma_f32_16x16x32_bf16 v[116:119], a[156:159], v[184:187], v[116:119]
    s_waitcnt lgkmcnt(7)
    ds_read_b64_tr_b16 a[190:191], v29 offset:47104
    v_add_f32 v70, 1.0, v70
    v_mfma_f32_16x16x32_bf16 v[112:115], a[160:163], v[192:195], v[112:115]
    ds_read_b64_tr_b16 a[144:145], v30 offset:24576
    v_rcp_f32 v69, v69
    v_mfma_f32_16x16x32_bf16 v[120:123], a[160:163], v[196:199], v[120:123]
    buffer_load_dwordx4 v21, s[16:19], s60 offen offset:1024 lds
    ds_read_b64_tr_b16 a[146:147], v30 offset:26624
    v_rcp_f32 v71, v71
    v_mfma_f32_16x16x32_bf16 v[124:127], a[164:167], v[196:199], v[124:127]
    ds_read_b64_tr_b16 a[148:149], v31 offset:24576
    v_mul_f32 v77, v77, v69
    v_rcp_f32 v68, v68
    v_mfma_f32_16x16x32_bf16 v[116:119], a[164:167], v[192:195], v[116:119]
    ds_read_b64_tr_b16 a[150:151], v31 offset:26624
    v_rcp_f32 v70, v70
    v_mfma_f32_16x16x32_bf16 v[112:115], a[168:171], v[200:203], v[112:115]
    ds_read_b64_tr_b16 a[152:153], v30 offset:28672
    v_mul_f32 v76, v76, v68
    v_mfma_f32_16x16x32_bf16 v[120:123], a[168:171], v[204:207], v[120:123]
    ds_read_b64_tr_b16 a[154:155], v30 offset:30720
    v_cvt_pk_bf16_f32 v246, v76, v77
    v_mfma_f32_16x16x32_bf16 v[124:127], a[172:175], v[204:207], v[124:127]
    ds_read_b64_tr_b16 a[156:157], v31 offset:28672
    v_mul_f32 v78, v78, v70
    v_mul_f32 v79, v79, v71
    v_mfma_f32_16x16x32_bf16 v[116:119], a[172:175], v[200:203], v[116:119]
    s_waitcnt lgkmcnt(7)
    ds_read_b64_tr_b16 a[158:159], v31 offset:30720
    v_cvt_pk_bf16_f32 v247, v78, v79
    v_mfma_f32_16x16x32_bf16 v[112:115], a[176:179], v[208:211], v[112:115]
    s_waitcnt vmcnt(14)
    buffer_store_dwordx4 v[244:247], v40, s[24:27], s83 offen offset:1024 sc1
    ds_read_b64_tr_b16 a[160:161], v30 offset:32768
    s_mul_i32 s55, s53, 80
    s_barrier
    v_mfma_f32_16x16x32_bf16 v[120:123], a[176:179], v[212:215], v[120:123]
    s_lshl3_add_u32 s55, s51, s55
    ds_read_b64_tr_b16 a[162:163], v30 offset:34816
    v_add_u32 v68, s55, v1
    v_mfma_f32_16x16x32_bf16 v[124:127], a[180:183], v[212:215], v[124:127]
    s_lshl3_add_u32 s56, s53, s50
    ds_read_b64_tr_b16 a[164:165], v31 offset:32768
    v_cmp_gt_u32 vcc, 8, v1
    v_mfma_f32_16x16x32_bf16 v[116:119], a[180:183], v[208:211], v[116:119]
    s_add_u32 s56, s56, 64
    ds_read_b64_tr_b16 a[166:167], v31 offset:34816
    v_and_b32 v69, 1, v1
    v_mfma_f32_16x16x32_bf16 v[112:115], a[184:187], v[216:219], v[112:115]
    s_mov_b32 s57, 0x2d40000
    ds_read_b64_tr_b16 a[168:169], v30 offset:36864
    v_lshl_add_u32 v69, v69, 2, s56
    v_mfma_f32_16x16x32_bf16 v[120:123], a[184:187], v[220:223], v[120:123]
    s_add_u32 s60, s66, s1
    ds_read_b64_tr_b16 a[170:171], v30 offset:38912
    v_cndmask_b32 v68, v69, v68, vcc
    v_mfma_f32_16x16x32_bf16 v[124:127], a[188:191], v[220:223], v[124:127]
    s_add_u32 m0, s74, 0x0
    ds_read_b64_tr_b16 a[172:173], v31 offset:36864
    v_lshl_add_u32 v0, v68, 6, s57
    v_mfma_f32_16x16x32_bf16 v[116:119], a[188:191], v[216:219], v[116:119]
    s_waitcnt lgkmcnt(7)
    ds_read_b64_tr_b16 a[174:175], v31 offset:38912
    buffer_load_dword v46, v0, s[24:27], 0 offen sc1
    v_mfma_f32_16x16x32_bf16 v[128:131], a[144:147], v[176:179], 0
    ds_read_b64_tr_b16 a[176:177], v30 offset:40960
    v_and_b32 v64, 15, v1
    v_mfma_f32_16x16x32_bf16 v[136:139], a[144:147], v[180:183], 0
    s_lshr_b32 s56, s51, 1
    ds_read_b64_tr_b16 a[178:179], v30 offset:43008
    v_lshrrev_b32 v65, 4, v1
    v_mfma_f32_16x16x32_bf16 v[140:143], a[148:151], v[180:183], 0
    s_lshl_b32 s56, s56, 14
    ds_read_b64_tr_b16 a[180:181], v31 offset:40960
    buffer_load_dwordx4 v20, s[16:19], s60 offen offset:0 lds
    v_mfma_f32_16x16x32_bf16 v[132:135], a[148:151], v[176:179], 0
    s_and_b32 s57, s51, 1
    ds_read_b64_tr_b16 a[182:183], v31 offset:43008
    s_lshl_b32 s57, s57, 6
    v_mfma_f32_16x16x32_bf16 v[128:131], a[152:155], v[184:187], v[128:131]
    s_add_u32 s56, s56, s57
    s_add_u32 s56, s56, 0x1bf80
    ds_read_b64_tr_b16 a[184:185], v30 offset:45056
    v_lshl_add_u32 v66, v64, 2, s56
    v_mfma_f32_16x16x32_bf16 v[136:139], a[152:155], v[188:191], v[136:139]
    s_lshr_b32 s56, s50, 1
    ds_read_b64_tr_b16 a[186:187], v30 offset:47104
    buffer_load_dwordx4 v21, s[16:19], s60 offen offset:1024 lds
    ds_read_b32 v67, v66
    v_mfma_f32_16x16x32_bf16 v[140:143], a[156:159], v[188:191], v[140:143]
    ds_read_b64_tr_b16 a[188:189], v31 offset:45056
    s_lshl1_add_u32 s56, s54, s56
    v_mfma_f32_16x16x32_bf16 v[132:135], a[156:159], v[184:187], v[132:135]
    s_mul_i32 s56, s56, 73728
    ds_read_b64_tr_b16 a[190:191], v31 offset:47104
    s_waitcnt lgkmcnt(9)
    ds_read_b64_tr_b16 a[144:145], v38 offset:0
    v_lshlrev_b32 v72, 4, v65
    v_mfma_f32_16x16x32_bf16 v[128:131], a[160:163], v[192:195], v[128:131]
    s_lshl_b32 s55, s55, 9
    ds_read_b64_tr_b16 a[146:147], v38 offset:1024
    s_add_u32 s55, s55, s56
    v_mfma_f32_16x16x32_bf16 v[136:139], a[160:163], v[196:199], v[136:139]
    s_and_b32 s56, s50, 1
    s_lshl_b32 s56, s56, 6
    s_add_u32 s55, s55, s56
    v_mfma_f32_16x16x32_bf16 v[140:143], a[164:167], v[196:199], v[140:143]
    s_add_u32 s55, s55, 0x2800000
    ds_read_b64_tr_b16 a[148:149], v39 offset:0
    v_lshl_add_u32 v70, v64, 7, v72
    v_mfma_f32_16x16x32_bf16 v[132:135], a[164:167], v[192:195], v[132:135]
    s_lshr_b32 s56, s51, 2
    ds_read_b64_tr_b16 a[150:151], v39 offset:1024
    buffer_load_dwordx4 v22, s[16:19], s60 offen offset:2048 lds
    v_mfma_f32_16x16x32_bf16 v[128:131], a[168:171], v[200:203], v[128:131]
    s_lshl1_add_u32 s56, s54, s56
    ds_read_b64_tr_b16 a[152:153], v38 offset:2048
    v_add_u32 v2, s55, v70
    v_mfma_f32_16x16x32_bf16 v[136:139], a[168:171], v[204:207], v[136:139]
    s_lshl3_add_u32 s55, s53, s50
    s_mul_i32 s56, s56, 73728
    ds_read_b64_tr_b16 a[154:155], v38 offset:3072
    s_lshl_b32 s55, s55, 9
    s_add_u32 s55, s55, s56
    v_mfma_f32_16x16x32_bf16 v[140:143], a[172:175], v[204:207], v[140:143]
    s_and_b32 s56, s51, 2
    ds_read_b64_tr_b16 a[156:157], v39 offset:2048
    v_bfe_u32 v68, v1, 2, 1
    v_mfma_f32_16x16x32_bf16 v[132:135], a[172:175], v[200:203], v[132:135]
    s_lshl_b32 s56, s56, 5
    ds_read_b64_tr_b16 a[158:159], v39 offset:3072
    s_waitcnt lgkmcnt(8)
    v_mfma_f32_16x16x32_bf16 v[128:131], a[176:179], v[208:211], v[128:131]
    buffer_load_dwordx4 v23, s[16:19], s60 offen offset:3072 lds
    ds_read_b64_tr_b16 a[160:161], v38 offset:4096
    v_mfma_f32_16x16x32_bf16 v[136:139], a[176:179], v[212:215], v[136:139]
    s_add_u32 s55, s55, s56
    ds_read_b64_tr_b16 a[162:163], v38 offset:5120
    v_and_b32 v70, 3, v1
    v_mfma_f32_16x16x32_bf16 v[140:143], a[180:183], v[212:215], v[140:143]
    ds_read_b64_tr_b16 a[164:165], v39 offset:4096
    v_lshl_add_u32 v70, v68, 4, v70
    v_lshl_add_u32 v70, v70, 7, v72
    v_mfma_f32_16x16x32_bf16 v[132:135], a[180:183], v[208:211], v[132:135]
    s_add_u32 s55, s55, 0x2808000
    ds_read_b64_tr_b16 a[166:167], v39 offset:5120
    v_add_u32 v3, s55, v70
    v_mfma_f32_16x16x32_bf16 v[128:131], a[184:187], v[216:219], v[128:131]
    s_add_u32 s60, s67, s1
    ds_read_b64_tr_b16 a[168:169], v38 offset:6144
    v_and_b32 v68, 1, v1
    v_mfma_f32_16x16x32_bf16 v[136:139], a[184:187], v[220:223], v[136:139]
    ds_read_b64_tr_b16 a[170:171], v38 offset:7168
    v_lshlrev_b32 v68, 4, v68
    v_mfma_f32_16x16x32_bf16 v[140:143], a[188:191], v[220:223], v[140:143]
    ds_read_b64_tr_b16 a[172:173], v39 offset:6144
    v_mov_b32 v73, 0xffff
    v_mfma_f32_16x16x32_bf16 v[132:135], a[188:191], v[216:219], v[132:135]
    s_waitcnt lgkmcnt(7)
    ds_read_b64_tr_b16 a[174:175], v39 offset:7168
    v_lshlrev_b32 v68, v68, v73
    v_bfe_u32 v73, v1, 1, 2
    v_mfma_f32_16x16x32_bf16 v[48:51], a[144:147], v[176:179], 0
    ds_read_b64_tr_b16 a[176:177], v38 offset:8192
    v_cmp_eq_u32 vcc, 0, v73
    v_mfma_f32_16x16x32_bf16 v[56:59], a[144:147], v[180:183], 0
    ds_read_b64_tr_b16 a[178:179], v38 offset:9216
    v_cndmask_b32 v74, 0, v68, vcc
    v_mfma_f32_16x16x32_bf16 v[60:63], a[148:151], v[180:183], 0
    s_add_u32 m0, s75, 0x0
    ds_read_b64_tr_b16 a[180:181], v39 offset:8192
    buffer_load_dwordx4 v20, s[16:19], s60 offen offset:0 lds
    ds_read_b64_tr_b16 a[182:183], v39 offset:9216
    v_cmp_eq_u32 vcc, 1, v73
    v_mfma_f32_16x16x32_bf16 v[52:55], a[148:151], v[176:179], 0
    ds_read_b64_tr_b16 a[184:185], v38 offset:10240
    v_cndmask_b32 v75, 0, v68, vcc
    v_cmp_eq_u32 vcc, 2, v73
    v_mfma_f32_16x16x32_bf16 v[48:51], a[152:155], v[184:187], v[48:51]
    ds_read_b64_tr_b16 a[186:187], v38 offset:11264
    v_cndmask_b32 v76, 0, v68, vcc
    v_mfma_f32_16x16x32_bf16 v[56:59], a[152:155], v[188:191], v[56:59]
    v_cmp_eq_u32 vcc, 3, v73
    v_bfe_u32 v69, v1, 3, 1
    v_mfma_f32_16x16x32_bf16 v[60:63], a[156:159], v[188:191], v[60:63]
    ds_read_b64_tr_b16 a[188:189], v39 offset:10240
    v_cndmask_b32 v77, 0, v68, vcc
    v_mfma_f32_16x16x32_bf16 v[52:55], a[156:159], v[184:187], v[52:55]
    s_waitcnt lgkmcnt(7)
    ds_read_b64_tr_b16 a[190:191], v39 offset:11264
    ds_read_b64_tr_b16 a[144:145], v38 offset:12288
    v_mfma_f32_16x16x32_bf16 v[48:51], a[160:163], v[192:195], v[48:51]
    s_waitcnt vmcnt(6)
    ds_read_b64_tr_b16 a[146:147], v38 offset:13312
    buffer_store_dword v43, v42, s[24:27], s38 offen offset:0 sc1
    ds_read_b64_tr_b16 a[148:149], v39 offset:12288
    v_mfma_f32_16x16x32_bf16 v[56:59], a[160:163], v[196:199], v[56:59]
    buffer_load_dwordx4 v21, s[16:19], s60 offen offset:1024 lds
    v_cmp_eq_u32 vcc, 0, v69
    v_mfma_f32_16x16x32_bf16 v[60:63], a[164:167], v[196:199], v[60:63]
    v_mov_b32 v73, 0x3f803f80
    v_and_b32 v68, v68, v73
    v_mfma_f32_16x16x32_bf16 v[52:55], a[164:167], v[192:195], v[52:55]
    ds_read_b64_tr_b16 a[150:151], v39 offset:13312
    v_cndmask_b32 v78, 0, v73, vcc
    v_mfma_f32_16x16x32_bf16 v[48:51], a[168:171], v[200:203], v[48:51]
    ds_read_b64_tr_b16 a[152:153], v38 offset:14336
    v_and_b32 v10, v74, v78
    v_mfma_f32_16x16x32_bf16 v[56:59], a[168:171], v[204:207], v[56:59]
    ds_read_b64_tr_b16 a[154:155], v38 offset:15360
    v_and_b32 v12, v76, v78
    v_mfma_f32_16x16x32_bf16 v[60:63], a[172:175], v[204:207], v[60:63]
    ds_read_b64_tr_b16 a[156:157], v39 offset:14336
    v_and_b32 v11, v75, v78
    v_mfma_f32_16x16x32_bf16 v[52:55], a[172:175], v[200:203], v[52:55]
    s_waitcnt lgkmcnt(7)
    ds_read_b64_tr_b16 a[158:159], v39 offset:15360
    v_bfe_u32 v73, v1, 2, 2
    v_mfma_f32_16x16x32_bf16 v[48:51], a[176:179], v[208:211], v[48:51]
    ds_read_b64_tr_b16 a[160:161], v38 offset:16384
    v_cmp_eq_u32 vcc, v65, v73
    s_barrier
    v_mfma_f32_16x16x32_bf16 v[56:59], a[176:179], v[212:215], v[56:59]
    s_add_u32 s60, s66, s3
    ds_read_b64_tr_b16 a[162:163], v38 offset:17408
    v_and_b32 v79, 2, v1
    v_mfma_f32_16x16x32_bf16 v[60:63], a[180:183], v[212:215], v[60:63]
    s_add_u32 m0, s74, 0x6000
    ds_read_b64_tr_b16 a[164:165], v39 offset:16384
    v_cndmask_b32 v68, 0, v68, vcc
    v_mfma_f32_16x16x32_bf16 v[52:55], a[180:183], v[208:211], v[52:55]
    ds_read_b64_tr_b16 a[166:167], v39 offset:17408
    v_mov_b32 v4, 0
    v_mfma_f32_16x16x32_bf16 v[48:51], a[184:187], v[216:219], v[48:51]
    ds_read_b64_tr_b16 a[168:169], v38 offset:18432
    v_and_b32 v13, v77, v78
    v_mov_b32 v9, 0
    v_mov_b32 v5, 0
    v_mfma_f32_16x16x32_bf16 v[56:59], a[184:187], v[220:223], v[56:59]
    ds_read_b64_tr_b16 a[170:171], v38 offset:19456
    v_mov_b32 v8, 0
    v_mfma_f32_16x16x32_bf16 v[60:63], a[188:191], v[220:223], v[60:63]
    ds_read_b64_tr_b16 a[172:173], v39 offset:18432
    v_cmp_eq_u32 vcc, 0, v79
    v_mfma_f32_16x16x32_bf16 v[52:55], a[188:191], v[216:219], v[52:55]
    s_waitcnt lgkmcnt(7)
    ds_read_b64_tr_b16 a[174:175], v39 offset:19456
    v_cndmask_b32 v6, 0, v68, vcc
    v_mfma_f32_16x16x32_bf16 v[48:51], a[144:147], a[192:195], v[48:51]
    ds_read_b64_tr_b16 a[176:177], v38 offset:20480
    buffer_load_dwordx4 v20, s[16:19], s60 offen offset:0 lds
    v_mfma_f32_16x16x32_bf16 v[56:59], a[144:147], a[196:199], v[56:59]
    ds_read_b64_tr_b16 a[178:179], v38 offset:21504
    v_xor_b32 v7, v68, v6
    v_mfma_f32_16x16x32_bf16 v[60:63], a[148:151], a[196:199], v[60:63]
    ds_read_b64_tr_b16 a[180:181], v39 offset:20480
    v_cmp_eq_u32 vcc, v65, v69
    v_mfma_f32_16x16x32_bf16 v[52:55], a[148:151], a[192:195], v[52:55]
    buffer_load_dwordx4 v21, s[16:19], s60 offen offset:1024 lds
    ds_read_b64_tr_b16 a[182:183], v39 offset:21504
    v_add_u32 v73, 2, v69
    v_mfma_f32_16x16x32_bf16 v[48:51], a[152:155], a[200:203], v[48:51]
    ds_read_b64_tr_b16 a[184:185], v38 offset:22528
    v_cndmask_b32 v78, 0, v36, vcc
    v_cmp_eq_u32 vcc, v65, v73
    v_mfma_f32_16x16x32_bf16 v[56:59], a[152:155], a[204:207], v[56:59]
    ds_read_b64_tr_b16 a[186:187], v38 offset:23552
    v_cndmask_b32 v79, 0, v37, vcc
    v_mfma_f32_16x16x32_bf16 v[60:63], a[156:159], a[204:207], v[60:63]
    buffer_load_dwordx4 v22, s[16:19], s60 offen offset:2048 lds
    ds_read_b64_tr_b16 a[188:189], v39 offset:22528
    v_mfma_f32_16x16x32_bf16 v[52:55], a[156:159], a[200:203], v[52:55]
    s_waitcnt lgkmcnt(7)
    ds_read_b64_tr_b16 a[190:191], v39 offset:23552
    v_and_b32 v248, v74, v78
    v_mfma_f32_16x16x32_bf16 v[48:51], a[160:163], a[208:211], v[48:51]
    ds_read_b64_tr_b16 a[144:145], v32 offset:24576
    v_and_b32 v249, v75, v78
    v_mfma_f32_16x16x32_bf16 v[56:59], a[160:163], a[212:215], v[56:59]
    ds_read_b64_tr_b16 a[146:147], v32 offset:26624
    v_and_b32 v253, v75, v79
    v_mfma_f32_16x16x32_bf16 v[60:63], a[164:167], a[212:215], v[60:63]
    buffer_load_dwordx4 v23, s[16:19], s60 offen offset:3072 lds
    ds_read_b64_tr_b16 a[148:149], v33 offset:24576
    v_mfma_f32_16x16x32_bf16 v[52:55], a[164:167], a[208:211], v[52:55]
    ds_read_b64_tr_b16 a[150:151], v33 offset:26624
    v_and_b32 v250, v76, v78
    v_mfma_f32_16x16x32_bf16 v[48:51], a[168:171], a[216:219], v[48:51]
    s_add_u32 s60, s67, s3
    ds_read_b64_tr_b16 a[152:153], v32 offset:28672
    v_and_b32 v254, v76, v79
    v_mfma_f32_16x16x32_bf16 v[56:59], a[168:171], a[220:223], v[56:59]
    s_and_b32 s55, s51, 1
    ds_read_b64_tr_b16 a[154:155], v32 offset:30720
    v_and_b32 v251, v77, v78
    v_mfma_f32_16x16x32_bf16 v[60:63], a[172:175], a[220:223], v[60:63]
    s_lshl_b32 s55, s55, 1
    ds_read_b64_tr_b16 a[156:157], v33 offset:28672
    v_add_u32 v69, s55, v69
    v_and_b32 v252, v74, v79
    v_mfma_f32_16x16x32_bf16 v[52:55], a[172:175], a[216:219], v[52:55]
    s_waitcnt lgkmcnt(7)
    ds_read_b64_tr_b16 a[158:159], v33 offset:30720
    v_and_b32 v255, v77, v79
    v_cmp_eq_u32 vcc, v65, v69
    v_mfma_f32_16x16x32_bf16 v[48:51], a[176:179], a[224:227], v[48:51]
    s_add_u32 m0, s75, 0x6000
    ds_read_b64_tr_b16 a[160:161], v32 offset:32768
    v_cndmask_b32 v78, 0, v67, vcc
    v_mfma_f32_16x16x32_bf16 v[56:59], a[176:179], a[228:231], v[56:59]
    ds_read_b64_tr_b16 a[162:163], v32 offset:34816
    v_and_b32 v74, v74, v78
    v_mfma_f32_16x16x32_bf16 v[60:63], a[180:183], a[228:231], v[60:63]
    ds_read_b64_tr_b16 a[164:165], v33 offset:32768
    v_and_b32 v76, v76, v78
    v_mfma_f32_16x16x32_bf16 v[52:55], a[180:183], a[224:227], v[52:55]
    ds_read_b64_tr_b16 a[166:167], v33 offset:34816
    buffer_load_dwordx4 v20, s[16:19], s60 offen offset:0 lds
    v_mfma_f32_16x16x32_bf16 v[48:51], a[184:187], a[232:235], v[48:51]
    ds_read_b64_tr_b16 a[168:169], v32 offset:36864
    v_and_b32 v77, v77, v78
    v_mfma_f32_16x16x32_bf16 v[56:59], a[184:187], a[236:239], v[56:59]
    ds_read_b64_tr_b16 a[170:171], v32 offset:38912
    v_and_b32 v75, v75, v78
    v_mfma_f32_16x16x32_bf16 v[60:63], a[188:191], a[236:239], v[60:63]
    s_waitcnt vmcnt(12)
    v_cmp_ne_u32 vcc, v46, v43
    ds_read_b64_tr_b16 a[172:173], v33 offset:36864
    buffer_load_dwordx4 v21, s[16:19], s60 offen offset:1024 lds
    v_mfma_f32_16x16x32_bf16 v[52:55], a[188:191], a[232:235], v[52:55]
    s_cbranch_vccnz SLOW5
BACK5:
    s_waitcnt lgkmcnt(7)
    ds_read_b64_tr_b16 a[174:175], v33 offset:38912
    v_mfma_f32_16x16x32_bf16 v[144:147], a[144:147], a[192:195], v[144:147]
    buffer_load_dwordx4 a[96:99], v2, s[24:27], 0 offen offset:0 sc1
    v_mfma_f32_16x16x32_bf16 v[152:155], a[144:147], a[196:199], v[152:155]
    ds_read_b64_tr_b16 a[176:177], v32 offset:40960
    ds_read_b64_tr_b16 a[178:179], v32 offset:43008
    v_mfma_f32_16x16x32_bf16 v[156:159], a[148:151], a[196:199], v[156:159]
    buffer_load_dwordx4 a[100:103], v2, s[24:27], 0 offen offset:2048 sc1
    v_mfma_f32_16x16x32_bf16 v[148:151], a[148:151], a[192:195], v[148:151]
    ds_read_b64_tr_b16 a[180:181], v33 offset:40960
    ds_read_b64_tr_b16 a[182:183], v33 offset:43008
    v_mfma_f32_16x16x32_bf16 v[144:147], a[152:155], a[200:203], v[144:147]
    ds_read_b64_tr_b16 a[184:185], v32 offset:45056
    v_mfma_f32_16x16x32_bf16 v[152:155], a[152:155], a[204:207], v[152:155]
    buffer_load_dwordx4 a[104:107], v3, s[24:27], 0 offen offset:0 sc1
    v_mfma_f32_16x16x32_bf16 v[156:159], a[156:159], a[204:207], v[156:159]
    ds_read_b64_tr_b16 a[186:187], v32 offset:47104
    ds_read_b64_tr_b16 a[188:189], v33 offset:45056
    v_mfma_f32_16x16x32_bf16 v[148:151], a[156:159], a[200:203], v[148:151]
    s_waitcnt lgkmcnt(7)
    ds_read_b64_tr_b16 a[190:191], v33 offset:47104
    v_mfma_f32_16x16x32_bf16 v[144:147], a[160:163], a[208:211], v[144:147]
    buffer_load_dword v46, off, s[24:27], s39 sc1
    v_mfma_f32_16x16x32_bf16 v[152:155], a[160:163], a[212:215], v[152:155]
    ds_read_b64_tr_b16 a[144:145], v34 offset:24576
    ds_read_b64_tr_b16 a[146:147], v34 offset:26624
    v_mfma_f32_16x16x32_bf16 v[156:159], a[164:167], a[212:215], v[156:159]
    ds_read_b64_tr_b16 a[148:149], v35 offset:24576
    v_mfma_f32_16x16x32_bf16 v[148:151], a[164:167], a[208:211], v[148:151]
    ds_read_b64_tr_b16 a[150:151], v35 offset:26624
    v_and_b32 v36, 0xffff0000, v36
    v_mfma_f32_16x16x32_bf16 v[144:147], a[168:171], a[216:219], v[144:147]
    ds_read_b64_tr_b16 a[152:153], v34 offset:28672
    v_sub_f32 v36, 1.0, v36
    v_mfma_f32_16x16x32_bf16 v[152:155], a[168:171], a[220:223], v[152:155]
    ds_read_b64_tr_b16 a[154:155], v34 offset:30720
    v_cvt_pk_bf16_f32 v36, v36, v36
    v_mfma_f32_16x16x32_bf16 v[156:159], a[172:175], a[220:223], v[156:159]
    ds_read_b64_tr_b16 a[156:157], v35 offset:28672
    v_mfma_f32_16x16x32_bf16 v[148:151], a[172:175], a[216:219], v[148:151]
    s_waitcnt lgkmcnt(7)
    ds_read_b64_tr_b16 a[158:159], v35 offset:30720
    v_mfma_f32_16x16x32_bf16 v[144:147], a[176:179], a[224:227], v[144:147]
    s_waitcnt vmcnt(10)
    s_barrier
    v_mfma_f32_16x16x32_bf16 v[152:155], a[176:179], a[228:231], v[152:155]
    ds_read_b64_tr_b16 a[160:161], v34 offset:32768
    ds_read_b64_tr_b16 a[162:163], v34 offset:34816
    v_mfma_f32_16x16x32_bf16 v[156:159], a[180:183], a[228:231], v[156:159]
    ds_read_b64_tr_b16 a[164:165], v35 offset:32768
    v_and_b32 v37, 0xffff0000, v37
    v_mfma_f32_16x16x32_bf16 v[148:151], a[180:183], a[224:227], v[148:151]
    s_add_u32 m0, s77, 0xc000
    ds_read_b64_tr_b16 a[166:167], v35 offset:34816
    v_lshlrev_b32 v36, 16, v36
    v_mfma_f32_16x16x32_bf16 v[144:147], a[184:187], a[232:235], v[144:147]
    ds_read_b64_tr_b16 a[168:169], v34 offset:36864
    v_sub_f32 v37, 1.0, v37
    v_mfma_f32_16x16x32_bf16 v[152:155], a[184:187], a[236:239], v[152:155]
    ds_read_b64_tr_b16 a[170:171], v34 offset:38912
    v_cvt_pk_bf16_f32 v37, v37, v37
    v_mfma_f32_16x16x32_bf16 v[156:159], a[188:191], a[236:239], v[156:159]
    ds_read_b64_tr_b16 a[172:173], v35 offset:36864
    ds_read_b64_tr_b16 a[174:175], v35 offset:38912
    v_mfma_f32_16x16x32_bf16 v[148:151], a[188:191], a[232:235], v[148:151]
    s_waitcnt lgkmcnt(8)
    ds_read_b64_tr_b16 a[176:177], v34 offset:40960
    v_mfma_f32_16x16x32_bf16 v[160:163], a[144:147], a[192:195], v[160:163]
    buffer_load_dwordx4 v24, s[16:19], s72 offen offset:0 lds
    v_mfma_f32_16x16x32_bf16 v[168:171], a[144:147], a[196:199], v[168:171]
    ds_read_b64_tr_b16 a[178:179], v34 offset:43008
    v_lshlrev_b32 v37, 16, v37
    v_mfma_f32_16x16x32_bf16 v[172:175], a[148:151], a[196:199], v[172:175]
    ds_read_b64_tr_b16 a[180:181], v35 offset:40960
    v_and_b32 v67, 0xffff0000, v67
    v_mfma_f32_16x16x32_bf16 v[164:167], a[148:151], a[192:195], v[164:167]
    ds_read_b64_tr_b16 a[182:183], v35 offset:43008
    v_sub_f32 v67, 1.0, v67
    v_mfma_f32_16x16x32_bf16 v[160:163], a[152:155], a[200:203], v[160:163]
    ds_read_b64_tr_b16 a[184:185], v34 offset:45056
    v_cvt_pk_bf16_f32 v67, v67, v67
    v_mfma_f32_16x16x32_bf16 v[168:171], a[152:155], a[204:207], v[168:171]
    ds_read_b64_tr_b16 a[186:187], v34 offset:47104
    ds_read_b64_tr_b16 a[188:189], v35 offset:45056
    v_mfma_f32_16x16x32_bf16 v[172:175], a[156:159], a[204:207], v[172:175]
    buffer_load_dwordx4 v25, s[16:19], s72 offen offset:1024 lds
    v_mfma_f32_16x16x32_bf16 v[164:167], a[156:159], a[200:203], v[164:167]
    ds_read_b64_tr_b16 a[190:191], v35 offset:47104
    s_waitcnt lgkmcnt(8)
    v_mfma_f32_16x16x32_bf16 v[160:163], a[160:163], a[208:211], v[160:163]
    s_lshl3_add_u32 s55, s52, s51
    ds_read_b64_tr_b16 a[144:145], v28 offset:0
    v_lshlrev_b32 v3, 16, v67
    v_mfma_f32_16x16x32_bf16 v[168:171], a[160:163], a[212:215], v[168:171]
    s_lshl_b32 s56, s55, 5
    ds_read_b64_tr_b16 a[146:147], v28 offset:2048
    s_add_u32 s56, s56, s50
    v_mfma_f32_16x16x32_bf16 v[172:175], a[164:167], a[212:215], v[172:175]
    s_lshl_b32 s56, s56, 11
    s_add_u32 s56, s56, 0x1400000
    ds_read_b64_tr_b16 a[148:149], v29 offset:0
    v_mfma_f32_16x16x32_bf16 v[164:167], a[164:167], a[208:211], v[164:167]
    ds_read_b64_tr_b16 a[150:151], v29 offset:2048
    v_mfma_f32_16x16x32_bf16 v[160:163], a[168:171], a[216:219], v[160:163]
    ds_read_b64_tr_b16 a[152:153], v28 offset:4096
    ds_read_b64_tr_b16 a[154:155], v28 offset:6144
    v_mfma_f32_16x16x32_bf16 v[168:171], a[168:171], a[220:223], v[168:171]
    ds_read_b64_tr_b16 a[156:157], v29 offset:4096
    s_add_u32 m0, s78, 0xc000
    v_mfma_f32_16x16x32_bf16 v[172:175], a[172:175], a[220:223], v[172:175]
    ds_read_b64_tr_b16 a[158:159], v29 offset:6144
    s_lshl_b32 s55, s55, 5
    v_mfma_f32_16x16x32_bf16 v[164:167], a[172:175], a[216:219], v[164:167]
    s_waitcnt lgkmcnt(8)
    ds_read_b64_tr_b16 a[160:161], v28 offset:8192
    v_mfma_f32_16x16x32_bf16 v[160:163], a[176:179], a[224:227], v[160:163]
    s_add_u32 s55, s55, s50
    v_lshl_add_u32 v19, v1, 4, s56
    s_lshl_b32 s55, s55, 8
    v_mfma_f32_16x16x32_bf16 v[168:171], a[176:179], a[228:231], v[168:171]
    s_add_u32 s55, s55, 0x2400000
    ds_read_b64_tr_b16 a[162:163], v28 offset:10240
    v_lshl_add_u32 v68, v64, 4, s55
    v_mfma_f32_16x16x32_bf16 v[172:175], a[180:183], a[228:231], v[172:175]
    ds_read_b64_tr_b16 a[164:165], v29 offset:8192
    ds_read_b64_tr_b16 a[166:167], v29 offset:10240
    v_mfma_f32_16x16x32_bf16 v[164:167], a[180:183], a[224:227], v[164:167]
    buffer_load_dwordx4 v24, s[16:19], s73 offen offset:0 lds
    v_mfma_f32_16x16x32_bf16 v[160:163], a[184:187], a[232:235], v[160:163]
    s_lshl2_add_u32 s55, s54, s50
    ds_read_b64_tr_b16 a[168:169], v28 offset:12288
    v_lshl_add_u32 v45, v65, 10, v68
    v_mfma_f32_16x16x32_bf16 v[168:171], a[184:187], a[236:239], v[168:171]
    s_mul_i32 s55, s55, 36864
    s_mul_i32 s56, s53, 640
    ds_read_b64_tr_b16 a[170:171], v28 offset:14336
    v_mfma_f32_16x16x32_bf16 v[172:175], a[188:191], a[236:239], v[172:175]
    ds_read_b64_tr_b16 a[172:173], v29 offset:12288
    v_mfma_f32_16x16x32_bf16 v[164:167], a[188:191], a[232:235], v[164:167]
    s_add_u32 s55, s55, s56
    s_waitcnt lgkmcnt(7)
    ds_read_b64_tr_b16 a[174:175], v29 offset:14336
    v_mfma_f32_16x16x32_bf16 v[80:83], a[144:147], a[192:195], v[80:83]
    s_lshl_b32 s56, s51, 6
    ds_read_b64_tr_b16 a[176:177], v28 offset:16384
    v_mfma_f32_16x16x32_bf16 v[88:91], a[144:147], a[196:199], v[88:91]
    ds_read_b64_tr_b16 a[178:179], v28 offset:18432
    v_and_b32 v71, 1, v65
    v_mfma_f32_16x16x32_bf16 v[92:95], a[148:151], a[196:199], v[92:95]
    ds_read_b64_tr_b16 a[180:181], v29 offset:16384
    v_mfma_f32_16x16x32_bf16 v[84:87], a[148:151], a[192:195], v[84:87]
    s_movk_i32 s57, 1152
    s_add_u32 s55, s55, s56
    ds_read_b64_tr_b16 a[182:183], v29 offset:18432
    v_mfma_f32_16x16x32_bf16 v[80:83], a[152:155], a[200:203], v[80:83]
    ds_read_b64_tr_b16 a[184:185], v28 offset:20480
    v_lshrrev_b32 v72, 5, v1
    v_mfma_f32_16x16x32_bf16 v[88:91], a[152:155], a[204:207], v[88:91]
    ds_read_b64_tr_b16 a[186:187], v28 offset:22528
    v_lshlrev_b32 v71, 5, v71
    v_mfma_f32_16x16x32_bf16 v[92:95], a[156:159], a[204:207], v[92:95]
    ds_read_b64_tr_b16 a[188:189], v29 offset:20480
    v_mfma_f32_16x16x32_bf16 v[84:87], a[156:159], a[200:203], v[84:87]
    s_waitcnt lgkmcnt(7)
    ds_read_b64_tr_b16 a[190:191], v29 offset:22528
    v_mad_u32_u24 v71, v64, s57, v71
    v_mfma_f32_16x16x32_bf16 v[80:83], a[160:163], a[208:211], v[80:83]
    ds_read_b64_tr_b16 a[144:145], v30 offset:0
    v_lshl_add_u32 v68, v72, 4, v71
    v_mfma_f32_16x16x32_bf16 v[88:91], a[160:163], a[212:215], v[88:91]
    ds_read_b64_tr_b16 a[146:147], v30 offset:2048
    v_mfma_f32_16x16x32_bf16 v[92:95], a[164:167], a[212:215], v[92:95]
    ds_read_b64_tr_b16 a[148:149], v31 offset:0
    v_add_u32 v47, s55, v68
    v_mfma_f32_16x16x32_bf16 v[84:87], a[164:167], a[208:211], v[84:87]
    s_lshl3_add_u32 s55, s54, s51
    ds_read_b64_tr_b16 a[150:151], v31 offset:2048
    v_mfma_f32_16x16x32_bf16 v[80:83], a[168:171], a[216:219], v[80:83]
    ds_read_b64_tr_b16 a[152:153], v30 offset:4096
    v_mfma_f32_16x16x32_bf16 v[88:91], a[168:171], a[220:223], v[88:91]
    s_mul_i32 s55, s55, 18432
    ds_read_b64_tr_b16 a[154:155], v30 offset:6144
    v_mfma_f32_16x16x32_bf16 v[92:95], a[172:175], a[220:223], v[92:95]
    s_lshl3_add_u32 s56, s53, s50
    s_lshl3_add_u32 s55, s56, s55
    ds_read_b64_tr_b16 a[156:157], v31 offset:4096
    v_mfma_f32_16x16x32_bf16 v[84:87], a[172:175], a[216:219], v[84:87]
    s_waitcnt lgkmcnt(7)
    ds_read_b64_tr_b16 a[158:159], v31 offset:6144
    v_lshl_add_u32 v68, v72, 30, v71
    v_mfma_f32_16x16x32_bf16 v[80:83], a[176:179], a[224:227], v[80:83]
    s_waitcnt vmcnt(7)
    s_barrier
    v_mfma_f32_16x16x32_bf16 v[88:91], a[176:179], a[228:231], v[88:91]
    s_add_u32 s55, s55, 512
    ds_read_b64_tr_b16 a[160:161], v30 offset:8192
    ds_read_b64_tr_b16 a[162:163], v30 offset:10240
    v_mfma_f32_16x16x32_bf16 v[92:95], a[180:183], a[228:231], v[92:95]
    ds_read_b64_tr_b16 a[164:165], v31 offset:8192
    v_add_u32 v2, s55, v68
    v_mfma_f32_16x16x32_bf16 v[84:87], a[180:183], a[224:227], v[84:87]
    s_add_u32 s60, s69, s0
    s_lshr_b32 s56, s51, 1
    ds_read_b64_tr_b16 a[166:167], v31 offset:10240
    v_mfma_f32_16x16x32_bf16 v[80:83], a[184:187], a[232:235], v[80:83]
    ds_read_b64_tr_b16 a[168:169], v30 offset:12288
    v_mov_b32 v68, s50
    v_mfma_f32_16x16x32_bf16 v[88:91], a[184:187], a[236:239], v[88:91]
    ds_read_b64_tr_b16 a[170:171], v30 offset:14336
    s_add_u32 m0, s74, 0x12000
    v_mfma_f32_16x16x32_bf16 v[92:95], a[188:191], a[236:239], v[92:95]
    ds_read_b64_tr_b16 a[172:173], v31 offset:12288
    v_mov_b32 v69, s56
    v_mfma_f32_16x16x32_bf16 v[84:87], a[188:191], a[232:235], v[84:87]
    s_waitcnt lgkmcnt(7)
    ds_read_b64_tr_b16 a[174:175], v31 offset:14336
    v_and_b32 v70, 7, v1
    v_mfma_f32_16x16x32_bf16 v[96:99], a[144:147], a[192:195], v[96:99]
    buffer_load_dwordx4 v20, s[16:19], s60 offen offset:0 lds
    v_mfma_f32_16x16x32_bf16 v[104:107], a[144:147], a[196:199], v[104:107]
    s_lshl_b32 s55, s52, 12
    ds_read_b64_tr_b16 a[176:177], v30 offset:16384
    v_mfma_f32_16x16x32_bf16 v[108:111], a[148:151], a[196:199], v[108:111]
    ds_read_b64_tr_b16 a[178:179], v30 offset:18432
    ds_read_b64_tr_b16 a[180:181], v31 offset:16384
    v_mfma_f32_16x16x32_bf16 v[100:103], a[148:151], a[192:195], v[100:103]
    buffer_load_dwordx4 v21, s[16:19], s60 offen offset:1024 lds
    v_mfma_f32_16x16x32_bf16 v[96:99], a[152:155], a[200:203], v[96:99]
    s_add_u32 s55, s55, 0x2d20000
    ds_read_b64_tr_b16 a[182:183], v31 offset:18432
    ds_read_b64_tr_b16 a[184:185], v30 offset:20480
    v_mfma_f32_16x16x32_bf16 v[104:107], a[152:155], a[204:207], v[104:107]
    ds_read_b64_tr_b16 a[186:187], v30 offset:22528
    v_lshl_add_u32 v70, v70, 6, s55
    v_mfma_f32_16x16x32_bf16 v[108:111], a[156:159], a[204:207], v[108:111]
    buffer_load_dwordx4 v22, s[16:19], s60 offen offset:2048 lds
    ds_read_b64_tr_b16 a[188:189], v31 offset:20480
    v_mfma_f32_16x16x32_bf16 v[100:103], a[156:159], a[200:203], v[100:103]
    s_waitcnt lgkmcnt(7)
    ds_read_b64_tr_b16 a[190:191], v31 offset:22528
    v_cmp_gt_u32 vcc, 8, v1
    v_mfma_f32_16x16x32_bf16 v[96:99], a[160:163], a[208:211], v[96:99]
    ds_read_b64_tr_b16 a[144:145], v28 offset:24576
    v_cndmask_b32 v68, v68, v69, vcc
    v_mfma_f32_16x16x32_bf16 v[104:107], a[160:163], a[212:215], v[104:107]
    ds_read_b64_tr_b16 a[146:147], v28 offset:26624
    ds_read_b64_tr_b16 a[148:149], v29 offset:24576
    v_mfma_f32_16x16x32_bf16 v[108:111], a[164:167], a[212:215], v[108:111]
    buffer_load_dwordx4 v23, s[16:19], s60 offen offset:3072 lds
    v_mfma_f32_16x16x32_bf16 v[100:103], a[164:167], a[208:211], v[100:103]
    ds_read_b64_tr_b16 a[150:151], v29 offset:26624
    v_mfma_f32_16x16x32_bf16 v[96:99], a[168:171], a[216:219], v[96:99]
    s_waitcnt vmcnt(7)
    v_cmp_ne_u32 vcc, v46, v43
    v_lshl_add_u32 v18, v68, 10, v70
    v_mfma_f32_16x16x32_bf16 v[104:107], a[168:171], a[220:223], v[104:107]
    ds_read_b64_tr_b16 a[152:153], v28 offset:28672
    ds_read_b64_tr_b16 a[154:155], v28 offset:30720
    v_mfma_f32_16x16x32_bf16 v[108:111], a[172:175], a[220:223], v[108:111]
    s_cbranch_vccnz SLOW4
BACK4:
    ds_read_b64_tr_b16 a[156:157], v29 offset:28672
    buffer_load_dwordx4 a[240:243], v41, s[24:27], s82 offen offset:0 sc1
    v_mfma_f32_16x16x32_bf16 v[100:103], a[172:175], a[216:219], v[100:103]
    s_waitcnt lgkmcnt(7)
    ds_read_b64_tr_b16 a[158:159], v29 offset:30720
    s_add_u32 s60, s70, s0
    v_mfma_f32_16x16x32_bf16 v[96:99], a[176:179], a[224:227], v[96:99]
    s_add_u32 m0, s75, 0x12000
    s_lshl_b32 s44, s0, 7
    ds_read_b64_tr_b16 a[160:161], v28 offset:32768
    v_mfma_f32_16x16x32_bf16 v[104:107], a[176:179], a[228:231], v[104:107]
    buffer_load_dwordx4 a[244:247], v41, s[24:27], s82 offen offset:1024 sc1
    ds_read_b64_tr_b16 a[162:163], v28 offset:34816
    v_mfma_f32_16x16x32_bf16 v[108:111], a[180:183], a[228:231], v[108:111]
    s_add_u32 s45, s44, 8192
    ds_read_b64_tr_b16 a[164:165], v29 offset:32768
    ds_read_b64_tr_b16 a[166:167], v29 offset:34816
    v_mfma_f32_16x16x32_bf16 v[100:103], a[180:183], a[224:227], v[100:103]
    buffer_load_dwordx4 v20, s[16:19], s60 offen offset:0 lds
    v_mfma_f32_16x16x32_bf16 v[96:99], a[184:187], a[232:235], v[96:99]
    s_xor_b32 s46, s51, 1
    s_lshl_b32 s46, s46, 13
    ds_read_b64_tr_b16 a[168:169], v28 offset:36864
    v_mfma_f32_16x16x32_bf16 v[104:107], a[184:187], a[236:239], v[104:107]
    buffer_load_dwordx4 a[248:251], v41, s[24:27], s82 offen offset:2048 sc1
    v_mfma_f32_16x16x32_bf16 v[108:111], a[188:191], a[236:239], v[108:111]
    buffer_load_dwordx4 v21, s[16:19], s60 offen offset:1024 lds
    v_mfma_f32_16x16x32_bf16 v[100:103], a[188:191], a[232:235], v[100:103]
    s_waitcnt lgkmcnt(5)
    ds_read_b64_tr_b16 a[170:171], v28 offset:38912
    ds_read_b64_tr_b16 a[172:173], v29 offset:36864
    v_mfma_f32_16x16x32_bf16 v[112:115], a[144:147], a[192:195], v[112:115]
    ds_read_b64_tr_b16 a[174:175], v29 offset:38912
    v_mfma_f32_16x16x32_bf16 v[120:123], a[144:147], a[196:199], v[120:123]
    buffer_load_dwordx4 a[252:255], v41, s[24:27], s82 offen offset:3072 sc1
    v_mfma_f32_16x16x32_bf16 v[124:127], a[148:151], a[196:199], v[124:127]
    ds_read_b64_tr_b16 a[176:177], v28 offset:40960
    v_mfma_f32_16x16x32_bf16 v[116:119], a[148:151], a[192:195], v[116:119]
    ds_read_b64_tr_b16 a[178:179], v28 offset:43008
    ds_read_b64_tr_b16 a[180:181], v29 offset:40960
    v_mfma_f32_16x16x32_bf16 v[112:115], a[152:155], a[200:203], v[112:115]
    buffer_load_dwordx4 a[0:3], v41, s[24:27], s83 offen offset:0 sc1
    v_mfma_f32_16x16x32_bf16 v[14:17], a[104:107], v[74:77], 0
    ds_read_b64_tr_b16 a[182:183], v29 offset:43008
    ds_read_b64_tr_b16 a[184:185], v28 offset:45056
    v_mfma_f32_16x16x32_bf16 v[120:123], a[152:155], a[204:207], v[120:123]
    ds_read_b64_tr_b16 a[186:187], v28 offset:47104
    v_mfma_f32_16x16x32_bf16 v[124:127], a[156:159], a[204:207], v[124:127]
    ds_read_b64_tr_b16 a[188:189], v29 offset:45056
    v_mfma_f32_16x16x32_bf16 v[116:119], a[156:159], a[200:203], v[116:119]
    s_waitcnt lgkmcnt(7)
    ds_read_b64_tr_b16 a[190:191], v29 offset:47104
    v_mfma_f32_16x16x32_bf16 v[112:115], a[160:163], a[208:211], v[112:115]
    buffer_load_dwordx4 a[4:7], v41, s[24:27], s83 offen offset:1024 sc1
    v_mfma_f32_16x16x32_bf16 v[64:67], a[96:99], v[248:251], 0
    ds_read_b64_tr_b16 a[144:145], v30 offset:24576
    v_mfma_f32_16x16x32_bf16 v[120:123], a[160:163], a[212:215], v[120:123]
    ds_read_b64_tr_b16 a[146:147], v30 offset:26624
    v_mfma_f32_16x16x32_bf16 v[124:127], a[164:167], a[212:215], v[124:127]
    v_mfma_f32_16x16x32_bf16 v[116:119], a[164:167], a[208:211], v[116:119]
    ds_read_b64_tr_b16 a[148:149], v31 offset:24576
    v_mfma_f32_16x16x32_bf16 v[112:115], a[168:171], a[216:219], v[112:115]
    ds_read_b64_tr_b16 a[150:151], v31 offset:26624
    v_mfma_f32_16x16x32_bf16 v[68:71], a[100:103], v[248:251], 0
    ds_read_b64_tr_b16 a[152:153], v30 offset:28672
    v_mfma_f32_16x16x32_bf16 v[120:123], a[168:171], a[220:223], v[120:123]
    ds_read_b64_tr_b16 a[154:155], v30 offset:30720
    v_mfma_f32_16x16x32_bf16 v[124:127], a[172:175], a[220:223], v[124:127]
    ds_read_b64_tr_b16 a[156:157], v31 offset:28672
    v_mfma_f32_16x16x32_bf16 v[116:119], a[172:175], a[216:219], v[116:119]
    ds_read_b64_tr_b16 a[158:159], v31 offset:30720
    s_waitcnt lgkmcnt(8)
    v_mfma_f32_16x16x32_bf16 v[112:115], a[176:179], a[224:227], v[112:115]
    s_waitcnt vmcnt(12)
    s_barrier
    v_mfma_f32_16x16x32_bf16 v[72:75], a[96:99], v[252:255], 0
    ds_read_b64_tr_b16 a[160:161], v30 offset:32768
    v_mfma_f32_16x16x32_bf16 v[120:123], a[176:179], a[228:231], v[120:123]
    ds_read_b64_tr_b16 a[162:163], v30 offset:34816
    v_mfma_f32_16x16x32_bf16 v[124:127], a[180:183], a[228:231], v[124:127]
    ds_read_b64_tr_b16 a[164:165], v31 offset:32768
    v_mfma_f32_16x16x32_bf16 v[116:119], a[180:183], a[224:227], v[116:119]
    ds_read_b64_tr_b16 a[166:167], v31 offset:34816
    v_mfma_f32_16x16x32_bf16 v[112:115], a[184:187], a[232:235], v[112:115]
    v_mfma_f32_16x16x32_bf16 v[76:79], a[100:103], v[252:255], 0
    ds_read_b64_tr_b16 a[168:169], v30 offset:36864
    v_mfma_f32_16x16x32_bf16 v[120:123], a[184:187], a[236:239], v[120:123]
    ds_read_b64_tr_b16 a[170:171], v30 offset:38912
    v_mfma_f32_16x16x32_bf16 v[124:127], a[188:191], a[236:239], v[124:127]
    s_add_u32 s60, s69, s1
    s_add_u32 m0, s74, 0x0
    ds_read_b64_tr_b16 a[172:173], v31 offset:36864
    v_mfma_f32_16x16x32_bf16 v[116:119], a[188:191], a[232:235], v[116:119]
    s_waitcnt lgkmcnt(7)
    ds_read_b64_tr_b16 a[174:175], v31 offset:38912
    ds_read_b64_tr_b16 a[176:177], v30 offset:40960
    v_mfma_f32_16x16x32_bf16 v[128:131], a[144:147], a[192:195], v[128:131]
    buffer_load_dwordx4 v20, s[16:19], s60 offen offset:0 lds
    v_mfma_f32_16x16x32_bf16 v[136:139], a[144:147], a[196:199], v[136:139]
    ds_read_b64_tr_b16 a[178:179], v30 offset:43008
    v_mfma_f32_16x16x32_bf16 v[140:143], a[148:151], a[196:199], v[140:143]
    ds_read_b64_tr_b16 a[180:181], v31 offset:40960
    v_mfma_f32_16x16x32_bf16 v[132:135], a[148:151], a[192:195], v[132:135]
    buffer_load_dwordx4 v21, s[16:19], s60 offen offset:1024 lds
    v_mfma_f32_16x16x32_bf16 v[128:131], a[152:155], a[200:203], v[128:131]
    ds_read_b64_tr_b16 a[182:183], v31 offset:43008
    v_mfma_f32_16x16x32_bf16 v[136:139], a[152:155], a[204:207], v[136:139]
    ds_read_b64_tr_b16 a[184:185], v30 offset:45056
    ds_read_b64_tr_b16 a[186:187], v30 offset:47104
    v_mfma_f32_16x16x32_bf16 v[140:143], a[156:159], a[204:207], v[140:143]
    buffer_load_dwordx4 v22, s[16:19], s60 offen offset:2048 lds
    v_mfma_f32_16x16x32_bf16 v[132:135], a[156:159], a[200:203], v[132:135]
    s_waitcnt lgkmcnt(6)
    ds_read_b64_tr_b16 a[188:189], v31 offset:45056
    ds_read_b64_tr_b16 a[190:191], v31 offset:47104
    v_mfma_f32_16x16x32_bf16 v[128:131], a[160:163], a[208:211], v[128:131]
    ds_read_b64_tr_b16 a[144:145], v38 offset:0
    v_mfma_f32_16x16x32_bf16 v[136:139], a[160:163], a[212:215], v[136:139]
    ds_read_b64_tr_b16 a[146:147], v38 offset:1024
    v_mfma_f32_16x16x32_bf16 v[140:143], a[164:167], a[212:215], v[140:143]
    buffer_load_dwordx4 v23, s[16:19], s60 offen offset:3072 lds
    v_mfma_f32_16x16x32_bf16 v[132:135], a[164:167], a[208:211], v[132:135]
    ds_read_b64_tr_b16 a[148:149], v39 offset:0
    v_mfma_f32_16x16x32_bf16 v[128:131], a[168:171], a[216:219], v[128:131]
    ds_read_b64_tr_b16 a[150:151], v39 offset:1024
    v_mfma_f32_16x16x32_bf16 v[136:139], a[168:171], a[220:223], v[136:139]
    ds_read_b64_tr_b16 a[152:153], v38 offset:2048
    v_mfma_f32_16x16x32_bf16 v[140:143], a[172:175], a[220:223], v[140:143]
    ds_read_b64_tr_b16 a[154:155], v38 offset:3072
    v_mfma_f32_16x16x32_bf16 v[132:135], a[172:175], a[216:219], v[132:135]
    s_waitcnt lgkmcnt(6)
    ds_read_b64_tr_b16 a[156:157], v39 offset:2048
    s_add_u32 s60, s70, s1
    v_mfma_f32_16x16x32_bf16 v[128:131], a[176:179], a[224:227], v[128:131]
    ds_read_b64_tr_b16 a[158:159], v39 offset:3072
    s_add_u32 m0, s75, 0x0
    v_mfma_f32_16x16x32_bf16 v[136:139], a[176:179], a[228:231], v[136:139]
    ds_read_b64_tr_b16 a[160:161], v38 offset:4096
    ds_read_b64_tr_b16 a[162:163], v38 offset:5120
    v_mfma_f32_16x16x32_bf16 v[140:143], a[180:183], a[228:231], v[140:143]
    ds_read_b64_tr_b16 a[164:165], v39 offset:4096
    v_mfma_f32_16x16x32_bf16 v[132:135], a[180:183], a[224:227], v[132:135]
    buffer_load_dwordx4 v20, s[16:19], s60 offen offset:0 lds
    v_mfma_f32_16x16x32_bf16 v[128:131], a[184:187], a[232:235], v[128:131]
    ds_read_b64_tr_b16 a[166:167], v39 offset:5120
    ds_read_b64_tr_b16 a[168:169], v38 offset:6144
    v_mfma_f32_16x16x32_bf16 v[136:139], a[184:187], a[236:239], v[136:139]
    ds_read_b64_tr_b16 a[170:171], v38 offset:7168
    ds_read_b64_tr_b16 a[172:173], v39 offset:6144
    v_mfma_f32_16x16x32_bf16 v[140:143], a[188:191], a[236:239], v[140:143]
    buffer_load_dwordx4 v21, s[16:19], s60 offen offset:1024 lds
    v_mfma_f32_16x16x32_bf16 v[132:135], a[188:191], a[232:235], v[132:135]
    s_waitcnt lgkmcnt(7)
    ds_read_b64_tr_b16 a[174:175], v39 offset:7168
    v_mfma_f32_16x16x32_bf16 v[48:51], a[144:147], v[224:227], v[48:51]
    ds_read_b64_tr_b16 a[176:177], v38 offset:8192
    v_mfma_f32_16x16x32_bf16 v[56:59], a[144:147], v[228:231], v[56:59]
    ds_read_b64_tr_b16 a[178:179], v38 offset:9216
    v_mfma_f32_16x16x32_bf16 v[60:63], a[148:151], v[228:231], v[60:63]
    ds_read_b64_tr_b16 a[180:181], v39 offset:8192
    v_mfma_f32_16x16x32_bf16 v[52:55], a[148:151], v[224:227], v[52:55]
    ds_read_b64_tr_b16 a[182:183], v39 offset:9216
    ds_read_b64_tr_b16 a[184:185], v38 offset:10240
    v_mfma_f32_16x16x32_bf16 v[48:51], a[152:155], v[232:235], v[48:51]
    s_waitcnt vmcnt(9)
    s_barrier
    v_mfma_f32_16x16x32_bf16 v[56:59], a[152:155], v[236:239], v[56:59]
    ds_read_b64_tr_b16 a[186:187], v38 offset:11264
    v_mfma_f32_16x16x32_bf16 v[60:63], a[156:159], v[236:239], v[60:63]
    ds_read_b64_tr_b16 a[188:189], v39 offset:10240
    v_mfma_f32_16x16x32_bf16 v[52:55], a[156:159], v[232:235], v[52:55]
    s_waitcnt lgkmcnt(7)
    s_waitcnt vmcnt(6)
    ds_read_b64_tr_b16 a[190:191], v39 offset:11264
    v_mfma_f32_16x16x32_bf16 v[48:51], a[160:163], a[240:243], v[48:51]
    s_add_u32 s60, s69, s3
    s_add_u32 m0, s74, 0x6000
    ds_read_b64_tr_b16 a[144:145], v32 offset:24576
    v_mfma_f32_16x16x32_bf16 v[56:59], a[160:163], a[244:247], v[56:59]
    ds_read_b64_tr_b16 a[146:147], v32 offset:26624
    v_mfma_f32_16x16x32_bf16 v[60:63], a[164:167], a[244:247], v[60:63]
    ds_read_b64_tr_b16 a[148:149], v33 offset:24576
    ds_read_b64_tr_b16 a[150:151], v33 offset:26624
    v_mfma_f32_16x16x32_bf16 v[52:55], a[164:167], a[240:243], v[52:55]
    ds_read_b64_tr_b16 a[152:153], v32 offset:28672
    ds_read_b64_tr_b16 a[154:155], v32 offset:30720
    v_mfma_f32_16x16x32_bf16 v[48:51], a[168:171], a[248:251], v[48:51]
    buffer_load_dwordx4 v20, s[16:19], s60 offen offset:0 lds
    v_mfma_f32_16x16x32_bf16 v[56:59], a[168:171], a[252:255], v[56:59]
    ds_read_b64_tr_b16 a[156:157], v33 offset:28672
    v_mfma_f32_16x16x32_bf16 v[60:63], a[172:175], a[252:255], v[60:63]
    ds_read_b64_tr_b16 a[158:159], v33 offset:30720
    v_mfma_f32_16x16x32_bf16 v[52:55], a[172:175], a[248:251], v[52:55]
    s_waitcnt lgkmcnt(8)
    buffer_load_dwordx4 v21, s[16:19], s60 offen offset:1024 lds
    v_mfma_f32_16x16x32_bf16 v[48:51], a[176:179], v[240:243], v[48:51]
    ds_read_b64_tr_b16 a[160:161], v32 offset:32768
    ds_read_b64_tr_b16 a[162:163], v32 offset:34816
    v_mfma_f32_16x16x32_bf16 v[56:59], a[176:179], v[244:247], v[56:59]
    ds_read_b64_tr_b16 a[164:165], v33 offset:32768
    v_mfma_f32_16x16x32_bf16 v[60:63], a[180:183], v[244:247], v[60:63]
    buffer_load_dwordx4 v22, s[16:19], s60 offen offset:2048 lds
    v_mfma_f32_16x16x32_bf16 v[52:55], a[180:183], v[240:243], v[52:55]
    ds_read_b64_tr_b16 a[166:167], v33 offset:34816
    ds_read_b64_tr_b16 a[168:169], v32 offset:36864
    v_mfma_f32_16x16x32_bf16 v[48:51], a[184:187], a[0:3], v[48:51]
    ds_read_b64_tr_b16 a[170:171], v32 offset:38912
    v_mfma_f32_16x16x32_bf16 v[56:59], a[184:187], a[4:7], v[56:59]
    ds_read_b64_tr_b16 a[172:173], v33 offset:36864
    v_mfma_f32_16x16x32_bf16 v[60:63], a[188:191], a[4:7], v[60:63]
    buffer_load_dwordx4 v23, s[16:19], s60 offen offset:3072 lds
    v_mfma_f32_16x16x32_bf16 v[52:55], a[188:191], a[0:3], v[52:55]
    s_waitcnt lgkmcnt(7)
    ds_read_b64_tr_b16 a[174:175], v33 offset:38912
    v_mfma_f32_16x16x32_bf16 v[144:147], a[144:147], v[224:227], v[144:147]
    ds_read_b64_tr_b16 a[176:177], v32 offset:40960
    s_add_u32 s60, s70, s3
    v_mfma_f32_16x16x32_bf16 v[152:155], a[144:147], v[228:231], v[152:155]
    s_add_u32 m0, s75, 0x6000
    ds_read_b64_tr_b16 a[178:179], v32 offset:43008
    v_mfma_f32_16x16x32_bf16 v[156:159], a[148:151], v[228:231], v[156:159]
    ds_read_b64_tr_b16 a[180:181], v33 offset:40960
    v_cvt_pk_bf16_f32 v48, v48, v49
    v_mfma_f32_16x16x32_bf16 v[148:151], a[148:151], v[224:227], v[148:151]
    ds_read_b64_tr_b16 a[182:183], v33 offset:43008
    v_cvt_pk_bf16_f32 v49, v50, v51
    v_mfma_f32_16x16x32_bf16 v[144:147], a[152:155], v[232:235], v[144:147]
    ds_read_b64_tr_b16 a[184:185], v32 offset:45056
    v_mfma_f32_16x16x32_bf16 v[152:155], a[152:155], v[236:239], v[152:155]
    ds_read_b64_tr_b16 a[186:187], v32 offset:47104
    v_mfma_f32_16x16x32_bf16 v[156:159], a[156:159], v[236:239], v[156:159]
    ds_read_b64_tr_b16 a[188:189], v33 offset:45056
    v_mfma_f32_16x16x32_bf16 v[148:151], a[156:159], v[232:235], v[148:151]
    s_waitcnt lgkmcnt(7)
    buffer_load_dwordx4 v20, s[16:19], s60 offen offset:0 lds
    ds_read_b64_tr_b16 a[190:191], v33 offset:47104
    v_mfma_f32_16x16x32_bf16 v[144:147], a[160:163], a[240:243], v[144:147]
    ds_read_b64_tr_b16 a[144:145], v34 offset:24576
    v_cvt_pk_bf16_f32 v51, v54, v55
    v_mfma_f32_16x16x32_bf16 v[152:155], a[160:163], a[244:247], v[152:155]
    ds_read_b64_tr_b16 a[146:147], v34 offset:26624
    v_cvt_pk_bf16_f32 v50, v52, v53
    v_mfma_f32_16x16x32_bf16 v[156:159], a[164:167], a[244:247], v[156:159]
    buffer_store_dwordx4 v[48:51], v44, s[24:27], s100 offen offset:0 sc1
    buffer_load_dwordx4 v21, s[16:19], s60 offen offset:1024 lds
    ds_read_b64_tr_b16 a[148:149], v35 offset:24576
    v_mfma_f32_16x16x32_bf16 v[148:151], a[164:167], a[240:243], v[148:151]
    ds_read_b64_tr_b16 a[150:151], v35 offset:26624
    v_mfma_f32_16x16x32_bf16 v[144:147], a[168:171], a[248:251], v[144:147]
    ds_read_b64_tr_b16 a[152:153], v34 offset:28672
    v_cvt_pk_bf16_f32 v56, v56, v57
    v_mfma_f32_16x16x32_bf16 v[152:155], a[168:171], a[252:255], v[152:155]
    ds_read_b64_tr_b16 a[154:155], v34 offset:30720
    v_cvt_pk_bf16_f32 v57, v58, v59
    v_mfma_f32_16x16x32_bf16 v[156:159], a[172:175], a[252:255], v[156:159]
    ds_read_b64_tr_b16 a[156:157], v35 offset:28672
    v_mfma_f32_16x16x32_bf16 v[148:151], a[172:175], a[248:251], v[148:151]
    s_add_u32 s100, s100, 8192
    ds_read_b64_tr_b16 a[158:159], v35 offset:30720
    s_waitcnt lgkmcnt(8)
    v_mfma_f32_16x16x32_bf16 v[144:147], a[176:179], v[240:243], v[144:147]
    s_waitcnt vmcnt(7)
    ds_read_b64_tr_b16 a[160:161], v34 offset:32768
    s_barrier
    v_mfma_f32_16x16x32_bf16 v[152:155], a[176:179], v[244:247], v[152:155]
    ds_read_b64_tr_b16 a[162:163], v34 offset:34816
    s_add_u32 s60, s64, s41
    v_mfma_f32_16x16x32_bf16 v[156:159], a[180:183], v[244:247], v[156:159]
    ds_read_b64_tr_b16 a[164:165], v35 offset:32768
    v_cvt_pk_bf16_f32 v58, v60, v61
    v_mfma_f32_16x16x32_bf16 v[148:151], a[180:183], v[240:243], v[148:151]
    s_add_u32 m0, s74, 0xc000
    ds_read_b64_tr_b16 a[166:167], v35 offset:34816
    v_cvt_pk_bf16_f32 v59, v62, v63
    v_mfma_f32_16x16x32_bf16 v[144:147], a[184:187], a[0:3], v[144:147]
    ds_read_b64_tr_b16 a[168:169], v34 offset:36864
    v_mfma_f32_16x16x32_bf16 v[152:155], a[184:187], a[4:7], v[152:155]
    buffer_store_dwordx4 v[56:59], v44, s[24:27], s100 offen offset:0 sc1
    buffer_load_dwordx4 v20, s[16:19], s60 offen offset:0 lds
    ds_read_b64_tr_b16 a[170:171], v34 offset:38912
    v_mfma_f32_16x16x32_bf16 v[156:159], a[188:191], a[4:7], v[156:159]
    buffer_load_dwordx4 v21, s[16:19], s60 offen offset:1024 lds
    v_mfma_f32_16x16x32_bf16 v[148:151], a[188:191], a[0:3], v[148:151]
    s_waitcnt lgkmcnt(6)
    ds_read_b64_tr_b16 a[172:173], v35 offset:36864
    ds_read_b64_tr_b16 a[174:175], v35 offset:38912
    v_mfma_f32_16x16x32_bf16 v[160:163], a[144:147], v[224:227], v[160:163]
    buffer_load_dwordx4 v22, s[16:19], s60 offen offset:2048 lds
    v_mfma_f32_16x16x32_bf16 v[168:171], a[144:147], v[228:231], v[168:171]
    ds_read_b64_tr_b16 a[176:177], v34 offset:40960
    ds_read_b64_tr_b16 a[178:179], v34 offset:43008
    v_mfma_f32_16x16x32_bf16 v[172:175], a[148:151], v[228:231], v[172:175]
    buffer_load_dwordx4 v23, s[16:19], s60 offen offset:3072 lds
    v_mfma_f32_16x16x32_bf16 v[164:167], a[148:151], v[224:227], v[164:167]
    ds_read_b64_tr_b16 a[180:181], v35 offset:40960
    ds_read_b64_tr_b16 a[182:183], v35 offset:43008
    v_mfma_f32_16x16x32_bf16 v[160:163], a[152:155], v[232:235], v[160:163]
    s_add_u32 s60, s65, s41
    ds_read_b64_tr_b16 a[184:185], v34 offset:45056
    ds_read_b64_tr_b16 a[186:187], v34 offset:47104
    v_mfma_f32_16x16x32_bf16 v[168:171], a[152:155], v[236:239], v[168:171]
    s_add_u32 m0, s75, 0xc000
    ds_read_b64_tr_b16 a[188:189], v35 offset:45056
    v_mfma_f32_16x16x32_bf16 v[172:175], a[156:159], v[236:239], v[172:175]
    buffer_load_dwordx4 v20, s[16:19], s60 offen offset:0 lds
    v_mfma_f32_16x16x32_bf16 v[164:167], a[156:159], v[232:235], v[164:167]
    s_waitcnt lgkmcnt(7)
    ds_read_b64_tr_b16 a[190:191], v35 offset:47104
    v_mfma_f32_16x16x32_bf16 v[160:163], a[160:163], a[240:243], v[160:163]
    buffer_load_dwordx4 v21, s[16:19], s60 offen offset:1024 lds
    v_mfma_f32_16x16x32_bf16 v[168:171], a[160:163], a[244:247], v[168:171]
    ds_read_b64_tr_b16 a[144:145], v28 offset:0
    ds_read_b64_tr_b16 a[146:147], v28 offset:2048
    v_mfma_f32_16x16x32_bf16 v[172:175], a[164:167], a[244:247], v[172:175]
    ds_read_b64_tr_b16 a[148:149], v29 offset:0
    v_mfma_f32_16x16x32_bf16 v[164:167], a[164:167], a[240:243], v[164:167]
    ds_read_b64_tr_b16 a[150:151], v29 offset:2048
    v_cvt_pk_bf16_f32 v144, v144, v145
    v_mfma_f32_16x16x32_bf16 v[160:163], a[168:171], a[248:251], v[160:163]
    ds_read_b64_tr_b16 a[152:153], v28 offset:4096
    s_lshl_b32 s62, s0, 10
    v_mfma_f32_16x16x32_bf16 v[168:171], a[168:171], a[252:255], v[168:171]
    ds_read_b64_tr_b16 a[154:155], v28 offset:6144
    v_mfma_f32_16x16x32_bf16 v[172:175], a[172:175], a[252:255], v[172:175]
    s_add_u32 s62, s62, s101
    v_cvt_pk_bf16_f32 v145, v146, v147
    v_cvt_pk_bf16_f32 v146, v148, v149
    v_mfma_f32_16x16x32_bf16 v[164:167], a[172:175], a[248:251], v[164:167]
    s_waitcnt lgkmcnt(6)
    ds_read_b64_tr_b16 a[156:157], v29 offset:4096
    v_cvt_pk_bf16_f32 v147, v150, v151
    v_mfma_f32_16x16x32_bf16 v[160:163], a[176:179], v[240:243], v[160:163]
    buffer_store_dwordx4 v[144:147], v44, s[24:27], s62 offen offset:0 sc1
    ds_read_b64_tr_b16 a[158:159], v29 offset:6144
    ds_read_b64_tr_b16 a[160:161], v28 offset:8192
    v_mfma_f32_16x16x32_bf16 v[168:171], a[176:179], v[244:247], v[168:171]
    ds_read_b64_tr_b16 a[162:163], v28 offset:10240
    v_mfma_f32_16x16x32_bf16 v[172:175], a[180:183], v[244:247], v[172:175]
    ds_read_b64_tr_b16 a[164:165], v29 offset:8192
    v_cvt_pk_bf16_f32 v152, v152, v153
    v_mfma_f32_16x16x32_bf16 v[164:167], a[180:183], v[240:243], v[164:167]
    ds_read_b64_tr_b16 a[166:167], v29 offset:10240
    v_cvt_pk_bf16_f32 v153, v154, v155
    v_mfma_f32_16x16x32_bf16 v[160:163], a[184:187], a[0:3], v[160:163]
    ds_read_b64_tr_b16 a[168:169], v28 offset:12288
    v_cvt_pk_bf16_f32 v154, v156, v157
    v_mfma_f32_16x16x32_bf16 v[168:171], a[184:187], a[4:7], v[168:171]
    v_cvt_pk_bf16_f32 v155, v158, v159
    v_mfma_f32_16x16x32_bf16 v[172:175], a[188:191], a[4:7], v[172:175]
    buffer_store_dwordx4 v[152:155], v44, s[24:27], s62 offen offset:1024 sc1
    ds_read_b64_tr_b16 a[170:171], v28 offset:14336
    ds_read_b64_tr_b16 a[172:173], v29 offset:12288
    v_mfma_f32_16x16x32_bf16 v[164:167], a[188:191], a[0:3], v[164:167]
    s_waitcnt lgkmcnt(7)
    ds_read_b64_tr_b16 a[174:175], v29 offset:14336
    v_mfma_f32_16x16x32_bf16 v[80:83], a[144:147], v[224:227], v[80:83]
    ds_read_b64_tr_b16 a[176:177], v28 offset:16384
    v_mfma_f32_16x16x32_bf16 v[88:91], a[144:147], v[228:231], v[88:91]
    ds_read_b64_tr_b16 a[178:179], v28 offset:18432
    v_mfma_f32_16x16x32_bf16 v[92:95], a[148:151], v[228:231], v[92:95]
    ds_read_b64_tr_b16 a[180:181], v29 offset:16384
    v_cvt_pk_bf16_f32 v160, v160, v161
    v_mfma_f32_16x16x32_bf16 v[84:87], a[148:151], v[224:227], v[84:87]
    ds_read_b64_tr_b16 a[182:183], v29 offset:18432
    v_cvt_pk_bf16_f32 v161, v162, v163
    v_mfma_f32_16x16x32_bf16 v[80:83], a[152:155], v[232:235], v[80:83]
    s_xor_b32 s62, s62, 0x10000
    ds_read_b64_tr_b16 a[184:185], v28 offset:20480
    v_mfma_f32_16x16x32_bf16 v[88:91], a[152:155], v[236:239], v[88:91]
    ds_read_b64_tr_b16 a[186:187], v28 offset:22528
    v_mfma_f32_16x16x32_bf16 v[92:95], a[156:159], v[236:239], v[92:95]
    ds_read_b64_tr_b16 a[188:189], v29 offset:20480
    v_mfma_f32_16x16x32_bf16 v[84:87], a[156:159], v[232:235], v[84:87]
    s_waitcnt lgkmcnt(7)
    v_cvt_pk_bf16_f32 v162, v164, v165
    v_cvt_pk_bf16_f32 v163, v166, v167
    v_mfma_f32_16x16x32_bf16 v[80:83], a[160:163], a[240:243], v[80:83]
    ds_read_b64_tr_b16 a[190:191], v29 offset:22528
    v_mfma_f32_16x16x32_bf16 v[88:91], a[160:163], a[244:247], v[88:91]
    buffer_store_dwordx4 v[160:163], v44, s[24:27], s62 offen offset:0 sc1
    ds_read_b64_tr_b16 a[144:145], v30 offset:0
    ds_read_b64_tr_b16 a[146:147], v30 offset:2048
    v_mfma_f32_16x16x32_bf16 v[92:95], a[164:167], a[244:247], v[92:95]
    ds_read_b64_tr_b16 a[148:149], v31 offset:0
    v_mfma_f32_16x16x32_bf16 v[84:87], a[164:167], a[240:243], v[84:87]
    ds_read_b64_tr_b16 a[150:151], v31 offset:2048
    v_cvt_pk_bf16_f32 v168, v168, v169
    v_mfma_f32_16x16x32_bf16 v[80:83], a[168:171], a[248:251], v[80:83]
    ds_read_b64_tr_b16 a[152:153], v30 offset:4096
    v_cvt_pk_bf16_f32 v169, v170, v171
    v_mfma_f32_16x16x32_bf16 v[88:91], a[168:171], a[252:255], v[88:91]
    ds_read_b64_tr_b16 a[154:155], v30 offset:6144
    v_cvt_pk_bf16_f32 v170, v172, v173
    v_mfma_f32_16x16x32_bf16 v[92:95], a[172:175], a[252:255], v[92:95]
    ds_read_b64_tr_b16 a[156:157], v31 offset:4096
    v_mfma_f32_16x16x32_bf16 v[84:87], a[172:175], a[248:251], v[84:87]
    s_waitcnt lgkmcnt(7)
    ds_read_b64_tr_b16 a[158:159], v31 offset:6144
    v_cvt_pk_bf16_f32 v171, v174, v175
    v_mfma_f32_16x16x32_bf16 v[80:83], a[176:179], v[240:243], v[80:83]
    s_waitcnt vmcnt(10)
    s_barrier
    v_mfma_f32_16x16x32_bf16 v[88:91], a[176:179], v[244:247], v[88:91]
    buffer_store_dwordx4 v[168:171], v44, s[24:27], s62 offen offset:1024 sc1
    ds_read_b64_tr_b16 a[160:161], v30 offset:8192
    s_add_u32 s60, s66, s41
    ds_read_b64_tr_b16 a[162:163], v30 offset:10240
    v_mfma_f32_16x16x32_bf16 v[92:95], a[180:183], v[244:247], v[92:95]
    ds_read_b64_tr_b16 a[164:165], v31 offset:8192
    ds_read_b64_tr_b16 a[166:167], v31 offset:10240
    v_mfma_f32_16x16x32_bf16 v[84:87], a[180:183], v[240:243], v[84:87]
    s_add_u32 m0, s74, 0x12000
    ds_read_b64_tr_b16 a[168:169], v30 offset:12288
    v_mfma_f32_16x16x32_bf16 v[80:83], a[184:187], a[0:3], v[80:83]
    ds_read_b64_tr_b16 a[170:171], v30 offset:14336
    ds_read_b64_tr_b16 a[172:173], v31 offset:12288
    v_mfma_f32_16x16x32_bf16 v[88:91], a[184:187], a[4:7], v[88:91]
    buffer_load_dwordx4 v20, s[16:19], s60 offen offset:0 lds
    v_mfma_f32_16x16x32_bf16 v[92:95], a[188:191], a[4:7], v[92:95]
    buffer_load_dwordx4 v21, s[16:19], s60 offen offset:1024 lds
    v_mfma_f32_16x16x32_bf16 v[84:87], a[188:191], a[0:3], v[84:87]
    ds_read_b64_tr_b16 a[174:175], v31 offset:14336
    s_waitcnt lgkmcnt(8)
    v_mfma_f32_16x16x32_bf16 v[96:99], a[144:147], v[224:227], v[96:99]
    buffer_load_dwordx4 v22, s[16:19], s60 offen offset:2048 lds
    v_mfma_f32_16x16x32_bf16 v[104:107], a[144:147], v[228:231], v[104:107]
    ds_read_b64_tr_b16 a[176:177], v30 offset:16384
    ds_read_b64_tr_b16 a[178:179], v30 offset:18432
    v_mfma_f32_16x16x32_bf16 v[108:111], a[148:151], v[228:231], v[108:111]
    buffer_load_dwordx4 v23, s[16:19], s60 offen offset:3072 lds
    v_mfma_f32_16x16x32_bf16 v[100:103], a[148:151], v[224:227], v[100:103]
    s_add_u32 s60, s67, s41
    ds_read_b64_tr_b16 a[180:181], v31 offset:16384
    ds_read_b64_tr_b16 a[182:183], v31 offset:18432
    v_mfma_f32_16x16x32_bf16 v[96:99], a[152:155], v[232:235], v[96:99]
    ds_read_b64_tr_b16 a[184:185], v30 offset:20480
    s_add_u32 m0, s75, 0x12000
    v_mfma_f32_16x16x32_bf16 v[104:107], a[152:155], v[236:239], v[104:107]
    ds_read_b64_tr_b16 a[186:187], v30 offset:22528
    ds_read_b64_tr_b16 a[188:189], v31 offset:20480
    v_mfma_f32_16x16x32_bf16 v[108:111], a[156:159], v[236:239], v[108:111]
    buffer_load_dwordx4 v20, s[16:19], s60 offen offset:0 lds
    v_mfma_f32_16x16x32_bf16 v[100:103], a[156:159], v[232:235], v[100:103]
    ds_read_b64_tr_b16 a[190:191], v31 offset:22528
    s_waitcnt lgkmcnt(8)
    v_mfma_f32_16x16x32_bf16 v[96:99], a[160:163], a[240:243], v[96:99]
    buffer_load_dwordx4 v21, s[16:19], s60 offen offset:1024 lds
    v_mfma_f32_16x16x32_bf16 v[104:107], a[160:163], a[244:247], v[104:107]
    ds_read_b64_tr_b16 a[144:145], v28 offset:24576
    v_mfma_f32_16x16x32_bf16 v[108:111], a[164:167], a[244:247], v[108:111]
    ds_read_b64_tr_b16 a[146:147], v28 offset:26624
    ds_read_b64_tr_b16 a[148:149], v29 offset:24576
    v_mfma_f32_16x16x32_bf16 v[100:103], a[164:167], a[240:243], v[100:103]
    ds_read_b64_tr_b16 a[150:151], v29 offset:26624
    v_cvt_pk_bf16_f32 v80, v80, v81
    v_mfma_f32_16x16x32_bf16 v[96:99], a[168:171], a[248:251], v[96:99]
    s_lshl_b32 s62, s1, 10
    ds_read_b64_tr_b16 a[152:153], v28 offset:28672
    v_mfma_f32_16x16x32_bf16 v[104:107], a[168:171], a[252:255], v[104:107]
    ds_read_b64_tr_b16 a[154:155], v28 offset:30720
    v_cvt_pk_bf16_f32 v81, v82, v83
    v_mfma_f32_16x16x32_bf16 v[108:111], a[172:175], a[252:255], v[108:111]
    ds_read_b64_tr_b16 a[156:157], v29 offset:28672
    v_cvt_pk_bf16_f32 v82, v84, v85
    v_mfma_f32_16x16x32_bf16 v[100:103], a[172:175], a[248:251], v[100:103]
    s_add_u32 s62, s62, s101
    s_waitcnt lgkmcnt(7)
    v_cvt_pk_bf16_f32 v83, v86, v87
    v_mfma_f32_16x16x32_bf16 v[96:99], a[176:179], v[240:243], v[96:99]
    buffer_store_dwordx4 v[80:83], v44, s[24:27], s62 offen offset:0 sc1
    ds_read_b64_tr_b16 a[158:159], v29 offset:30720
    ds_read_b64_tr_b16 a[160:161], v28 offset:32768
    v_mfma_f32_16x16x32_bf16 v[104:107], a[176:179], v[244:247], v[104:107]
    ds_read_b64_tr_b16 a[162:163], v28 offset:34816
    v_mfma_f32_16x16x32_bf16 v[108:111], a[180:183], v[244:247], v[108:111]
    ds_read_b64_tr_b16 a[164:165], v29 offset:32768
    v_cvt_pk_bf16_f32 v88, v88, v89
    v_mfma_f32_16x16x32_bf16 v[100:103], a[180:183], v[240:243], v[100:103]
    ds_read_b64_tr_b16 a[166:167], v29 offset:34816
    v_mfma_f32_16x16x32_bf16 v[96:99], a[184:187], a[0:3], v[96:99]
    v_cvt_pk_bf16_f32 v89, v90, v91
    v_cvt_pk_bf16_f32 v90, v92, v93
    v_mfma_f32_16x16x32_bf16 v[104:107], a[184:187], a[4:7], v[104:107]
    ds_read_b64_tr_b16 a[168:169], v28 offset:36864
    v_cvt_pk_bf16_f32 v91, v94, v95
    v_mfma_f32_16x16x32_bf16 v[108:111], a[188:191], a[4:7], v[108:111]
    buffer_store_dwordx4 v[88:91], v44, s[24:27], s62 offen offset:1024 sc1
    ds_read_b64_tr_b16 a[170:171], v28 offset:38912
    ds_read_b64_tr_b16 a[172:173], v29 offset:36864
    v_mfma_f32_16x16x32_bf16 v[100:103], a[188:191], a[0:3], v[100:103]
    s_waitcnt lgkmcnt(7)
    ds_read_b64_tr_b16 a[174:175], v29 offset:38912
    v_mfma_f32_16x16x32_bf16 v[112:115], a[144:147], v[224:227], v[112:115]
    ds_read_b64_tr_b16 a[176:177], v28 offset:40960
    v_mfma_f32_16x16x32_bf16 v[120:123], a[144:147], v[228:231], v[120:123]
    ds_read_b64_tr_b16 a[178:179], v28 offset:43008
    v_mfma_f32_16x16x32_bf16 v[124:127], a[148:151], v[228:231], v[124:127]
    ds_read_b64_tr_b16 a[180:181], v29 offset:40960
    v_mfma_f32_16x16x32_bf16 v[116:119], a[148:151], v[224:227], v[116:119]
    ds_read_b64_tr_b16 a[182:183], v29 offset:43008
    ds_read_b64_tr_b16 a[184:185], v28 offset:45056
    v_mfma_f32_16x16x32_bf16 v[112:115], a[152:155], v[232:235], v[112:115]
    s_waitcnt vmcnt(12)
    s_barrier
    v_mfma_f32_16x16x32_bf16 v[120:123], a[152:155], v[236:239], v[120:123]
    s_add_u32 s60, s69, s41
    ds_read_b64_tr_b16 a[186:187], v28 offset:47104
    v_mfma_f32_16x16x32_bf16 v[124:127], a[156:159], v[236:239], v[124:127]
    ds_read_b64_tr_b16 a[188:189], v29 offset:45056
    s_add_u32 m0, s74, 0x0
    v_mfma_f32_16x16x32_bf16 v[116:119], a[156:159], v[232:235], v[116:119]
    s_waitcnt lgkmcnt(7)
    ds_read_b64_tr_b16 a[190:191], v29 offset:47104
    ds_read_b64_tr_b16 a[144:145], v30 offset:24576
    v_mfma_f32_16x16x32_bf16 v[112:115], a[160:163], a[240:243], v[112:115]
    buffer_load_dwordx4 v20, s[16:19], s60 offen offset:0 lds
    v_mfma_f32_16x16x32_bf16 v[120:123], a[160:163], a[244:247], v[120:123]
    buffer_load_dwordx4 v21, s[16:19], s60 offen offset:1024 lds
    v_mfma_f32_16x16x32_bf16 v[124:127], a[164:167], a[244:247], v[124:127]
    ds_read_b64_tr_b16 a[146:147], v30 offset:26624
    buffer_load_dwordx4 v22, s[16:19], s60 offen offset:2048 lds
    v_mfma_f32_16x16x32_bf16 v[116:119], a[164:167], a[240:243], v[116:119]
    ds_read_b64_tr_b16 a[148:149], v31 offset:24576
    buffer_load_dwordx4 v23, s[16:19], s60 offen offset:3072 lds
    ds_read_b64_tr_b16 a[150:151], v31 offset:26624
    v_mfma_f32_16x16x32_bf16 v[112:115], a[168:171], a[248:251], v[112:115]
    ds_read_b64_tr_b16 a[152:153], v30 offset:28672
    s_add_u32 s60, s70, s41
    v_mfma_f32_16x16x32_bf16 v[120:123], a[168:171], a[252:255], v[120:123]
    s_add_u32 m0, s75, 0x0
    ds_read_b64_tr_b16 a[154:155], v30 offset:30720
    ds_read_b64_tr_b16 a[156:157], v31 offset:28672
    v_mfma_f32_16x16x32_bf16 v[124:127], a[172:175], a[252:255], v[124:127]
    buffer_load_dwordx4 v20, s[16:19], s60 offen offset:0 lds
    v_mfma_f32_16x16x32_bf16 v[116:119], a[172:175], a[248:251], v[116:119]
    s_waitcnt lgkmcnt(7)
    buffer_load_dwordx4 v21, s[16:19], s60 offen offset:1024 lds
    ds_read_b64_tr_b16 a[158:159], v31 offset:30720
    v_mfma_f32_16x16x32_bf16 v[112:115], a[176:179], v[240:243], v[112:115]
    ds_read_b64_tr_b16 a[160:161], v30 offset:32768
    v_cvt_pk_bf16_f32 v96, v96, v97
    v_mfma_f32_16x16x32_bf16 v[120:123], a[176:179], v[244:247], v[120:123]
    ds_read_b64_tr_b16 a[162:163], v30 offset:34816
    v_cvt_pk_bf16_f32 v97, v98, v99
    v_mfma_f32_16x16x32_bf16 v[124:127], a[180:183], v[244:247], v[124:127]
    s_xor_b32 s62, s62, 0x10000
    ds_read_b64_tr_b16 a[164:165], v31 offset:32768
    v_cvt_pk_bf16_f32 v98, v100, v101
    v_mfma_f32_16x16x32_bf16 v[116:119], a[180:183], v[240:243], v[116:119]
    ds_read_b64_tr_b16 a[166:167], v31 offset:34816
    v_cvt_pk_bf16_f32 v104, v104, v105
    v_mfma_f32_16x16x32_bf16 v[112:115], a[184:187], a[0:3], v[112:115]
    ds_read_b64_tr_b16 a[168:169], v30 offset:36864
    v_mfma_f32_16x16x32_bf16 v[120:123], a[184:187], a[4:7], v[120:123]
    ds_read_b64_tr_b16 a[170:171], v30 offset:38912
    v_cvt_pk_bf16_f32 v99, v102, v103
    v_mfma_f32_16x16x32_bf16 v[124:127], a[188:191], a[4:7], v[124:127]
    ds_read_b64_tr_b16 a[172:173], v31 offset:36864
    v_mfma_f32_16x16x32_bf16 v[116:119], a[188:191], a[0:3], v[116:119]
    buffer_store_dwordx4 v[96:99], v44, s[24:27], s62 offen offset:0 sc1
    ds_read_b64_tr_b16 a[174:175], v31 offset:38912
    s_waitcnt lgkmcnt(8)
    v_mfma_f32_16x16x32_bf16 v[128:131], a[144:147], v[224:227], v[128:131]
    ds_read_b64_tr_b16 a[176:177], v30 offset:40960
    v_cvt_pk_bf16_f32 v105, v106, v107
    v_mfma_f32_16x16x32_bf16 v[136:139], a[144:147], v[228:231], v[136:139]
    ds_read_b64_tr_b16 a[178:179], v30 offset:43008
    v_cvt_pk_bf16_f32 v106, v108, v109
    v_mfma_f32_16x16x32_bf16 v[140:143], a[148:151], v[228:231], v[140:143]
    ds_read_b64_tr_b16 a[180:181], v31 offset:40960
    v_mfma_f32_16x16x32_bf16 v[132:135], a[148:151], v[224:227], v[132:135]
    ds_read_b64_tr_b16 a[182:183], v31 offset:43008
    v_cvt_pk_bf16_f32 v107, v110, v111
    v_mfma_f32_16x16x32_bf16 v[128:131], a[152:155], v[232:235], v[128:131]
    buffer_store_dwordx4 v[104:107], v44, s[24:27], s62 offen offset:1024 sc1
    ds_read_b64_tr_b16 a[184:185], v30 offset:45056
    v_cvt_pk_bf16_f32 v112, v112, v113
    s_lshl_b32 s62, s3, 10
    v_mfma_f32_16x16x32_bf16 v[136:139], a[152:155], v[236:239], v[136:139]
    ds_read_b64_tr_b16 a[186:187], v30 offset:47104
    v_mfma_f32_16x16x32_bf16 v[140:143], a[156:159], v[236:239], v[140:143]
    ds_read_b64_tr_b16 a[188:189], v31 offset:45056
    v_cvt_pk_bf16_f32 v113, v114, v115
    v_mfma_f32_16x16x32_bf16 v[132:135], a[156:159], v[232:235], v[132:135]
    s_waitcnt lgkmcnt(7)
    s_add_u32 s62, s62, s101
    ds_read_b64_tr_b16 a[190:191], v31 offset:47104
    v_mfma_f32_16x16x32_bf16 v[128:131], a[160:163], a[240:243], v[128:131]
    ds_read_b64_tr_b16 a[144:145], v32 offset:0
    v_mfma_f32_16x16x32_bf16 v[136:139], a[160:163], a[244:247], v[136:139]
    ds_read_b64_tr_b16 a[146:147], v32 offset:2048
    v_cvt_pk_bf16_f32 v115, v118, v119
    v_mfma_f32_16x16x32_bf16 v[140:143], a[164:167], a[244:247], v[140:143]
    ds_read_b64_tr_b16 a[148:149], v33 offset:0
    v_cvt_pk_bf16_f32 v114, v116, v117
    v_mfma_f32_16x16x32_bf16 v[132:135], a[164:167], a[240:243], v[132:135]
    buffer_store_dwordx4 v[112:115], v44, s[24:27], s62 offen offset:0 sc1
    ds_read_b64_tr_b16 a[150:151], v33 offset:2048
    v_mfma_f32_16x16x32_bf16 v[128:131], a[168:171], a[248:251], v[128:131]
    ds_read_b64_tr_b16 a[152:153], v32 offset:4096
    v_mfma_f32_16x16x32_bf16 v[136:139], a[168:171], a[252:255], v[136:139]
    ds_read_b64_tr_b16 a[154:155], v32 offset:6144
    v_cvt_pk_bf16_f32 v120, v120, v121
    v_mfma_f32_16x16x32_bf16 v[140:143], a[172:175], a[252:255], v[140:143]
    ds_read_b64_tr_b16 a[156:157], v33 offset:4096
    v_cvt_pk_bf16_f32 v121, v122, v123
    v_mfma_f32_16x16x32_bf16 v[132:135], a[172:175], a[248:251], v[132:135]
    s_waitcnt lgkmcnt(7)
    v_mfma_f32_16x16x32_bf16 v[128:131], a[176:179], v[240:243], v[128:131]
    ds_read_b64_tr_b16 a[158:159], v33 offset:6144
    v_cvt_pk_bf16_f32 v123, v126, v127
    v_mfma_f32_16x16x32_bf16 v[136:139], a[176:179], v[244:247], v[136:139]
    ds_read_b64_tr_b16 a[160:161], v32 offset:8192
    v_cvt_pk_bf16_f32 v122, v124, v125
    v_mfma_f32_16x16x32_bf16 v[140:143], a[180:183], v[244:247], v[140:143]
    buffer_store_dwordx4 v[120:123], v44, s[24:27], s62 offen offset:1024 sc1
    ds_read_b64_tr_b16 a[162:163], v32 offset:10240
    ds_read_b64_tr_b16 a[164:165], v33 offset:8192
    v_mfma_f32_16x16x32_bf16 v[132:135], a[180:183], v[240:243], v[132:135]
    ds_read_b64_tr_b16 a[166:167], v33 offset:10240
    v_mfma_f32_16x16x32_bf16 v[128:131], a[184:187], a[0:3], v[128:131]
    ds_read_b64_tr_b16 a[168:169], v32 offset:12288
    v_mfma_f32_16x16x32_bf16 v[136:139], a[184:187], a[4:7], v[136:139]
    ds_read_b64_tr_b16 a[170:171], v32 offset:14336
    v_mfma_f32_16x16x32_bf16 v[140:143], a[188:191], a[4:7], v[140:143]
    ds_read_b64_tr_b16 a[172:173], v33 offset:12288
    v_mfma_f32_16x16x32_bf16 v[132:135], a[188:191], a[0:3], v[132:135]
    s_waitcnt lgkmcnt(7)
    ds_read_b64_tr_b16 a[174:175], v33 offset:14336
    v_mfma_f32_16x16x32_bf16 v[144:147], a[144:147], v[176:179], 0
    ds_read_b64_tr_b16 a[176:177], v32 offset:16384
    v_mfma_f32_16x16x32_bf16 v[152:155], a[144:147], v[180:183], 0
    ds_read_b64_tr_b16 a[178:179], v32 offset:18432
    v_mfma_f32_16x16x32_bf16 v[156:159], a[148:151], v[180:183], 0
    ds_read_b64_tr_b16 a[180:181], v33 offset:16384
    v_mfma_f32_16x16x32_bf16 v[148:151], a[148:151], v[176:179], 0
    ds_read_b64_tr_b16 a[182:183], v33 offset:18432
    ds_read_b64_tr_b16 a[184:185], v32 offset:20480
    v_mfma_f32_16x16x32_bf16 v[144:147], a[152:155], v[184:187], v[144:147]
    s_waitcnt vmcnt(12)
    s_barrier
    v_mfma_f32_16x16x32_bf16 v[152:155], a[152:155], v[188:191], v[152:155]
    ds_read_b64_tr_b16 a[186:187], v32 offset:22528
    v_cvt_pk_bf16_f32 v128, v128, v129
    v_mfma_f32_16x16x32_bf16 v[156:159], a[156:159], v[188:191], v[156:159]
    buffer_store_dword v43, v42, s[24:27], s40 offen offset:0 sc1
    ds_read_b64_tr_b16 a[188:189], v33 offset:20480
    v_mfma_f32_16x16x32_bf16 v[148:151], a[156:159], v[184:187], v[148:151]
    s_waitcnt lgkmcnt(7)
    ds_read_b64_tr_b16 a[190:191], v33 offset:22528
    v_cvt_pk_bf16_f32 v129, v130, v131
    v_mfma_f32_16x16x32_bf16 v[144:147], a[160:163], v[192:195], v[144:147]
    ds_read_b64_tr_b16 a[144:145], v32 offset:24576
    v_mfma_f32_16x16x32_bf16 v[152:155], a[160:163], v[196:199], v[152:155]
    s_xor_b32 s62, s62, 0x10000
    ds_read_b64_tr_b16 a[146:147], v32 offset:26624
    v_mfma_f32_16x16x32_bf16 v[156:159], a[164:167], v[196:199], v[156:159]
    v_cvt_pk_bf16_f32 v131, v134, v135
    v_cvt_pk_bf16_f32 v130, v132, v133
    v_mfma_f32_16x16x32_bf16 v[148:151], a[164:167], v[192:195], v[148:151]
    buffer_store_dwordx4 v[128:131], v44, s[24:27], s62 offen offset:0 sc1
    ds_read_b64_tr_b16 a[148:149], v33 offset:24576
    ds_read_b64_tr_b16 a[150:151], v33 offset:26624
    v_mfma_f32_16x16x32_bf16 v[144:147], a[168:171], v[200:203], v[144:147]
    ds_read_b64_tr_b16 a[152:153], v32 offset:28672
    v_mfma_f32_16x16x32_bf16 v[152:155], a[168:171], v[204:207], v[152:155]
    ds_read_b64_tr_b16 a[154:155], v32 offset:30720
    v_cvt_pk_bf16_f32 v136, v136, v137
    v_mfma_f32_16x16x32_bf16 v[156:159], a[172:175], v[204:207], v[156:159]
    ds_read_b64_tr_b16 a[156:157], v33 offset:28672
    v_mfma_f32_16x16x32_bf16 v[148:151], a[172:175], v[200:203], v[148:151]
    ds_read_b64_tr_b16 a[158:159], v33 offset:30720
    s_waitcnt lgkmcnt(8)
    v_mfma_f32_16x16x32_bf16 v[144:147], a[176:179], v[208:211], v[144:147]
    v_cvt_pk_bf16_f32 v137, v138, v139
    v_cvt_pk_bf16_f32 v139, v142, v143
    v_mfma_f32_16x16x32_bf16 v[152:155], a[176:179], v[212:215], v[152:155]
    ds_read_b64_tr_b16 a[160:161], v32 offset:32768
    v_cvt_pk_bf16_f32 v138, v140, v141
    v_mfma_f32_16x16x32_bf16 v[156:159], a[180:183], v[212:215], v[156:159]
    buffer_store_dwordx4 v[136:139], v44, s[24:27], s62 offen offset:1024 sc1
    ds_read_b64_tr_b16 a[162:163], v32 offset:34816
    ds_read_b64_tr_b16 a[164:165], v33 offset:32768
    v_mfma_f32_16x16x32_bf16 v[148:151], a[180:183], v[208:211], v[148:151]
    ds_read_b64_tr_b16 a[166:167], v33 offset:34816
    v_mfma_f32_16x16x32_bf16 v[144:147], a[184:187], v[216:219], v[144:147]
    ds_read_b64_tr_b16 a[168:169], v32 offset:36864
    v_mfma_f32_16x16x32_bf16 v[152:155], a[184:187], v[220:223], v[152:155]
    ds_read_b64_tr_b16 a[170:171], v32 offset:38912
    v_mfma_f32_16x16x32_bf16 v[156:159], a[188:191], v[220:223], v[156:159]
    ds_read_b64_tr_b16 a[172:173], v33 offset:36864
    v_mfma_f32_16x16x32_bf16 v[148:151], a[188:191], v[216:219], v[148:151]
    s_waitcnt lgkmcnt(7)
    ds_read_b64_tr_b16 a[174:175], v33 offset:38912
    v_mfma_f32_16x16x32_bf16 v[144:147], a[144:147], a[192:195], v[144:147]
    ds_read_b64_tr_b16 a[176:177], v32 offset:40960
    v_mfma_f32_16x16x32_bf16 v[152:155], a[144:147], a[196:199], v[152:155]
    ds_read_b64_tr_b16 a[178:179], v32 offset:43008
    v_mfma_f32_16x16x32_bf16 v[156:159], a[148:151], a[196:199], v[156:159]
    ds_read_b64_tr_b16 a[180:181], v33 offset:40960
    v_mfma_f32_16x16x32_bf16 v[148:151], a[148:151], a[192:195], v[148:151]
    ds_read_b64_tr_b16 a[182:183], v33 offset:43008
    v_mfma_f32_16x16x32_bf16 v[144:147], a[152:155], a[200:203], v[144:147]
    s_waitcnt vmcnt(7)
    s_barrier
    v_mfma_f32_16x16x32_bf16 v[152:155], a[152:155], a[204:207], v[152:155]
    ds_read_b64_tr_b16 a[184:185], v32 offset:45056
    v_mfma_f32_16x16x32_bf16 v[156:159], a[156:159], a[204:207], v[156:159]
    ds_read_b64_tr_b16 a[186:187], v32 offset:47104
    ds_read_b64_tr_b16 a[188:189], v33 offset:45056
    v_mfma_f32_16x16x32_bf16 v[148:151], a[156:159], a[200:203], v[148:151]
    s_waitcnt lgkmcnt(7)
    ds_read_b64_tr_b16 a[190:191], v33 offset:47104
    v_mfma_f32_16x16x32_bf16 v[144:147], a[160:163], a[208:211], v[144:147]
    ds_read_b64_tr_b16 a[144:145], v28 offset:0
    v_mfma_f32_16x16x32_bf16 v[152:155], a[160:163], a[212:215], v[152:155]
    ds_read_b64_tr_b16 a[146:147], v28 offset:2048
    v_mfma_f32_16x16x32_bf16 v[156:159], a[164:167], a[212:215], v[156:159]
    ds_read_b64_tr_b16 a[148:149], v29 offset:0
    v_mfma_f32_16x16x32_bf16 v[148:151], a[164:167], a[208:211], v[148:151]
    ds_read_b64_tr_b16 a[150:151], v29 offset:2048
    v_mfma_f32_16x16x32_bf16 v[144:147], a[168:171], a[216:219], v[144:147]
    ds_read_b64_tr_b16 a[152:153], v28 offset:4096
    v_mfma_f32_16x16x32_bf16 v[152:155], a[168:171], a[220:223], v[152:155]
    ds_read_b64_tr_b16 a[154:155], v28 offset:6144
    v_mfma_f32_16x16x32_bf16 v[156:159], a[172:175], a[220:223], v[156:159]
    ds_read_b64_tr_b16 a[156:157], v29 offset:4096
    v_mfma_f32_16x16x32_bf16 v[148:151], a[172:175], a[216:219], v[148:151]
    s_waitcnt lgkmcnt(7)
    ds_read_b64_tr_b16 a[158:159], v29 offset:6144
    v_mfma_f32_16x16x32_bf16 v[144:147], a[176:179], a[224:227], v[144:147]
    ds_read_b64_tr_b16 a[160:161], v28 offset:8192
    v_mfma_f32_16x16x32_bf16 v[152:155], a[176:179], a[228:231], v[152:155]
    ds_read_b64_tr_b16 a[162:163], v28 offset:10240
    v_mfma_f32_16x16x32_bf16 v[156:159], a[180:183], a[228:231], v[156:159]
    ds_read_b64_tr_b16 a[164:165], v29 offset:8192
    v_mfma_f32_16x16x32_bf16 v[148:151], a[180:183], a[224:227], v[148:151]
    ds_read_b64_tr_b16 a[166:167], v29 offset:10240
    v_mfma_f32_16x16x32_bf16 v[144:147], a[184:187], a[232:235], v[144:147]
    ds_read_b64_tr_b16 a[168:169], v28 offset:12288
    v_mfma_f32_16x16x32_bf16 v[152:155], a[184:187], a[236:239], v[152:155]
    ds_read_b64_tr_b16 a[170:171], v28 offset:14336
    v_mfma_f32_16x16x32_bf16 v[156:159], a[188:191], a[236:239], v[156:159]
    ds_read_b64_tr_b16 a[172:173], v29 offset:12288
    v_mfma_f32_16x16x32_bf16 v[148:151], a[188:191], a[232:235], v[148:151]
    s_waitcnt lgkmcnt(7)
    ds_read_b64_tr_b16 a[174:175], v29 offset:14336
    v_mfma_f32_16x16x32_bf16 v[144:147], a[144:147], v[224:227], v[144:147]
    ds_read_b64_tr_b16 a[176:177], v28 offset:16384
    v_mfma_f32_16x16x32_bf16 v[152:155], a[144:147], v[228:231], v[152:155]
    ds_read_b64_tr_b16 a[178:179], v28 offset:18432
    v_mfma_f32_16x16x32_bf16 v[156:159], a[148:151], v[228:231], v[156:159]
    ds_read_b64_tr_b16 a[180:181], v29 offset:16384
    v_mfma_f32_16x16x32_bf16 v[148:151], a[148:151], v[224:227], v[148:151]
    ds_read_b64_tr_b16 a[182:183], v29 offset:18432
    ds_read_b64_tr_b16 a[184:185], v28 offset:20480
    v_mfma_f32_16x16x32_bf16 v[144:147], a[152:155], v[232:235], v[144:147]
    s_waitcnt vmcnt(5)
    buffer_store_dword v43, v42, s[24:27], s40 offen offset:512 sc1
    v_mfma_f32_16x16x32_bf16 v[152:155], a[152:155], v[236:239], v[152:155]
    buffer_load_dword v46, v18, s[24:27], 0 offen offset:0 sc1
    v_mfma_f32_16x16x32_bf16 v[156:159], a[156:159], v[236:239], v[156:159]
    ds_read_b64_tr_b16 a[186:187], v28 offset:22528
    ds_read_b64_tr_b16 a[188:189], v29 offset:20480
    v_mfma_f32_16x16x32_bf16 v[148:151], a[156:159], v[232:235], v[148:151]
    s_waitcnt lgkmcnt(7)
    ds_read_b64_tr_b16 a[190:191], v29 offset:22528
    v_mfma_f32_16x16x32_bf16 v[144:147], a[160:163], a[240:243], v[144:147]
    ds_read_b64_tr_b16 a[144:145], v34 offset:0
    v_mfma_f32_16x16x32_bf16 v[152:155], a[160:163], a[244:247], v[152:155]
    ds_read_b64_tr_b16 a[146:147], v34 offset:2048
    v_mfma_f32_16x16x32_bf16 v[156:159], a[164:167], a[244:247], v[156:159]
    ds_read_b64_tr_b16 a[148:149], v35 offset:0
    v_mfma_f32_16x16x32_bf16 v[148:151], a[164:167], a[240:243], v[148:151]
    ds_read_b64_tr_b16 a[150:151], v35 offset:2048
    v_mfma_f32_16x16x32_bf16 v[144:147], a[168:171], a[248:251], v[144:147]
    ds_read_b64_tr_b16 a[152:153], v34 offset:4096
    v_mfma_f32_16x16x32_bf16 v[152:155], a[168:171], a[252:255], v[152:155]
    ds_read_b64_tr_b16 a[154:155], v34 offset:6144
    v_mfma_f32_16x16x32_bf16 v[156:159], a[172:175], a[252:255], v[156:159]
    ds_read_b64_tr_b16 a[156:157], v35 offset:4096
    v_mfma_f32_16x16x32_bf16 v[148:151], a[172:175], a[248:251], v[148:151]
    s_waitcnt lgkmcnt(7)
    ds_read_b64_tr_b16 a[158:159], v35 offset:6144
    v_mfma_f32_16x16x32_bf16 v[144:147], a[176:179], v[240:243], v[144:147]
    ds_read_b64_tr_b16 a[160:161], v34 offset:8192
    v_mfma_f32_16x16x32_bf16 v[152:155], a[176:179], v[244:247], v[152:155]
    ds_read_b64_tr_b16 a[162:163], v34 offset:10240
    v_mfma_f32_16x16x32_bf16 v[156:159], a[180:183], v[244:247], v[156:159]
    ds_read_b64_tr_b16 a[164:165], v35 offset:8192
    v_mfma_f32_16x16x32_bf16 v[148:151], a[180:183], v[240:243], v[148:151]
    ds_read_b64_tr_b16 a[166:167], v35 offset:10240
    v_mfma_f32_16x16x32_bf16 v[144:147], a[184:187], a[0:3], v[144:147]
    ds_read_b64_tr_b16 a[168:169], v34 offset:12288
    v_mfma_f32_16x16x32_bf16 v[152:155], a[184:187], a[4:7], v[152:155]
    ds_read_b64_tr_b16 a[170:171], v34 offset:14336
    v_mfma_f32_16x16x32_bf16 v[156:159], a[188:191], a[4:7], v[156:159]
    ds_read_b64_tr_b16 a[172:173], v35 offset:12288
    v_mfma_f32_16x16x32_bf16 v[148:151], a[188:191], a[0:3], v[148:151]
    ds_read_b64_tr_b16 a[174:175], v35 offset:14336
    s_waitcnt lgkmcnt(8)
    v_mfma_f32_16x16x32_bf16 v[160:163], a[144:147], v[176:179], 0
    s_lshl_b32 s62, s41, 10
    ds_read_b64_tr_b16 a[176:177], v34 offset:16384
    ds_read_b64_tr_b16 a[178:179], v34 offset:18432
    v_mfma_f32_16x16x32_bf16 v[168:171], a[144:147], v[180:183], 0
    s_add_u32 s62, s62, s101
    ds_read_b64_tr_b16 a[180:181], v35 offset:16384
    v_cvt_pk_bf16_f32 v144, v144, v145
    v_mfma_f32_16x16x32_bf16 v[172:175], a[148:151], v[180:183], 0
    ds_read_b64_tr_b16 a[182:183], v35 offset:18432
    v_mfma_f32_16x16x32_bf16 v[164:167], a[148:151], v[176:179], 0
    ds_read_b64_tr_b16 a[184:185], v34 offset:20480
    v_cvt_pk_bf16_f32 v145, v146, v147
    v_mfma_f32_16x16x32_bf16 v[160:163], a[152:155], v[184:187], v[160:163]
    v_cvt_pk_bf16_f32 v147, v150, v151
    v_mfma_f32_16x16x32_bf16 v[168:171], a[152:155], v[188:191], v[168:171]
    ds_read_b64_tr_b16 a[186:187], v34 offset:22528
    v_cvt_pk_bf16_f32 v146, v148, v149
    v_mfma_f32_16x16x32_bf16 v[172:175], a[156:159], v[188:191], v[172:175]
    ds_read_b64_tr_b16 a[188:189], v35 offset:20480
    v_cvt_pk_bf16_f32 v152, v152, v153
    v_mfma_f32_16x16x32_bf16 v[164:167], a[156:159], v[184:187], v[164:167]
    s_waitcnt lgkmcnt(7)
    buffer_store_dwordx4 v[144:147], v44, s[24:27], s62 offen offset:0 sc1
    ds_read_b64_tr_b16 a[190:191], v35 offset:22528
    v_cvt_pk_bf16_f32 v153, v154, v155
    v_cvt_pk_bf16_f32 v154, v156, v157
    v_mfma_f32_16x16x32_bf16 v[160:163], a[160:163], v[192:195], v[160:163]
    ds_read_b64_tr_b16 a[144:145], v34 offset:24576
    v_cvt_pk_bf16_f32 v155, v158, v159
    v_mfma_f32_16x16x32_bf16 v[168:171], a[160:163], v[196:199], v[168:171]
    buffer_store_dwordx4 v[152:155], v44, s[24:27], s62 offen offset:1024 sc1
    ds_read_b64_tr_b16 a[146:147], v34 offset:26624
    ds_read_b64_tr_b16 a[148:149], v35 offset:24576
    v_mfma_f32_16x16x32_bf16 v[172:175], a[164:167], v[196:199], v[172:175]
    ds_read_b64_tr_b16 a[150:151], v35 offset:26624
    v_mfma_f32_16x16x32_bf16 v[164:167], a[164:167], v[192:195], v[164:167]
    v_mfma_f32_16x16x32_bf16 v[160:163], a[168:171], v[200:203], v[160:163]
    ds_read_b64_tr_b16 a[152:153], v34 offset:28672
    v_mfma_f32_16x16x32_bf16 v[168:171], a[168:171], v[204:207], v[168:171]
    ds_read_b64_tr_b16 a[154:155], v34 offset:30720
    v_mfma_f32_16x16x32_bf16 v[172:175], a[172:175], v[204:207], v[172:175]
    ds_read_b64_tr_b16 a[156:157], v35 offset:28672
    v_mfma_f32_16x16x32_bf16 v[164:167], a[172:175], v[200:203], v[164:167]
    s_waitcnt lgkmcnt(7)
    ds_read_b64_tr_b16 a[158:159], v35 offset:30720
    v_mfma_f32_16x16x32_bf16 v[160:163], a[176:179], v[208:211], v[160:163]
    ds_read_b64_tr_b16 a[160:161], v34 offset:32768
    v_mfma_f32_16x16x32_bf16 v[168:171], a[176:179], v[212:215], v[168:171]
    ds_read_b64_tr_b16 a[162:163], v34 offset:34816
    v_mfma_f32_16x16x32_bf16 v[172:175], a[180:183], v[212:215], v[172:175]
    ds_read_b64_tr_b16 a[164:165], v35 offset:32768
    v_mfma_f32_16x16x32_bf16 v[164:167], a[180:183], v[208:211], v[164:167]
    ds_read_b64_tr_b16 a[166:167], v35 offset:34816
    v_mfma_f32_16x16x32_bf16 v[160:163], a[184:187], v[216:219], v[160:163]
    s_waitcnt vmcnt(2)
    v_cmp_ne_u32 vcc, v46, v43
    v_mfma_f32_16x16x32_bf16 v[168:171], a[184:187], v[220:223], v[168:171]
    ds_read_b64_tr_b16 a[168:169], v34 offset:36864
    ds_read_b64_tr_b16 a[170:171], v34 offset:38912
    v_mfma_f32_16x16x32_bf16 v[172:175], a[188:191], v[220:223], v[172:175]
    s_cbranch_vccnz SLOW6
BACK6:
    v_mfma_f32_16x16x32_bf16 v[164:167], a[188:191], v[216:219], v[164:167]
    s_lshl_b32 s62, s3, 7
    s_waitcnt lgkmcnt(6)
    ds_read_b64_tr_b16 a[172:173], v35 offset:36864
    v_mfma_f32_16x16x32_bf16 v[160:163], a[144:147], a[192:195], v[160:163]
    buffer_load_dword v46, v18, s[24:27], 0 offen offset:512 sc1
    ds_read_b64_tr_b16 a[174:175], v35 offset:38912
    v_mfma_f32_16x16x32_bf16 v[168:171], a[144:147], a[196:199], v[168:171]
    buffer_load_dwordx4 a[16:19], v19, s[24:27], s62 offen offset:0 sc1
    ds_read_b64_tr_b16 a[176:177], v34 offset:40960
    v_mfma_f32_16x16x32_bf16 v[172:175], a[148:151], a[196:199], v[172:175]
    ds_read_b64_tr_b16 a[178:179], v34 offset:43008
    buffer_load_dwordx4 a[20:23], v19, s[24:27], s62 offen offset:1024 sc1
    v_mfma_f32_16x16x32_bf16 v[164:167], a[148:151], a[192:195], v[164:167]
    s_add_u32 s62, s62, 8192
    ds_read_b64_tr_b16 a[180:181], v35 offset:40960
    ds_read_b64_tr_b16 a[182:183], v35 offset:43008
    v_mfma_f32_16x16x32_bf16 v[160:163], a[152:155], a[200:203], v[160:163]
    ds_read_b64_tr_b16 a[184:185], v34 offset:45056
    v_mfma_f32_16x16x32_bf16 v[168:171], a[152:155], a[204:207], v[168:171]
    ds_read_b64_tr_b16 a[186:187], v34 offset:47104
    ds_read_b64_tr_b16 a[188:189], v35 offset:45056
    v_mfma_f32_16x16x32_bf16 v[172:175], a[156:159], a[204:207], v[172:175]
    buffer_load_dwordx4 a[24:27], v19, s[24:27], s62 offen offset:0 sc1
    v_mfma_f32_16x16x32_bf16 v[164:167], a[156:159], a[200:203], v[164:167]
    ds_read_b64_tr_b16 a[190:191], v35 offset:47104
    s_waitcnt lgkmcnt(8)
    v_mfma_f32_16x16x32_bf16 v[160:163], a[160:163], a[208:211], v[160:163]
    buffer_load_dwordx4 a[28:31], v19, s[24:27], s62 offen offset:1024 sc1
    v_mfma_f32_16x16x32_bf16 v[168:171], a[160:163], a[212:215], v[168:171]
    ds_read_b64_tr_b16 a[144:145], v30 offset:0
    v_mfma_f32_16x16x32_bf16 v[172:175], a[164:167], a[212:215], v[172:175]
    buffer_load_dwordx4 a[48:51], v45, s[24:27], 0 offen sc1
    v_mfma_f32_16x16x32_bf16 v[164:167], a[164:167], a[208:211], v[164:167]
    ds_read_b64_tr_b16 a[146:147], v30 offset:2048
    ds_read_b64_tr_b16 a[148:149], v31 offset:0
    v_mfma_f32_16x16x32_bf16 v[160:163], a[168:171], a[216:219], v[160:163]
    buffer_load_dwordx4 a[52:55], v45, s[24:27], s80 offen sc1
    v_mfma_f32_16x16x32_bf16 v[168:171], a[168:171], a[220:223], v[168:171]
    ds_read_b64_tr_b16 a[150:151], v31 offset:2048
    v_mfma_f32_16x16x32_bf16 v[172:175], a[172:175], a[220:223], v[172:175]
    ds_read_b64_tr_b16 a[152:153], v30 offset:4096
    ds_read_b64_tr_b16 a[154:155], v30 offset:6144
    v_mfma_f32_16x16x32_bf16 v[164:167], a[172:175], a[216:219], v[164:167]
    s_waitcnt lgkmcnt(6)
    ds_read_b64_tr_b16 a[156:157], v31 offset:4096
    v_mfma_f32_16x16x32_bf16 v[160:163], a[176:179], a[224:227], v[160:163]
    ds_read_b64_tr_b16 a[158:159], v31 offset:6144
    v_mfma_f32_16x16x32_bf16 v[168:171], a[176:179], a[228:231], v[168:171]
    ds_read_b64_tr_b16 a[160:161], v30 offset:8192
    v_mfma_f32_16x16x32_bf16 v[172:175], a[180:183], a[228:231], v[172:175]
    ds_read_b64_tr_b16 a[162:163], v30 offset:10240
    v_mfma_f32_16x16x32_bf16 v[164:167], a[180:183], a[224:227], v[164:167]
    ds_read_b64_tr_b16 a[164:165], v31 offset:8192
    v_mfma_f32_16x16x32_bf16 v[160:163], a[184:187], a[232:235], v[160:163]
    ds_read_b64_tr_b16 a[166:167], v31 offset:10240
    v_mfma_f32_16x16x32_bf16 v[168:171], a[184:187], a[236:239], v[168:171]
    ds_read_b64_tr_b16 a[168:169], v30 offset:12288
    ds_read_b64_tr_b16 a[170:171], v30 offset:14336
    v_mfma_f32_16x16x32_bf16 v[172:175], a[188:191], a[236:239], v[172:175]
    ds_read_b64_tr_b16 a[172:173], v31 offset:12288
    v_mfma_f32_16x16x32_bf16 v[164:167], a[188:191], a[232:235], v[164:167]
    s_waitcnt lgkmcnt(7)
    ds_read_b64_tr_b16 a[174:175], v31 offset:14336
    v_mfma_f32_16x16x32_bf16 v[160:163], a[144:147], v[224:227], v[160:163]
    ds_read_b64_tr_b16 a[176:177], v30 offset:16384
    v_mfma_f32_16x16x32_bf16 v[168:171], a[144:147], v[228:231], v[168:171]
    ds_read_b64_tr_b16 a[178:179], v30 offset:18432
    v_mfma_f32_16x16x32_bf16 v[172:175], a[148:151], v[228:231], v[172:175]
    ds_read_b64_tr_b16 a[180:181], v31 offset:16384
    v_mfma_f32_16x16x32_bf16 v[164:167], a[148:151], v[224:227], v[164:167]
    ds_read_b64_tr_b16 a[182:183], v31 offset:18432
    v_mfma_f32_16x16x32_bf16 v[160:163], a[152:155], v[232:235], v[160:163]
    s_waitcnt vmcnt(6)
    v_cmp_ne_u32 vcc, v46, v43
    v_mfma_f32_16x16x32_bf16 v[168:171], a[152:155], v[236:239], v[168:171]
    ds_read_b64_tr_b16 a[184:185], v30 offset:20480
    ds_read_b64_tr_b16 a[186:187], v30 offset:22528
    v_mfma_f32_16x16x32_bf16 v[172:175], a[156:159], v[236:239], v[172:175]
    s_cbranch_vccnz SLOW7
BACK7:
    v_mfma_f32_16x16x32_bf16 v[164:167], a[156:159], v[232:235], v[164:167]
    s_lshl_b32 s62, s1, 7
    s_waitcnt lgkmcnt(6)
    buffer_load_dwordx4 a[32:35], v19, s[24:27], s62 offen offset:0 sc1
    v_mfma_f32_16x16x32_bf16 v[160:163], a[160:163], a[240:243], v[160:163]
    ds_read_b64_tr_b16 a[188:189], v31 offset:20480
    ds_read_b64_tr_b16 a[190:191], v31 offset:22528
    v_mfma_f32_16x16x32_bf16 v[168:171], a[160:163], a[244:247], v[168:171]
    buffer_load_dwordx4 a[36:39], v19, s[24:27], s62 offen offset:1024 sc1
    v_mfma_f32_16x16x32_bf16 v[172:175], a[164:167], a[244:247], v[172:175]
    s_add_u32 s62, s62, 8192
    v_mfma_f32_16x16x32_bf16 v[164:167], a[164:167], a[240:243], v[164:167]
    v_mfma_f32_16x16x32_bf16 v[160:163], a[168:171], a[248:251], v[160:163]
    buffer_load_dwordx4 a[40:43], v19, s[24:27], s62 offen offset:0 sc1
    v_mfma_f32_16x16x32_bf16 v[168:171], a[168:171], a[252:255], v[168:171]
    v_mfma_f32_16x16x32_bf16 v[172:175], a[172:175], a[252:255], v[172:175]
    buffer_load_dwordx4 a[44:47], v19, s[24:27], s62 offen offset:1024 sc1
    v_mfma_f32_16x16x32_bf16 v[164:167], a[172:175], a[248:251], v[164:167]
    s_waitcnt lgkmcnt(0)
    buffer_load_dwordx4 v[80:83], v19, s[24:27], s44 offen offset:0 sc1
    v_mfma_f32_16x16x32_bf16 v[160:163], a[176:179], v[240:243], v[160:163]
    v_mfma_f32_16x16x32_bf16 v[168:171], a[176:179], v[244:247], v[168:171]
    buffer_load_dwordx4 v[84:87], v19, s[24:27], s44 offen offset:1024 sc1
    v_mfma_f32_16x16x32_bf16 v[172:175], a[180:183], v[244:247], v[172:175]
    buffer_load_dwordx4 v[88:91], v19, s[24:27], s45 offen offset:0 sc1
    v_mfma_f32_16x16x32_bf16 v[164:167], a[180:183], v[240:243], v[164:167]
    v_mfma_f32_16x16x32_bf16 v[160:163], a[184:187], a[0:3], v[160:163]
    buffer_load_dwordx4 v[92:95], v19, s[24:27], s45 offen offset:1024 sc1
    v_mfma_f32_16x16x32_bf16 v[168:171], a[184:187], a[4:7], v[168:171]
    v_mfma_f32_16x16x32_bf16 v[172:175], a[188:191], a[4:7], v[172:175]
    buffer_load_dwordx4 v[96:99], v19, s[24:27], s46 offen offset:0 sc1
    v_mfma_f32_16x16x32_bf16 v[164:167], a[188:191], a[0:3], v[164:167]
    s_waitcnt vmcnt(11)
    buffer_load_dwordx4 v[100:103], v19, s[24:27], s46 offen offset:1024 sc1
    v_mfma_f32_16x16x32_bf16 v[160:163], v[6:9], a[16:19], v[160:163]
    v_mfma_f32_16x16x32_bf16 v[164:167], v[4:7], a[16:19], v[164:167]
    v_mfma_f32_16x16x32_bf16 v[168:171], v[6:9], a[20:23], v[168:171]
    v_mfma_f32_16x16x32_bf16 v[172:175], v[4:7], a[20:23], v[172:175]
    v_mfma_f32_16x16x32_bf16 v[160:163], v[6:9], a[24:27], v[160:163]
    v_mfma_f32_16x16x32_bf16 v[164:167], v[4:7], a[24:27], v[164:167]
    v_mfma_f32_16x16x32_bf16 v[168:171], v[6:9], a[28:31], v[168:171]
    v_mfma_f32_16x16x32_bf16 v[172:175], v[4:7], a[28:31], v[172:175]
    s_waitcnt vmcnt(10)
    v_mfma_f32_16x16x32_bf16 v[48:51], v[10:13], a[48:51], 0
    v_mfma_f32_16x16x32_bf16 v[48:51], v[10:13], a[52:55], v[48:51]
    s_waitcnt vmcnt(6)
    v_mfma_f32_16x16x32_bf16 v[160:163], v[6:9], a[32:35], v[160:163]
    v_mfma_f32_16x16x32_bf16 v[164:167], v[4:7], a[32:35], v[164:167]
    v_mfma_f32_16x16x32_bf16 v[168:171], v[6:9], a[36:39], v[168:171]
    v_mfma_f32_16x16x32_bf16 v[172:175], v[4:7], a[36:39], v[172:175]
    v_mfma_f32_16x16x32_bf16 v[160:163], v[6:9], a[40:43], v[160:163]
    s_nop 1
    v_fma_f32 v50, v50, v3, v16
    v_mfma_f32_16x16x32_bf16 v[164:167], v[4:7], a[40:43], v[164:167]
    v_fma_f32 v51, v51, v3, v17
    v_mfma_f32_16x16x32_bf16 v[168:171], v[6:9], a[44:47], v[168:171]
    v_fma_f32 v48, v48, v3, v14
    v_fma_f32 v49, v49, v3, v15
    v_mfma_f32_16x16x32_bf16 v[172:175], v[4:7], a[44:47], v[172:175]
    s_waitcnt vmcnt(2)
    v_max3_u32 v104, v80, v81, v82
    v_max3_u32 v106, v86, v87, v88
    v_max3_u32 v107, v89, v90, v91
    v_max3_u32 v104, v104, v92, v93
    v_max3_u32 v105, v83, v84, v85
    v_max3_u32 v105, v105, v94, v95
    v_max3_u32 v104, v104, v105, v106
    v_max_u32 v104, v104, v107
    v_cmp_eq_u32 vcc, -1, v104
    v_cvt_pk_bf16_f32 v48, v48, v49
    v_cvt_pk_bf16_f32 v49, v50, v51
    buffer_store_dwordx2 v[48:49], v2, s[20:23], 0 offen
    s_cbranch_vccnz SLOW8
BACK8:
    v_mfma_f32_16x16x32_bf16 v[160:163], v[6:9], v[80:83], v[160:163]
    v_mfma_f32_16x16x32_bf16 v[164:167], v[4:7], v[80:83], v[164:167]
    v_mfma_f32_16x16x32_bf16 v[168:171], v[6:9], v[84:87], v[168:171]
    v_mfma_f32_16x16x32_bf16 v[172:175], v[4:7], v[84:87], v[172:175]
    v_mfma_f32_16x16x32_bf16 v[160:163], v[6:9], v[88:91], v[160:163]
    v_mfma_f32_16x16x32_bf16 v[164:167], v[4:7], v[88:91], v[164:167]
    v_mfma_f32_16x16x32_bf16 v[168:171], v[6:9], v[92:95], v[168:171]
    v_mfma_f32_16x16x32_bf16 v[172:175], v[4:7], v[92:95], v[172:175]
    s_waitcnt vmcnt(1)
    v_max3_u32 v104, v96, v97, v98
    v_max3_u32 v105, v99, v100, v101
    v_max3_u32 v104, v104, v102, v103
    v_max_u32 v104, v104, v105
    v_cmp_eq_u32 vcc, -1, v104
    s_cbranch_vccnz SLOW9
BACK9:
    v_mfma_f32_16x16x32_bf16 v[160:163], v[6:9], v[96:99], v[160:163]
    v_mfma_f32_16x16x32_bf16 v[164:167], v[4:7], v[96:99], v[164:167]
    s_nop 6
    v_fma_f32 v161, v161, v36, v65
    v_mfma_f32_16x16x32_bf16 v[168:171], v[6:9], v[100:103], v[168:171]
    v_fma_f32 v160, v160, v36, v64
    v_fma_f32 v163, v163, v36, v67
    v_fma_f32 v162, v162, v36, v66
    v_cvt_pk_bf16_f32 v160, v160, v161
    v_mfma_f32_16x16x32_bf16 v[172:175], v[4:7], v[100:103], v[172:175]
    v_fma_f32 v164, v164, v36, v68
    v_fma_f32 v165, v165, v36, v69
    v_cvt_pk_bf16_f32 v161, v162, v163
    v_fma_f32 v167, v167, v36, v71
    v_fma_f32 v166, v166, v36, v70
    v_fma_f32 v168, v168, v37, v72
    v_fma_f32 v171, v171, v37, v75
    v_cvt_pk_bf16_f32 v162, v164, v165
    v_fma_f32 v169, v169, v37, v73
    v_cvt_pk_bf16_f32 v168, v168, v169
    v_fma_f32 v174, v174, v37, v78
    v_fma_f32 v175, v175, v37, v79
    v_fma_f32 v170, v170, v37, v74
    v_fma_f32 v172, v172, v37, v76
    v_fma_f32 v173, v173, v37, v77
    v_cvt_pk_bf16_f32 v169, v170, v171
    v_cvt_pk_bf16_f32 v163, v166, v167
    v_cvt_pk_bf16_f32 v170, v172, v173
    v_cvt_pk_bf16_f32 v171, v174, v175
    v_permlane16_swap_b32 v160, v162
    v_permlane16_swap_b32 v161, v163
    v_permlane16_swap_b32 v169, v171
    v_permlane16_swap_b32 v168, v170
    buffer_store_dwordx4 v[160:163], v47, s[20:23], 0 offen offset:0
    buffer_store_dwordx4 v[168:171], v47, s[20:23], s83 offen offset:2048
    s_endpgm
PATHB:
    global_load_dword v248, v215, s[32:33]
    global_load_dword v249, v215, s[34:35]
    global_load_dword v250, v215, s[36:37]
    global_load_dword v251, v215, s[38:39]
    global_load_dword v252, v215, s[40:41]
    global_load_dword v253, v215, s[42:43]
    global_load_ushort v254, v216, s[44:45]
    global_load_ushort v255, v216, s[46:47]
    s_cmp_lt_u32 s75, 8
    s_cselect_b32 s36, 0, 64
    s_load_dwordx16 s[16:31], s[0:1], 8
    s_mul_i32 s55, s79, 101376
    s_mul_i32 s56, s51, 1152
    v_mul_u32_u24 v218, 9216, v1
    v_mul_u32_u24 v217, 47, v1
    v_lshrrev_b32 v217, 9, v217
    v_cmp_gt_u32 vcc, 44, v1
    s_mov_b32 s57, -100736
    s_add_u32 s55, s55, s56
    v_mad_i32_i24 v219, v217, s57, v218
    v_lshrrev_b32 v217, 1, v217
    s_movk_i32 s57, -1152
    v_mad_i32_i24 v219, v217, s57, v219
    v_mov_b32 v217, 0x40000000
    v_add_u32 v219, s55, v219
    s_sub_u32 s57, s79, 32
    v_cndmask_b32 v0, v217, v219, vcc
    s_mul_i32 s55, s57, 221184
    buffer_load_dword v46, v0, s[8:11], 0 offen
    buffer_load_dword v46, v0, s[12:15], 0 offen
    v_cmp_gt_u32 vcc, 24, v1
    s_cmp_lt_u32 s75, 8
    s_cselect_b32 s56, 0x40000000, s56
    s_mov_b32 s33, 0x40000000
    s_add_u32 s55, s55, s56
    s_add_u32 s55, s55, 256
    v_add_u32 v219, s55, v218
    s_mul_i32 s55, s57, 73728
    s_add_u32 s55, s55, s56
    v_add_u32 v217, 4294746752, v219
    v_cndmask_b32 v219, v217, v219, vcc
    s_sub_u32 s55, s55, 441984
    v_cmp_gt_u32 vcc, 56, v1
    v_add_u32 v218, s55, v218
    v_add_u32 v217, 4294894208, v218
    v_cndmask_b32 v218, v217, v218, vcc
    s_lshl3_add_u32 s55, s75, s51
    s_lshl2_add_u32 s55, s55, s50
    v_min_u32 v217, 41, v1
    v_cmp_gt_u32 vcc, 48, v1
    s_mul_i32 s55, s55, 5376
    v_lshl_add_u32 v217, v217, 7, s55
    s_lshl_b32 s56, s78, 6
    s_add_u32 s56, s56, 0x2d60000
    buffer_load_dword v46, v217, s[4:7], 0 offen
    s_cmp_lt_u32 s75, 14
    v_cndmask_b32 v235, v218, v219, vcc
    s_cselect_b32 s32, s56, 0x40000000
    s_lshl_b32 s56, s76, 6
    s_add_u32 s56, s56, 0x2d40000
    s_cmp_lt_u32 s2, 144
    s_mov_b32 s82, 12288
    s_movk_i32 s57, 544
    v_and_b32 v209, 3, v1
    v_lshrrev_b32 v210, 2, v1
    s_mul_i32 s55, s50, 6144
    s_mov_b32 s43, s77
    s_cselect_b32 s42, s56, 0x40000000
    s_add_u32 s55, s55, 0x12000
    s_add_u32 s56, s63, 12384
    v_lshl_add_u32 v109, v1, 3, s56
    v_and_b32 v211, 15, v1
    s_sub_u32 s56, s56, 5984
    v_lshl_add_u32 v108, v1, 3, s55
    v_mov_b32 v217, s55
    v_and_b32 v208, 3, v210
    v_cmp_gt_u32 vcc, 11, v211
    v_lshlrev_b32 v212, 3, v209
    s_mov_b32 s81, 8192
    v_mov_b32 v218, s56
    v_cndmask_b32 v217, v218, v217, vcc
    v_lshl_add_u32 v217, v206, 4, v217
    v_mad_u32_u24 v110, v211, s57, v217
    v_lshrrev_b32 v217, 1, v211
    v_xor_b32 v217, v206, v217
    v_lshlrev_b32 v217, 4, v217
    v_lshl_add_u32 v217, v211, 7, v217
    v_add_u32 v232, s63, v217
    v_xor_b32 v218, 64, v217
    s_lshl_b32 s56, s53, 6
    s_mov_b32 s68, 0xbfb8aa3b
    s_mov_b32 s83, 16384
    v_add_u32 v233, s63, v218
    v_lshl_add_u32 v217, v206, 3, v208
    v_lshl_add_u32 v218, v217, 7, v212
    s_mov_b32 s80, 4096
    v_lshrrev_b32 v219, 1, v208
    v_lshl_add_u32 v219, v207, 1, v219
    v_xor_b32 v198, 0, v219
    v_lshl_add_u32 v8, v198, 5, v218
    v_xor_b32 v198, 1, v219
    v_lshl_add_u32 v9, v198, 5, v218
    v_xor_b32 v198, 2, v219
    s_mul_i32 s55, s51, 1152
    v_lshl_add_u32 v10, v198, 5, v218
    v_xor_b32 v198, 3, v219
    v_lshl_add_u32 v11, v198, 5, v218
    s_add_u32 s56, s56, s55
    v_xor_b32 v198, 0, v207
    s_mul_i32 s55, s50, 48
    v_add_u32 v12, 0xc000, v8
    v_add_u32 v14, 0xc000, v10
    s_add_u32 s59, s56, 512
    v_add_u32 v15, 0xc000, v11
    v_lshl_add_u32 v218, v217, 6, v212
    v_lshl_add_u32 v16, v198, 5, v218
    v_xor_b32 v198, 1, v207
    s_movk_i32 s57, 9216
    v_add_u32 v18, 0xc000, v16
    v_lshrrev_b32 v219, 5, v1
    v_lshlrev_b32 v219, 1, v219
    v_add_u32 v13, 0xc000, v9
    v_lshl_add_u32 v17, v198, 5, v218
    v_add_u32 v218, s55, v210
    v_mul_lo_u32 v218, v218, s57
    s_lshr_b32 s55, s76, 4
    s_and_b32 s57, s76, 15
    v_xor_b32 v219, v209, v219
    s_lshl_b32 s100, s55, 7
    s_mul_i32 s56, s57, 147456
    v_and_b32 v198, 1, v209
    s_add_u32 s56, s56, s100
    v_lshl_add_u32 v5, v219, 4, v218
    s_cmp_lt_u32 s2, 144
    v_add_u32 v19, 0xc000, v17
    s_cselect_b32 s3, s56, 0x40000000
    s_lshl_b32 s56, s43, 6
    s_add_u32 s56, s56, 0x2d44000
    s_cmp_lt_u32 s2, 144
    v_add_u32 v7, 0x47800, v5
    s_cselect_b32 s41, s56, 0x40000000
    s_lshl2_add_u32 s57, s57, s50
    s_lshl_b32 s56, s55, 12
    s_mul_i32 s57, s57, 36864
    s_sub_u32 s56, s56, s57
    v_add_u32 v6, 0x23c00, v5
    s_add_u32 s56, s56, 0x2cb7030
    s_cmp_lt_u32 s2, 144
    v_lshlrev_b32 v218, 4, v206
    s_cselect_b32 s56, s56, 0x40000000
    v_sub_u32 v218, s56, v218
    v_lshl_add_u32 v47, v211, 6, v218
    v_lshlrev_b32 v218, 3, v206
    v_sub_u32 v218, v218, v208
    v_lshl_add_u32 v198, v198, 3, s63
    v_add_u32 v199, 7, v218
    v_bfe_u32 v200, v199, 1, 3
    v_lshl_add_u32 v199, v199, 7, v198
    v_lshrrev_b32 v219, 1, v209
    v_xor_b32 v200, v219, v200
    v_lshlrev_b32 v200, 4, v200
    v_xor_b32 v201, 0, v200
    v_add_u32 v220, v201, v199
    v_xor_b32 v201, 32, v200
    v_add_u32 v222, v201, v199
    v_xor_b32 v201, 64, v200
    v_add_u32 v224, v201, v199
    v_xor_b32 v201, 96, v200
    v_add_u32 v226, v201, v199
    s_lshr_b32 s55, s43, 6
    v_add_u32 v199, 3, v218
    v_bfe_u32 v200, v199, 1, 3
    v_xor_b32 v200, v219, v200
    v_lshl_add_u32 v199, v199, 7, v198
    v_lshlrev_b32 v200, 4, v200
    s_mov_b32 s57, 36864
    v_xor_b32 v201, 0, v200
    s_lshl_b32 s55, s55, 12
    s_add_u32 s55, s55, 0x2d44000
    v_add_u32 v221, v201, v199
    v_xor_b32 v201, 32, v200
    v_add_u32 v223, v201, v199
    v_lshl_add_u32 v246, v1, 6, s55
    s_lshl_b32 s55, s43, 6
    v_xor_b32 v201, 64, v200
    s_mul_i32 s100, s78, 5120
    s_add_u32 s55, s55, 0x2a80000
    v_lshl_add_u32 v218, v209, 4, s55
    s_add_u32 s100, s100, 0x2e00000
    v_add_u32 v225, v201, v199
    v_xor_b32 v201, 96, v200
    v_add_u32 v227, v201, v199
    v_mad_u32_u24 v247, v210, s57, v218
    s_movk_i32 s57, 1152
    v_lshlrev_b32 v218, 1, v206
    v_xor_b32 v218, v205, v218
    v_lshlrev_b32 v218, 4, v218
    v_mad_u32_u24 v20, v204, s57, v218
    v_lshlrev_b32 v218, 1, v207
    v_xor_b32 v218, v209, v218
    v_lshlrev_b32 v218, 4, v218
    v_add_u32 v23, 24576, v20
    s_andn2_b32 s55, 1, s51
    v_mad_u32_u24 v24, v210, s57, v218
    v_add_u32 v25, 17408, v24
    v_lshlrev_b32 v203, 4, v206
    s_lshl_b32 s55, s55, 1
    v_add_u32 v26, 34816, v24
    v_bfe_u32 v219, v1, 3, 2
    v_xor_b32 v219, s55, v219
    v_xor_b32 v198, 0, v219
    v_add_u32 v27, 52224, v24
    v_lshl_add_u32 v218, v210, 7, v212
    v_lshl_add_u32 v28, v198, 5, v218
    v_xor_b32 v198, 1, v219
    v_lshl_add_u32 v29, v198, 5, v218
    v_xor_b32 v198, 2, v219
    v_lshl_add_u32 v30, v198, 5, v218
    v_xor_b32 v198, 3, v219
    v_add_u32 v33, 0xc000, v29
    v_add_u32 v32, 0xc000, v28
    v_add_u32 v21, 8192, v20
    v_add_u32 v22, 16384, v20
    v_lshl_add_u32 v31, v198, 5, v218
    v_xor_b32 v198, 0, v207
    v_lshl_add_u32 v218, v210, 6, v212
    v_lshl_add_u32 v36, v198, 5, v218
    v_xor_b32 v198, 1, v207
    v_add_u32 v35, 0xc000, v31
    s_mul_i32 s55, s51, 663552
    s_mul_i32 s57, s53, 640
    s_mul_i32 s56, s53, 368640
    v_add_u32 v34, 0xc000, v30
    s_add_u32 s55, s55, s57
    v_add_u32 v38, 0xc000, v36
    s_add_u32 s44, s55, s56
    s_sub_u32 s45, s55, s56
    s_add_u32 s45, s45, 368640
    s_mul_i32 s56, s53, 36864
    v_lshl_add_u32 v37, v198, 5, v218
    s_add_u32 s55, s55, 294912
    s_add_u32 s46, s55, s56
    s_sub_u32 s47, s55, s56
    s_mul_i32 s56, s50, 18432
    s_add_u32 s47, s47, 36864
    s_mul_i32 s55, s50, 36864
    s_add_u32 s57, s56, 147456
    s_add_u32 s64, s44, s55
    s_add_u32 s65, s44, s57
    s_add_u32 s66, s45, s55
    v_add_u32 v39, 0xc000, v37
    s_add_u32 s67, s45, s57
    s_sub_u32 s79, s45, 73728
    s_sub_u32 s76, s47, 36864
    s_cmp_lt_u32 s50, 2
    s_mul_i32 s57, s53, 576
    s_cselect_b32 s79, s44, s79
    s_cselect_b32 s76, s46, s76
    s_add_u32 s79, s79, s55
    s_add_u32 s69, s79, 221184
    s_add_u32 s70, s76, s56
    s_sub_u32 s57, 512, s57
    s_mul_i32 s56, s2, 73728
    s_mul_i32 s76, s50, 6144
    s_add_u32 s72, s69, s57
    s_add_u32 s73, s70, s57
    s_mul_i32 s55, s50, 110592
    s_sub_u32 s79, s45, 221184
    s_cmp_lt_u32 s50, 2
    s_cselect_b32 s79, s44, s79
    s_add_u32 s79, s79, s55
    s_add_u32 s71, s79, s57
    s_lshl_b32 s74, s50, 12
    s_lshl_b32 s77, s50, 11
    s_add_u32 s75, s77, 16384
    s_lshl_b32 s78, s50, 10
    s_mul_i32 s55, s50, 18432
    s_add_u32 s78, s78, 8192
    s_add_u32 s56, s56, s55
    v_lshl_add_u32 v40, v1, 4, s56
    s_xor_b32 s57, s2, 8
    s_mul_i32 s56, s57, 73728
    s_add_u32 s56, s56, s55
    s_lshl2_add_u32 s57, s57, s50
    s_lshl_b32 s57, s57, 6
    v_mov_b32 v218, 0x40000000
    s_add_u32 s39, s57, 0x2d00000
    s_lshl2_add_u32 s57, s2, s50
    v_lshl_add_u32 v41, v1, 4, s56
    s_lshl_b32 s57, s57, 6
    s_add_u32 s38, s57, 0x2d00000
    s_lshl_b32 s55, s52, 8
    s_lshl2_add_u32 s56, s51, s50
    s_add_u32 s55, s55, s56
    s_lshl_b32 s55, s55, 11
    s_add_u32 s55, s55, 0x1400000
    v_lshl_add_u32 v44, v1, 4, s55
    v_cmp_gt_u32 vcc, 16, v1
    s_lshl2_add_u32 s55, s52, s50
    s_lshl4_add_u32 s55, s55, s51
    s_mov_b32 s57, 73728
    s_lshl_b32 s55, s55, 6
    s_add_u32 s40, s55, 0x2d20000
    v_lshlrev_b32 v219, 2, v1
    s_lshl_b32 s55, s43, 7
    v_cndmask_b32 v42, v218, v219, vcc
    s_add_u32 s55, s55, 0x2800000
    v_lshrrev_b32 v219, 5, v1
    s_cmp_lt_u32 s2, 144
    s_cselect_b32 s55, s55, 0x40000000
    v_lshl_add_u32 v219, v219, 4, s55
    s_lshl_b32 s55, s43, 6
    s_add_u32 s44, s55, 0x2d60000
    v_bfe_u32 v218, v1, 2, 3
    s_mul_i32 s55, s43, 5120
    s_add_u32 s55, s55, 0x2e00000
    v_lshl_add_u32 v219, v209, 5, v219
    s_mov_b32 s46, s100
    s_cmp_lt_u32 s2, 144
    v_mad_u32_u24 v45, v218, s57, v219
    s_cselect_b32 s45, s55, 0x40000000
    s_waitcnt lgkmcnt(0)
    s_waitcnt vmcnt(3)
    v_lshlrev_b32 v112, 16, v248
    v_and_b32 v113, 0xffff0000, v248
    v_lshlrev_b32 v114, 16, v249
    v_and_b32 v115, 0xffff0000, v249
    v_lshlrev_b32 v255, 16, v255
    v_lshlrev_b32 v116, 16, v250
    v_lshlrev_b32 v254, 16, v254
    v_and_b32 v117, 0xffff0000, v250
    v_lshlrev_b32 v118, 16, v251
    v_mul_f32 v254, 0x3fb8aa3b, v254
    v_exp_f32 v254, v254
    v_and_b32 v123, 0xffff0000, v253
    v_lshlrev_b32 v122, 16, v253
    v_and_b32 v119, 0xffff0000, v251
    v_cvt_pk_bf16_f32 v254, v254, v254
    v_lshlrev_b32 v120, 16, v252
    v_and_b32 v121, 0xffff0000, v252
    v_lshlrev_b32 v128, 16, v254
    v_lshlrev_b32 v129, 16, v254
    v_pk_mul_f32 v[124:125], v[112:113], v[128:129]
    v_pk_mul_f32 v[126:127], v[114:115], v[128:129]
    v_pk_mul_f32 v[118:119], v[118:119], v[128:129]
    v_pk_mul_f32 v[140:141], v[120:121], v[118:119]
    v_pk_mul_f32 v[116:117], v[116:117], v[128:129]
    v_pk_mul_f32 v[138:139], v[122:123], v[118:119]
    v_mul_f32 v132, 0xbfa2f983, v126
    v_mul_f32 v136, 0x41a2f983, v126
    v_mul_f32 v130, 0x4138aa3b, v124
    v_mul_f32 v133, 0xbfa2f983, v127
    v_fract_f32 v133, v133
    v_mul_f32 v134, 0x4338aa3b, v124
    v_fract_f32 v136, v136
    v_mul_f32 v137, 0x41a2f983, v127
    v_pk_fma_f32 v[84:85], v[120:121], v[116:117], v[138:139] neg_lo:[0,0,1] neg_hi:[0,0,1]
    v_fract_f32 v132, v132
    v_sin_f32 v82, v136
    v_mul_f32 v131, 0x4138aa3b, v125
    v_sin_f32 v79, v133
    v_pk_fma_f32 v[86:87], v[122:123], v[116:117], v[140:141]
    v_cos_f32 v77, v133
    v_exp_f32 v131, v131
    v_cos_f32 v76, v132
    v_exp_f32 v130, v130
    v_exp_f32 v134, v134
    v_sin_f32 v78, v132
    v_mul_f32 v135, 0x4338aa3b, v125
    v_fract_f32 v137, v137
    v_mul_f32 v133, 0x4322f983, v127
    v_pk_mul_f32 v[86:87], v[86:87], -1.0 op_sel_hi:[1,0]
    v_mul_f32 v132, 0x4322f983, v126
    v_pk_mul_f32 v[76:77], v[76:77], v[130:131]
    v_exp_f32 v135, v135
    v_cos_f32 v81, v137
    v_fract_f32 v133, v133
    v_sin_f32 v83, v137
    v_fract_f32 v132, v132
    v_cos_f32 v80, v136
    v_sin_f32 v94, v132
    v_pk_mul_f32 v[78:79], v[78:79], v[130:131]
    v_pk_mul_f32 v[82:83], v[82:83], v[134:135]
    buffer_load_dword v46, v235, s[8:11], 0 offen
    v_mul_f32 v131, 0x44b8aa3b, v125
    v_mul_f32 v137, 0x3e22f983, v127
    v_fract_f32 v137, v137
    v_pk_mul_f32 v[80:81], v[80:81], v[134:135]
    v_mul_f32 v136, 0x3e22f983, v126
    v_mul_f32 v130, 0x44b8aa3b, v124
    v_cos_f32 v92, v132
    v_exp_f32 v131, v131
    v_cos_f32 v93, v133
    v_fract_f32 v136, v136
    v_mul_f32 v134, 0x3fb8aa3b, v124
    v_cos_f32 v48, v136
    v_sin_f32 v95, v133
    v_cvt_pk_bf16_f32 v142, v84, v86
    v_exp_f32 v130, v130
    v_exp_f32 v134, v134
    v_mul_f32 v135, 0x3fb8aa3b, v125
    v_cos_f32 v49, v137
    v_pk_mul_f32 v[92:93], v[92:93], v[130:131]
    v_sin_f32 v50, v136
    v_sin_f32 v51, v137
    v_exp_f32 v135, v135
    v_pk_mul_f32 v[94:95], v[94:95], v[130:131]
    v_pk_mul_f32 v[48:49], v[48:49], v[134:135]
    v_pk_mul_f32 v[130:131], v[86:87], v[78:79]
    v_cvt_pk_bf16_f32 v148, v92, v94
    v_pk_fma_f32 v[88:89], v[84:85], v[76:77], v[130:131] neg_lo:[0,0,1] neg_hi:[0,0,1]
    v_pk_mul_f32 v[132:133], v[84:85], v[78:79]
    v_pk_fma_f32 v[90:91], v[86:87], v[76:77], v[132:133]
    v_pk_mul_f32 v[50:51], v[50:51], v[134:135]
    v_cvt_pk_bf16_f32 v143, v85, v87
    v_cvt_pk_bf16_f32 v149, v93, v95
    v_pk_mul_f32 v[134:135], v[94:95], v[82:83]
    v_pk_fma_f32 v[96:97], v[92:93], v[80:81], v[134:135] neg_lo:[0,0,1] neg_hi:[0,0,1]
    v_pk_mul_f32 v[138:139], v[50:51], v[50:51]
    v_pk_mul_f32 v[140:141], v[48:49], v[50:51]
    v_cvt_pk_bf16_f32 v145, v89, v91
    v_cvt_pk_bf16_f32 v144, v88, v90
    v_pk_mul_f32 v[136:137], v[92:93], v[82:83]
    v_pk_mul_f32 v[130:131], v[90:91], v[78:79]
    ds_write_b64 v108, v[142:143] offset:0
    ds_write_b64 v108, v[144:145] offset:544
    v_pk_fma_f32 v[98:99], v[94:95], v[80:81], v[136:137]
    v_cvt_pk_bf16_f32 v150, v96, v98
    v_pk_mul_f32 v[134:135], v[98:99], v[82:83]
    v_pk_fma_f32 v[84:85], v[88:89], v[76:77], v[130:131] neg_lo:[0,0,1] neg_hi:[0,0,1]
    v_cvt_pk_bf16_f32 v151, v97, v99
    v_pk_mul_f32 v[132:133], v[88:89], v[78:79]
    v_pk_fma_f32 v[86:87], v[90:91], v[76:77], v[132:133]
    v_cvt_pk_bf16_f32 v143, v85, v87
    v_pk_fma_f32 v[54:55], v[50:51], v[48:49], v[140:141]
    v_pk_mul_f32 v[132:133], v[84:85], v[78:79]
    v_pk_mul_f32 v[130:131], v[86:87], v[78:79]
    v_pk_mul_f32 v[136:137], v[96:97], v[82:83]
    v_pk_fma_f32 v[90:91], v[86:87], v[76:77], v[132:133]
    v_pk_fma_f32 v[88:89], v[84:85], v[76:77], v[130:131] neg_lo:[0,0,1] neg_hi:[0,0,1]
    v_pk_fma_f32 v[52:53], v[48:49], v[48:49], v[138:139] neg_lo:[0,0,1] neg_hi:[0,0,1]
    v_pk_fma_f32 v[94:95], v[98:99], v[80:81], v[136:137]
    v_pk_mul_f32 v[130:131], v[90:91], v[78:79]
    v_cvt_pk_bf16_f32 v145, v89, v91
    v_cvt_pk_bf16_f32 v142, v84, v86
    v_pk_fma_f32 v[84:85], v[88:89], v[76:77], v[130:131] neg_lo:[0,0,1] neg_hi:[0,0,1]
    v_pk_mul_f32 v[138:139], v[54:55], v[50:51]
    v_pk_mul_f32 v[140:141], v[52:53], v[50:51]
    v_cvt_pk_bf16_f32 v144, v88, v90
    ds_write_b64 v108, v[142:143] offset:1088
    ds_write_b64 v108, v[144:145] offset:1632
    v_pk_mul_f32 v[132:133], v[88:89], v[78:79]
    v_pk_fma_f32 v[92:93], v[96:97], v[80:81], v[134:135] neg_lo:[0,0,1] neg_hi:[0,0,1]
    v_pk_fma_f32 v[86:87], v[90:91], v[76:77], v[132:133]
    v_pk_mul_f32 v[134:135], v[94:95], v[82:83]
    v_pk_mul_f32 v[132:133], v[84:85], v[78:79]
    v_pk_mul_f32 v[130:131], v[86:87], v[78:79]
    v_pk_fma_f32 v[96:97], v[92:93], v[80:81], v[134:135] neg_lo:[0,0,1] neg_hi:[0,0,1]
    v_pk_mul_f32 v[136:137], v[92:93], v[82:83]
    v_cvt_pk_bf16_f32 v152, v92, v94
    v_pk_fma_f32 v[88:89], v[84:85], v[76:77], v[130:131] neg_lo:[0,0,1] neg_hi:[0,0,1]
    v_cvt_pk_bf16_f32 v143, v85, v87
    v_pk_fma_f32 v[56:57], v[52:53], v[48:49], v[138:139] neg_lo:[0,0,1] neg_hi:[0,0,1]
    v_pk_fma_f32 v[90:91], v[86:87], v[76:77], v[132:133]
    v_pk_fma_f32 v[58:59], v[54:55], v[48:49], v[140:141]
    v_cvt_pk_bf16_f32 v142, v84, v86
    v_cvt_pk_bf16_f32 v153, v93, v95
    v_cvt_pk_bf16_f32 v145, v89, v91
    v_pk_fma_f32 v[98:99], v[94:95], v[80:81], v[136:137]
    v_pk_mul_f32 v[134:135], v[98:99], v[82:83]
    v_pk_fma_f32 v[92:93], v[96:97], v[80:81], v[134:135] neg_lo:[0,0,1] neg_hi:[0,0,1]
    v_cvt_pk_bf16_f32 v144, v88, v90
    v_pk_mul_f32 v[132:133], v[88:89], v[78:79]
    v_pk_mul_f32 v[136:137], v[96:97], v[82:83]
    v_pk_fma_f32 v[86:87], v[90:91], v[76:77], v[132:133]
    v_pk_mul_f32 v[130:131], v[90:91], v[78:79]
    ds_write_b64 v108, v[142:143] offset:2176
    ds_write_b64 v108, v[144:145] offset:2720
    v_pk_fma_f32 v[84:85], v[88:89], v[76:77], v[130:131] neg_lo:[0,0,1] neg_hi:[0,0,1]
    v_pk_mul_f32 v[132:133], v[84:85], v[78:79]
    v_pk_mul_f32 v[138:139], v[54:55], v[54:55]
    v_pk_mul_f32 v[130:131], v[86:87], v[78:79]
    v_pk_mul_f32 v[140:141], v[52:53], v[54:55]
    v_cvt_pk_bf16_f32 v155, v97, v99
    v_pk_fma_f32 v[94:95], v[98:99], v[80:81], v[136:137]
    v_pk_fma_f32 v[88:89], v[84:85], v[76:77], v[130:131] neg_lo:[0,0,1] neg_hi:[0,0,1]
    v_cvt_pk_bf16_f32 v154, v96, v98
    v_pk_mul_f32 v[136:137], v[92:93], v[82:83]
    v_pk_fma_f32 v[62:63], v[54:55], v[52:53], v[140:141]
    v_pk_mul_f32 v[134:135], v[94:95], v[82:83]
    v_pk_fma_f32 v[90:91], v[86:87], v[76:77], v[132:133]
    v_pk_fma_f32 v[60:61], v[52:53], v[52:53], v[138:139] neg_lo:[0,0,1] neg_hi:[0,0,1]
    v_cvt_pk_bf16_f32 v142, v84, v86
    v_cvt_pk_bf16_f32 v145, v89, v91
    v_cvt_pk_bf16_f32 v144, v88, v90
    v_cvt_pk_bf16_f32 v143, v85, v87
    ds_write_b64 v108, v[142:143] offset:3264
    ds_write_b64 v108, v[144:145] offset:3808
    v_pk_mul_f32 v[130:131], v[90:91], v[78:79]
    v_pk_mul_f32 v[132:133], v[88:89], v[78:79]
    v_pk_fma_f32 v[84:85], v[88:89], v[76:77], v[130:131] neg_lo:[0,0,1] neg_hi:[0,0,1]
    v_pk_fma_f32 v[86:87], v[90:91], v[76:77], v[132:133]
    v_pk_mul_f32 v[130:131], v[86:87], v[78:79]
    v_cvt_pk_bf16_f32 v142, v84, v86
    v_pk_mul_f32 v[140:141], v[60:61], v[50:51]
    v_pk_mul_f32 v[132:133], v[84:85], v[78:79]
    v_pk_fma_f32 v[90:91], v[86:87], v[76:77], v[132:133]
    v_pk_fma_f32 v[98:99], v[94:95], v[80:81], v[136:137]
    v_pk_fma_f32 v[88:89], v[84:85], v[76:77], v[130:131] neg_lo:[0,0,1] neg_hi:[0,0,1]
    v_pk_mul_f32 v[132:133], v[88:89], v[78:79]
    v_cvt_pk_bf16_f32 v157, v93, v95
    v_pk_fma_f32 v[96:97], v[92:93], v[80:81], v[134:135] neg_lo:[0,0,1] neg_hi:[0,0,1]
    v_cvt_pk_bf16_f32 v145, v89, v91
    v_cvt_pk_bf16_f32 v143, v85, v87
    v_pk_mul_f32 v[138:139], v[62:63], v[50:51]
    v_cvt_pk_bf16_f32 v144, v88, v90
    ds_write_b64 v108, v[142:143] offset:4352
    ds_write_b64 v108, v[144:145] offset:4896
    v_pk_mul_f32 v[130:131], v[90:91], v[78:79]
    v_pk_mul_f32 v[134:135], v[98:99], v[82:83]
    v_cvt_pk_bf16_f32 v156, v92, v94
    v_pk_fma_f32 v[92:93], v[96:97], v[80:81], v[134:135] neg_lo:[0,0,1] neg_hi:[0,0,1]
    v_pk_mul_f32 v[136:137], v[96:97], v[82:83]
    v_pk_fma_f32 v[84:85], v[88:89], v[76:77], v[130:131] neg_lo:[0,0,1] neg_hi:[0,0,1]
    v_pk_fma_f32 v[86:87], v[90:91], v[76:77], v[132:133]
    v_pk_fma_f32 v[66:67], v[62:63], v[48:49], v[140:141]
    v_pk_fma_f32 v[64:65], v[60:61], v[48:49], v[138:139] neg_lo:[0,0,1] neg_hi:[0,0,1]
    v_pk_mul_f32 v[132:133], v[84:85], v[78:79]
    v_pk_mul_f32 v[130:131], v[86:87], v[78:79]
    v_pk_fma_f32 v[90:91], v[86:87], v[76:77], v[132:133]
    v_pk_fma_f32 v[88:89], v[84:85], v[76:77], v[130:131] neg_lo:[0,0,1] neg_hi:[0,0,1]
    v_cvt_pk_bf16_f32 v158, v96, v98
    v_cvt_pk_bf16_f32 v142, v84, v86
    v_cvt_pk_bf16_f32 v159, v97, v99
    v_cvt_pk_bf16_f32 v143, v85, v87
    v_pk_mul_f32 v[140:141], v[60:61], v[54:55]
    v_pk_fma_f32 v[94:95], v[98:99], v[80:81], v[136:137]
    v_cvt_pk_bf16_f32 v161, v93, v95
    v_pk_mul_f32 v[136:137], v[92:93], v[82:83]
    v_cvt_pk_bf16_f32 v145, v89, v91
    v_cvt_pk_bf16_f32 v144, v88, v90
    v_pk_mul_f32 v[130:131], v[90:91], v[78:79]
    v_pk_mul_f32 v[138:139], v[62:63], v[54:55]
    v_pk_fma_f32 v[84:85], v[88:89], v[76:77], v[130:131] neg_lo:[0,0,1] neg_hi:[0,0,1]
    v_pk_fma_f32 v[68:69], v[60:61], v[52:53], v[138:139] neg_lo:[0,0,1] neg_hi:[0,0,1]
    ds_write_b64 v108, v[142:143] offset:5440
    buffer_load_dword v46, v235, s[12:15], 0 offen
    ds_write_b64 v109, v[144:145] offset:0
    v_cvt_pk_bf16_f32 v160, v92, v94
    v_pk_fma_f32 v[70:71], v[62:63], v[52:53], v[140:141]
    v_pk_mul_f32 v[132:133], v[88:89], v[78:79]
    v_pk_fma_f32 v[86:87], v[90:91], v[76:77], v[132:133]
    v_cvt_pk_bf16_f32 v143, v85, v87
    v_pk_mul_f32 v[130:131], v[86:87], v[78:79]
    v_pk_mul_f32 v[138:139], v[62:63], v[58:59]
    v_pk_fma_f32 v[88:89], v[84:85], v[76:77], v[130:131] neg_lo:[0,0,1] neg_hi:[0,0,1]
    v_pk_mul_f32 v[134:135], v[94:95], v[82:83]
    v_pk_fma_f32 v[96:97], v[92:93], v[80:81], v[134:135] neg_lo:[0,0,1] neg_hi:[0,0,1]
    v_pk_mul_f32 v[140:141], v[60:61], v[58:59]
    v_pk_mul_f32 v[132:133], v[84:85], v[78:79]
    v_pk_fma_f32 v[90:91], v[86:87], v[76:77], v[132:133]
    v_cvt_pk_bf16_f32 v144, v88, v90
    v_cvt_pk_bf16_f32 v145, v89, v91
    v_pk_fma_f32 v[98:99], v[94:95], v[80:81], v[136:137]
    v_pk_mul_f32 v[130:131], v[90:91], v[78:79]
    v_pk_fma_f32 v[74:75], v[62:63], v[56:57], v[140:141]
    v_cvt_pk_bf16_f32 v162, v96, v98
    v_cvt_pk_bf16_f32 v142, v84, v86
    v_pk_mul_f32 v[136:137], v[96:97], v[82:83]
    v_pk_mul_f32 v[134:135], v[98:99], v[82:83]
    v_pk_fma_f32 v[94:95], v[98:99], v[80:81], v[136:137]
    v_pk_fma_f32 v[92:93], v[96:97], v[80:81], v[134:135] neg_lo:[0,0,1] neg_hi:[0,0,1]
    ds_write_b64 v109, v[142:143] offset:544
    ds_write_b64 v109, v[144:145] offset:1088
    v_pk_fma_f32 v[84:85], v[88:89], v[76:77], v[130:131] neg_lo:[0,0,1] neg_hi:[0,0,1]
    v_pk_mul_f32 v[132:133], v[88:89], v[78:79]
    v_pk_fma_f32 v[86:87], v[90:91], v[76:77], v[132:133]
    v_pk_mul_f32 v[132:133], v[84:85], v[78:79]
    v_pk_mul_f32 v[130:131], v[86:87], v[78:79]
    v_cvt_pk_bf16_f32 v165, v93, v95
    v_cvt_pk_bf16_f32 v142, v84, v86
    v_pk_fma_f32 v[90:91], v[86:87], v[76:77], v[132:133]
    v_cvt_pk_bf16_f32 v143, v85, v87
    v_pk_fma_f32 v[88:89], v[84:85], v[76:77], v[130:131] neg_lo:[0,0,1] neg_hi:[0,0,1]
    v_pk_fma_f32 v[72:73], v[60:61], v[56:57], v[138:139] neg_lo:[0,0,1] neg_hi:[0,0,1]
    v_cvt_pk_bf16_f32 v164, v92, v94
    v_cvt_pk_bf16_f32 v163, v97, v99
    v_cvt_pk_bf16_f32 v144, v88, v90
    v_cvt_pk_bf16_f32 v145, v89, v91
    ds_write_b64 v109, v[142:143] offset:1632
    ds_write_b64 v109, v[144:145] offset:2176
    ds_read_b128 a[192:195], v110 offset:0
    ds_read_b128 a[196:199], v110 offset:64
    ds_read_b128 a[200:203], v110 offset:128
    ds_read_b128 a[204:207], v110 offset:192
    ds_read_b128 a[208:211], v110 offset:256
    ds_read_b128 a[212:215], v110 offset:320
    ds_read_b128 a[216:219], v110 offset:384
    ds_read_b128 a[220:223], v110 offset:448
    ds_write_b64 v108, v[148:149] offset:0
    ds_write_b64 v108, v[150:151] offset:544
    ds_write_b64 v108, v[152:153] offset:1088
    ds_write_b64 v108, v[154:155] offset:1632
    ds_write_b64 v108, v[156:157] offset:2176
    ds_write_b64 v108, v[158:159] offset:2720
    ds_write_b64 v108, v[160:161] offset:3264
    ds_write_b64 v108, v[162:163] offset:3808
    ds_write_b64 v108, v[164:165] offset:4352
    ds_read_b128 a[224:227], v110 offset:0
    ds_read_b128 a[228:231], v110 offset:64
    ds_read_b128 a[232:235], v110 offset:128
    ds_read_b128 a[236:239], v110 offset:192
    ds_read_b128 a[240:243], v110 offset:256
    ds_read_b128 a[244:247], v110 offset:320
    ds_read_b128 a[248:251], v110 offset:384
    ds_read_b128 a[252:255], v110 offset:448
    v_pk_mul_f32 v[136:137], v[80:81], v[82:83]
    v_pk_fma_f32 v[94:95], v[82:83], v[80:81], v[136:137]
    v_pk_mul_f32 v[134:135], v[82:83], v[82:83]
    v_mov_b32 v147, 0x3f80
    v_mov_b32 v146, 0x3f80
    v_pk_fma_f32 v[92:93], v[80:81], v[80:81], v[134:135] neg_lo:[0,0,1] neg_hi:[0,0,1]
    v_pk_mul_f32 v[138:139], v[94:95], v[54:55]
    v_cvt_pk_bf16_f32 v167, v93, v95
    v_cvt_pk_bf16_f32 v145, v53, v55
    v_pk_fma_f32 v[84:85], v[92:93], v[52:53], v[138:139] neg_lo:[0,0,1] neg_hi:[0,0,1]
    v_cvt_pk_bf16_f32 v166, v92, v94
    v_pk_mul_f32 v[138:139], v[94:95], v[62:63]
    v_cvt_pk_bf16_f32 v142, v48, v50
    v_cvt_pk_bf16_f32 v143, v49, v51
    v_cvt_pk_bf16_f32 v144, v52, v54
    ds_write_b64 v108, v[146:147] offset:0
    ds_write_b64 v108, v[142:143] offset:544
    ds_write_b64 v108, v[144:145] offset:1088
    v_cvt_pk_bf16_f32 v143, v57, v59
    v_cvt_pk_bf16_f32 v142, v56, v58
    v_pk_mul_f32 v[140:141], v[92:93], v[54:55]
    v_pk_fma_f32 v[86:87], v[94:95], v[52:53], v[140:141]
    v_cvt_pk_bf16_f32 v168, v84, v86
    v_cvt_pk_bf16_f32 v169, v85, v87
    s_waitcnt lgkmcnt(7)
    v_pk_mul_f32 v[140:141], v[92:93], v[62:63]
    v_pk_fma_f32 v[90:91], v[94:95], v[60:61], v[140:141]
    v_pk_fma_f32 v[88:89], v[92:93], v[60:61], v[138:139] neg_lo:[0,0,1] neg_hi:[0,0,1]
    v_cvt_pk_bf16_f32 v145, v61, v63
    v_mfma_f32_16x16x32_bf16 v[242:245], a[224:227], a[192:195], 0
    ds_write_b64 v108, v[142:143] offset:1632
    v_cvt_pk_bf16_f32 v144, v60, v62
    v_mfma_f32_16x16x32_bf16 v[242:245], a[228:231], a[196:199], v[242:245]
    s_lshl2_add_u32 s55, s51, s52
    v_cvt_pk_bf16_f32 v142, v64, v66
    s_sub_u32 s55, s55, 18
    v_mfma_f32_16x16x32_bf16 v[242:245], a[232:235], a[200:203], v[242:245]
    s_and_b32 s56, s51, 1
    ds_write_b64 v108, v[144:145] offset:2176
    s_lshl_b32 s56, s56, 6
    v_cvt_pk_bf16_f32 v171, v89, v91
    v_cvt_pk_bf16_f32 v170, v88, v90
    v_pk_mul_f32 v[138:139], v[94:95], v[70:71]
    v_pk_fma_f32 v[84:85], v[92:93], v[68:69], v[138:139] neg_lo:[0,0,1] neg_hi:[0,0,1]
    s_or_b32 s55, s55, s56
    v_mfma_f32_16x16x32_bf16 v[242:245], a[236:239], a[204:207], v[242:245]
    s_or_b32 s34, s55, s36
    v_cvt_pk_bf16_f32 v143, v65, v67
    s_min_u32 s55, s34, 31
    s_lshl2_add_u32 s55, s55, s50
    ds_write_b64 v108, v[142:143] offset:2720
    v_cvt_pk_bf16_f32 v144, v68, v70
    v_pk_mul_f32 v[140:141], v[92:93], v[70:71]
    v_pk_fma_f32 v[86:87], v[94:95], v[68:69], v[140:141]
    v_cvt_pk_bf16_f32 v172, v84, v86
    s_waitcnt lgkmcnt(6)
    v_pk_mul_f32 v[134:135], v[94:95], v[82:83]
    v_cvt_pk_bf16_f32 v145, v69, v71
    v_mfma_f32_16x16x32_bf16 v[242:245], a[240:243], a[208:211], v[242:245]
    s_add_u32 s55, s55, 448
    ds_write_b64 v108, v[144:145] offset:3264
    s_lshl_b32 s56, s55, 8
    v_lshl_add_u32 v215, v1, 2, s56
    v_cvt_pk_bf16_f32 v142, v72, v74
    s_lshl_b32 s56, s55, 1
    v_mov_b32 v216, s56
    v_cvt_pk_bf16_f32 v144, v80, v82
    v_cvt_pk_bf16_f32 v143, v73, v75
    v_pk_mul_f32 v[136:137], v[92:93], v[82:83]
    v_pk_fma_f32 v[98:99], v[94:95], v[80:81], v[136:137]
    v_pk_fma_f32 v[96:97], v[92:93], v[80:81], v[134:135] neg_lo:[0,0,1] neg_hi:[0,0,1]
    v_cvt_pk_bf16_f32 v173, v85, v87
    v_mfma_f32_16x16x32_bf16 v[242:245], a[244:247], a[212:215], v[242:245]
    global_load_dword a144, v215, s[16:17]
    global_load_dword a145, v215, s[18:19]
    ds_write_b64 v108, v[142:143] offset:3808
    v_cvt_pk_bf16_f32 v175, v97, v99
    v_cvt_pk_bf16_f32 v174, v96, v98
    v_mfma_f32_16x16x32_bf16 v[242:245], a[248:251], a[216:219], v[242:245]
    global_load_dword a146, v215, s[20:21]
    global_load_dword a147, v215, s[22:23]
    global_load_dword a148, v215, s[24:25]
    v_pk_mul_f32 v[140:141], v[96:97], v[54:55]
    v_pk_mul_f32 v[138:139], v[98:99], v[54:55]
    v_pk_fma_f32 v[88:89], v[96:97], v[52:53], v[138:139] neg_lo:[0,0,1] neg_hi:[0,0,1]
    v_pk_fma_f32 v[90:91], v[98:99], v[52:53], v[140:141]
    v_cvt_pk_bf16_f32 v145, v81, v83
    v_mfma_f32_16x16x32_bf16 v[242:245], a[252:255], a[220:223], v[242:245]
    global_load_dword a149, v215, s[26:27]
    global_load_ushort a150, v216, s[28:29]
    global_load_ushort a151, v216, s[30:31]
    ds_write_b64 v108, v[144:145] offset:4352
    v_pk_mul_f32 v[130:131], v[50:51], v[82:83]
    s_load_dwordx2 s[16:17], s[0:1], 96
    v_cvt_pk_bf16_f32 v176, v88, v90
    v_pk_mul_f32 v[132:133], v[48:49], v[82:83]
    s_load_dwordx2 s[20:21], s[0:1], 112
    v_cvt_pk_bf16_f32 v177, v89, v91
    v_pk_fma_f32 v[104:105], v[48:49], v[80:81], v[130:131] neg_lo:[0,0,1] neg_hi:[0,0,1]
    s_load_dwordx2 s[28:29], s[0:1], 120
    v_pk_mul_f32 v[138:139], v[98:99], v[62:63]
    s_load_dwordx2 s[24:25], s[0:1], 128
    v_pk_fma_f32 v[106:107], v[50:51], v[80:81], v[132:133]
    s_mul_i32 s56, s55, 5120
    v_pk_fma_f32 v[84:85], v[96:97], v[60:61], v[138:139] neg_lo:[0,0,1] neg_hi:[0,0,1]
    v_pk_mul_f32 v[130:131], v[54:55], v[82:83]
    v_pk_mul_f32 v[132:133], v[52:53], v[82:83]
    v_pk_mul_f32 v[138:139], v[98:99], v[70:71]
    v_pk_mul_f32 v[140:141], v[96:97], v[62:63]
    v_cvt_pk_bf16_f32 v143, v105, v107
    v_pk_fma_f32 v[102:103], v[54:55], v[80:81], v[132:133]
    v_pk_mul_f32 v[134:135], v[98:99], v[82:83]
    v_cvt_pk_bf16_f32 v142, v104, v106
    v_pk_fma_f32 v[86:87], v[98:99], v[60:61], v[140:141]
    s_add_u32 s35, s56, 0x2e00000
    s_lshl_b32 s56, s55, 6
    ds_write_b64 v108, v[142:143] offset:4896
    s_mov_b32 s31, 0x20000
    s_mov_b32 s26, 0x3100000
    v_pk_fma_f32 v[92:93], v[96:97], v[80:81], v[134:135] neg_lo:[0,0,1] neg_hi:[0,0,1]
    s_mov_b32 s19, 0x20000
    v_cvt_pk_bf16_f32 v178, v84, v86
    s_mov_b32 s18, 0x510000
    s_add_u32 s56, s56, 0x2d60000
    v_cvt_pk_bf16_f32 v179, v85, v87
    v_pk_mul_f32 v[140:141], v[96:97], v[70:71]
    v_pk_fma_f32 v[90:91], v[98:99], v[68:69], v[140:141]
    s_cmp_lt_u32 s34, 32
    v_pk_fma_f32 v[100:101], v[52:53], v[80:81], v[130:131] neg_lo:[0,0,1] neg_hi:[0,0,1]
    s_cselect_b32 s33, s56, 0x40000000
    v_pk_fma_f32 v[88:89], v[96:97], v[68:69], v[138:139] neg_lo:[0,0,1] neg_hi:[0,0,1]
    v_pk_mul_f32 v[130:131], v[58:59], v[82:83]
    v_pk_mul_f32 v[140:141], v[92:93], v[62:63]
    v_pk_mul_f32 v[136:137], v[96:97], v[82:83]
    v_cvt_pk_bf16_f32 v145, v101, v103
    v_cvt_pk_bf16_f32 v180, v88, v90
    v_pk_mul_f32 v[132:133], v[56:57], v[82:83]
    v_cvt_pk_bf16_f32 v144, v100, v102
    s_mov_b32 s23, 0x20000
    s_mov_b32 s22, 0x240000
    ds_write_b64 v108, v[144:145] offset:5440
    v_pk_fma_f32 v[104:105], v[56:57], v[80:81], v[130:131] neg_lo:[0,0,1] neg_hi:[0,0,1]
    v_cvt_pk_bf16_f32 v181, v89, v91
    v_pk_mul_f32 v[130:131], v[62:63], v[82:83]
    v_pk_fma_f32 v[106:107], v[58:59], v[80:81], v[132:133]
    v_pk_fma_f32 v[94:95], v[98:99], v[80:81], v[136:137]
    v_pk_mul_f32 v[132:133], v[60:61], v[82:83]
    v_cvt_pk_bf16_f32 v183, v93, v95
    s_mov_b32 s27, 0x20000
    s_mov_b32 s30, 0x100
    v_pk_mul_f32 v[138:139], v[94:95], v[62:63]
    v_pk_fma_f32 v[86:87], v[94:95], v[60:61], v[140:141]
    v_cvt_pk_bf16_f32 v142, v104, v106
    v_cvt_pk_bf16_f32 v143, v105, v107
    v_pk_mul_f32 v[134:135], v[94:95], v[82:83]
    v_pk_fma_f32 v[84:85], v[92:93], v[60:61], v[138:139] neg_lo:[0,0,1] neg_hi:[0,0,1]
    v_pk_fma_f32 v[102:103], v[62:63], v[80:81], v[132:133]
    v_cvt_pk_bf16_f32 v185, v85, v87
    v_cvt_pk_bf16_f32 v182, v92, v94
    v_pk_mul_f32 v[136:137], v[92:93], v[82:83]
    v_pk_fma_f32 v[100:101], v[60:61], v[80:81], v[130:131] neg_lo:[0,0,1] neg_hi:[0,0,1]
    v_pk_fma_f32 v[98:99], v[94:95], v[80:81], v[136:137]
    v_pk_fma_f32 v[96:97], v[92:93], v[80:81], v[134:135] neg_lo:[0,0,1] neg_hi:[0,0,1]
    v_cvt_pk_bf16_f32 v144, v100, v102
    v_cvt_pk_bf16_f32 v145, v101, v103
    v_pk_mul_f32 v[138:139], v[98:99], v[62:63]
    v_cvt_pk_bf16_f32 v187, v97, v99
    v_pk_fma_f32 v[88:89], v[96:97], v[60:61], v[138:139] neg_lo:[0,0,1] neg_hi:[0,0,1]
    v_cvt_pk_bf16_f32 v184, v84, v86
    v_cvt_pk_bf16_f32 v186, v96, v98
    v_pk_mul_f32 v[130:131], v[66:67], v[82:83]
    v_pk_mul_f32 v[132:133], v[64:65], v[82:83]
    v_pk_mul_f32 v[136:137], v[96:97], v[82:83]
    v_pk_fma_f32 v[106:107], v[66:67], v[80:81], v[132:133]
    v_pk_fma_f32 v[104:105], v[64:65], v[80:81], v[130:131] neg_lo:[0,0,1] neg_hi:[0,0,1]
    v_pk_mul_f32 v[140:141], v[96:97], v[62:63]
    v_pk_fma_f32 v[90:91], v[98:99], v[60:61], v[140:141]
    v_pk_mul_f32 v[134:135], v[98:99], v[82:83]
    v_cvt_pk_bf16_f32 v189, v89, v91
    v_cvt_pk_bf16_f32 v188, v88, v90
    v_pk_fma_f32 v[94:95], v[98:99], v[80:81], v[136:137]
    v_pk_mul_f32 v[132:133], v[68:69], v[82:83]
    s_add_u32 m0, s63, 0x0
    ds_write_b64 v109, v[142:143] offset:0
    buffer_load_dwordx4 v228, s[4:7], s101 offen offset:0 lds
    ds_write_b64 v109, v[144:145] offset:544
    v_pk_fma_f32 v[92:93], v[96:97], v[80:81], v[134:135] neg_lo:[0,0,1] neg_hi:[0,0,1]
    v_pk_mul_f32 v[130:131], v[70:71], v[82:83]
    v_pk_mul_f32 v[134:135], v[94:95], v[82:83]
    v_cvt_pk_bf16_f32 v190, v92, v94
    v_pk_fma_f32 v[100:101], v[68:69], v[80:81], v[130:131] neg_lo:[0,0,1] neg_hi:[0,0,1]
    v_pk_mul_f32 v[140:141], v[92:93], v[62:63]
    v_pk_mul_f32 v[136:137], v[92:93], v[82:83]
    v_cvt_pk_bf16_f32 v142, v104, v106
    v_cvt_pk_bf16_f32 v143, v105, v107
    v_pk_fma_f32 v[102:103], v[70:71], v[80:81], v[132:133]
    v_pk_mul_f32 v[138:139], v[94:95], v[62:63]
    v_pk_fma_f32 v[86:87], v[94:95], v[60:61], v[140:141]
    v_cvt_pk_bf16_f32 v191, v93, v95
    v_pk_fma_f32 v[84:85], v[92:93], v[60:61], v[138:139] neg_lo:[0,0,1] neg_hi:[0,0,1]
    v_cvt_pk_bf16_f32 v144, v100, v102
    v_pk_fma_f32 v[96:97], v[92:93], v[80:81], v[134:135] neg_lo:[0,0,1] neg_hi:[0,0,1]
    v_pk_fma_f32 v[98:99], v[94:95], v[80:81], v[136:137]
    v_cvt_pk_bf16_f32 v193, v85, v87
    v_pk_mul_f32 v[130:131], v[74:75], v[82:83]
    v_cvt_pk_bf16_f32 v145, v101, v103
    v_pk_mul_f32 v[140:141], v[96:97], v[62:63]
    v_pk_mul_f32 v[138:139], v[98:99], v[62:63]
    ds_write_b64 v109, v[142:143] offset:1088
    buffer_load_dwordx4 v229, s[4:7], s101 offen offset:1024 lds
    ds_write_b64 v109, v[144:145] offset:1632
    v_pk_fma_f32 v[90:91], v[98:99], v[60:61], v[140:141]
    v_pk_fma_f32 v[104:105], v[72:73], v[80:81], v[130:131] neg_lo:[0,0,1] neg_hi:[0,0,1]
    v_pk_mul_f32 v[132:133], v[72:73], v[82:83]
    v_pk_fma_f32 v[106:107], v[74:75], v[80:81], v[132:133]
    v_cvt_pk_bf16_f32 v192, v84, v86
    v_pk_fma_f32 v[88:89], v[96:97], v[60:61], v[138:139] neg_lo:[0,0,1] neg_hi:[0,0,1]
    v_cvt_pk_bf16_f32 v195, v97, v99
    v_cvt_pk_bf16_f32 v143, v105, v107
    v_cvt_pk_bf16_f32 v196, v88, v90
    v_cvt_pk_bf16_f32 v142, v104, v106
    v_cvt_pk_bf16_f32 v194, v96, v98
    v_cvt_pk_bf16_f32 v197, v89, v91
    ds_write_b64 v109, v[142:143] offset:2176
    ds_read_b128 a[224:227], v110 offset:0
    ds_read_b128 a[228:231], v110 offset:64
    ds_read_b128 a[232:235], v110 offset:128
    ds_read_b128 a[236:239], v110 offset:192
    ds_read_b128 a[240:243], v110 offset:256
    buffer_load_dwordx4 v230, s[4:7], s101 offen offset:2048 lds
    ds_read_b128 a[244:247], v110 offset:320
    ds_read_b128 a[248:251], v110 offset:384
    ds_read_b128 a[252:255], v110 offset:448
    ds_write_b64 v108, v[166:167] offset:0
    ds_write_b64 v108, v[168:169] offset:544
    ds_write_b64 v108, v[170:171] offset:1088
    ds_write_b64 v108, v[172:173] offset:1632
    ds_write_b64 v108, v[174:175] offset:2176
    ds_write_b64 v108, v[176:177] offset:2720
    ds_write_b64 v108, v[178:179] offset:3264
    ds_write_b64 v108, v[180:181] offset:3808
    ds_write_b64 v108, v[182:183] offset:4352
    ds_write_b64 v108, v[184:185] offset:4896
    ds_write_b64 v108, v[186:187] offset:5440
    ds_write_b64 v109, v[188:189] offset:0
    ds_write_b64 v109, v[190:191] offset:544
    ds_write_b64 v109, v[192:193] offset:1088
    ds_write_b64 v109, v[194:195] offset:1632
    ds_write_b64 v109, v[196:197] offset:2176
    ds_read_b128 v[48:51], v110 offset:0
    ds_read_b128 v[52:55], v110 offset:64
    ds_read_b128 v[56:59], v110 offset:128
    ds_read_b128 v[60:63], v110 offset:192
    buffer_load_dwordx4 v231, s[4:7], s101 offen offset:3072 lds
    ds_read_b128 v[64:67], v110 offset:256
    ds_read_b128 v[68:71], v110 offset:320
    ds_read_b128 v[72:75], v110 offset:384
    ds_read_b128 v[76:79], v110 offset:448
    s_waitcnt lgkmcnt(0)
    v_mfma_f32_16x16x32_bf16 v[234:237], a[224:227], a[192:195], 0
    v_mfma_f32_16x16x32_bf16 v[234:237], a[228:231], a[196:199], v[234:237]
    v_mfma_f32_16x16x32_bf16 v[234:237], a[232:235], a[200:203], v[234:237]
    v_mfma_f32_16x16x32_bf16 v[234:237], a[236:239], a[204:207], v[234:237]
    v_mfma_f32_16x16x32_bf16 v[234:237], a[240:243], a[208:211], v[234:237]
    v_mfma_f32_16x16x32_bf16 v[234:237], a[244:247], a[212:215], v[234:237]
    v_mfma_f32_16x16x32_bf16 v[234:237], a[248:251], a[216:219], v[234:237]
    v_mfma_f32_16x16x32_bf16 v[234:237], a[252:255], a[220:223], v[234:237]
    v_mfma_f32_16x16x32_bf16 v[238:241], v[48:51], a[192:195], 0
    v_mfma_f32_16x16x32_bf16 v[238:241], v[52:55], a[196:199], v[238:241]
    v_mfma_f32_16x16x32_bf16 v[238:241], v[56:59], a[200:203], v[238:241]
    v_mfma_f32_16x16x32_bf16 v[238:241], v[60:63], a[204:207], v[238:241]
    v_mfma_f32_16x16x32_bf16 v[238:241], v[64:67], a[208:211], v[238:241]
    v_mfma_f32_16x16x32_bf16 v[238:241], v[68:71], a[212:215], v[238:241]
    v_mfma_f32_16x16x32_bf16 v[238:241], v[72:75], a[216:219], v[238:241]
    v_mfma_f32_16x16x32_bf16 v[238:241], v[76:79], a[220:223], v[238:241]
    s_mov_b64 exec, 1
    v_add_f32 v234, v234, v255
    s_mov_b64 exec, -1
    s_waitcnt lgkmcnt(0)
    s_mul_i32 s55, s50, 6144
    s_add_u32 s55, s55, 0x12000
    v_mov_b32 v84, 0
    v_and_b32 v81, 15, v1
    v_lshlrev_b32 v112, 4, v1
    v_mov_b32 v85, 0
    v_and_b32 v88, 1, v1
    v_mov_b32 v87, 0
    v_mov_b32 v86, 0
    v_lshl_add_u32 v80, v1, 4, s55
    ds_write_b128 v80, v[84:87] offset:0
    s_movk_i32 s57, 196
    ds_write_b128 v80, v[84:87] offset:1024
    s_add_u32 s56, s55, 3104
    ds_write_b128 v80, v[84:87] offset:2048
    v_lshrrev_b32 v83, 1, v81
    v_add_u32 v104, 1, v81
    v_lshrrev_b32 v104, 1, v104
    v_lshrrev_b32 v82, 4, v1
    v_lshrrev_b32 v103, 1, v82
    v_cvt_pk_bf16_f32 v90, v240, v241
    v_lshlrev_b32 v83, 2, v83
    v_cvt_pk_bf16_f32 v89, v238, v239
    v_lshl_add_u32 v83, v82, 6, v83
    v_mad_u32_u24 v83, v88, s57, v83
    v_cvt_pk_bf16_f32 v106, v244, v245
    v_sub_u32 v83, s56, v83
    s_add_u32 s56, s55, 2528
    v_lshlrev_b32 v104, 2, v104
    v_cvt_pk_bf16_f32 v101, v236, v237
    v_lshl_add_u32 v105, v88, 1, s56
    v_and_b32 v102, 1, v82
    v_lshl_add_u32 v91, v81, 4, s55
    v_lshl_add_u32 v104, v82, 7, v104
    v_sub_u32 v104, v105, v104
    v_lshl_add_u32 v102, v102, 3, v91
    v_lshl_add_u32 v102, v103, 8, v102
    v_lshl_add_u32 v91, v82, 8, v91
    v_cvt_pk_bf16_f32 v100, v234, v235
    v_cvt_pk_bf16_f32 v103, v235, v236
    v_cvt_pk_bf16_f32 v105, v242, v243
    v_cvt_pk_bf16_f32 v107, v242, v242
    s_mov_b32 exec_lo, 0
    ds_write_b32 v83, v90
    s_mov_b32 exec_hi, -2
    ds_write_b32 v83, v89 offset:32
    s_mov_b32 exec_hi, 1
    v_mov_b32 v240, v239
    v_mov_b32 v241, 0
    v_mov_b32 v239, v238
    s_mov_b32 exec_lo, -2
    ds_write_b16 v104, v105 offset:96
    s_mov_b32 exec_lo, -1
    v_cvt_pk_bf16_f32 v94, v240, v240
    v_cvt_pk_bf16_f32 v92, v238, v238
    v_cvt_pk_bf16_f32 v93, v239, v240
    v_cvt_pk_bf16_f32 v96, v238, v239
    v_cvt_pk_bf16_f32 v97, v240, v240
    v_cvt_pk_bf16_f32 v98, v240, v241
    ds_write_b16 v91, v92 offset:542
    ds_write_b96 v91, v[92:94] offset:544
    ds_write_b16_d16_hi v91, v98 offset:556
    ds_write_b32 v91, v92 offset:1724
    ds_write_b96 v91, v[96:98] offset:1728
    s_mov_b32 exec_hi, 0
    ds_write_b16_d16_hi v104, v105 offset:64
    ds_write_b16 v104, v106 offset:32
    ds_write_b16_d16_hi v104, v106
    s_mov_b32 exec_lo, 1
    ds_write_b16 v80, v107 offset:2880
    ds_write_b16 v80, v107 offset:1126
    ds_write_b16 v80, v107 offset:1128
    ds_write_b32 v80, v107 offset:2308
    s_mov_b64 exec, -1
    ds_write_b64 v102, v[100:101] offset:32
    ds_write_b16 v102, v100 offset:1214
    ds_write_b32 v102, v103 offset:1216
    ds_write_b16_d16_hi v102, v101 offset:1220
    ds_read_b128 v[48:51], v80 offset:0
    ds_read_b128 v[52:55], v80 offset:1024
    ds_read_b128 v[56:59], v80 offset:2048
    s_waitcnt lgkmcnt(2)
    buffer_store_dwordx4 v[48:51], v112, s[24:27], s46 offen offset:0 sc1
    s_waitcnt lgkmcnt(1)
    buffer_store_dwordx4 v[52:55], v112, s[24:27], s46 offen offset:1024 sc1
    s_waitcnt lgkmcnt(0)
    buffer_store_dwordx4 v[56:59], v112, s[24:27], s46 offen offset:2048 sc1
    s_cmp_ge_u32 s34, 32
    s_cbranch_scc1 PATHB1
    s_waitcnt vmcnt(7)
    v_accvgpr_read_b32 v248, a144
    v_accvgpr_read_b32 v254, a150
    v_accvgpr_read_b32 v253, a149
    v_accvgpr_read_b32 v250, a146
    v_accvgpr_read_b32 v251, a147
    v_accvgpr_read_b32 v252, a148
    v_accvgpr_read_b32 v255, a151
    v_accvgpr_read_b32 v249, a145
    v_lshlrev_b32 v112, 16, v248
    v_lshlrev_b32 v254, 16, v254
    v_and_b32 v113, 0xffff0000, v248
    v_mul_f32 v254, 0x3fb8aa3b, v254
    v_lshlrev_b32 v122, 16, v253
    v_and_b32 v123, 0xffff0000, v253
    v_exp_f32 v254, v254
    v_lshlrev_b32 v116, 16, v250
    v_and_b32 v117, 0xffff0000, v250
    v_lshlrev_b32 v118, 16, v251
    v_cvt_pk_bf16_f32 v254, v254, v254
    v_and_b32 v119, 0xffff0000, v251
    v_lshlrev_b32 v255, 16, v255
    v_lshlrev_b32 v120, 16, v252
    v_and_b32 v121, 0xffff0000, v252
    v_lshlrev_b32 v128, 16, v254
    v_lshlrev_b32 v114, 16, v249
    v_and_b32 v115, 0xffff0000, v249
    s_add_u32 m0, s63, 0xf80
    s_nop 0
    buffer_load_dwordx4 v228, s[4:7], s101 offen offset:128 lds
    buffer_load_dwordx4 v229, s[4:7], s101 offen offset:1152 lds
    v_lshlrev_b32 v129, 16, v254
    v_pk_mul_f32 v[118:119], v[118:119], v[128:129]
    v_pk_mul_f32 v[138:139], v[122:123], v[118:119]
    v_pk_mul_f32 v[140:141], v[120:121], v[118:119]
    v_pk_mul_f32 v[116:117], v[116:117], v[128:129]
    v_pk_mul_f32 v[124:125], v[112:113], v[128:129]
    v_pk_fma_f32 v[86:87], v[122:123], v[116:117], v[140:141]
    v_mul_f32 v130, 0x4138aa3b, v124
    v_pk_mul_f32 v[126:127], v[114:115], v[128:129]
    v_mul_f32 v132, 0xbfa2f983, v126
    v_mul_f32 v131, 0x4138aa3b, v125
    s_add_u32 s60, s58, 0x0
    buffer_load_dwordx4 v230, s[4:7], s101 offen offset:2176 lds
    buffer_load_dwordx4 v231, s[4:7], s101 offen offset:3200 lds
    v_fract_f32 v132, v132
    v_mul_f32 v133, 0xbfa2f983, v127
    v_mul_f32 v134, 0x4338aa3b, v124
    v_pk_mul_f32 v[86:87], v[86:87], -1.0 op_sel_hi:[1,0]
    v_pk_fma_f32 v[84:85], v[120:121], v[116:117], v[138:139] neg_lo:[0,0,1] neg_hi:[0,0,1]
    v_fract_f32 v133, v133
    v_exp_f32 v131, v131
    v_sin_f32 v78, v132
    v_exp_f32 v130, v130
    v_exp_f32 v134, v134
    v_mul_f32 v136, 0x41a2f983, v126
    v_cos_f32 v76, v132
    v_fract_f32 v136, v136
    v_mul_f32 v137, 0x41a2f983, v127
    v_mul_f32 v135, 0x4338aa3b, v125
    v_sin_f32 v82, v136
    v_cos_f32 v77, v133
    v_fract_f32 v137, v137
    v_exp_f32 v135, v135
    v_sin_f32 v79, v133
    v_pk_mul_f32 v[76:77], v[76:77], v[130:131]
    v_pk_mul_f32 v[78:79], v[78:79], v[130:131]
    v_mul_f32 v130, 0x44b8aa3b, v124
    v_mul_f32 v131, 0x44b8aa3b, v125
    v_cos_f32 v80, v136
    v_sin_f32 v83, v137
    v_mul_f32 v132, 0x4322f983, v126
    v_cos_f32 v81, v137
    v_mul_f32 v133, 0x4322f983, v127
    v_exp_f32 v130, v130
    v_pk_mul_f32 v[80:81], v[80:81], v[134:135]
    s_add_u32 m0, s61, 0x0
    s_nop 0
    buffer_load_dwordx4 v2, s[8:11], s60 offen offset:0 lds
    buffer_load_dwordx4 v3, s[8:11], s60 offen offset:1024 lds
    v_pk_mul_f32 v[82:83], v[82:83], v[134:135]
    v_exp_f32 v131, v131
    v_fract_f32 v133, v133
    v_fract_f32 v132, v132
    v_cos_f32 v92, v132
    v_sin_f32 v95, v133
    v_cos_f32 v93, v133
    v_mul_f32 v135, 0x3fb8aa3b, v125
    v_pk_mul_f32 v[92:93], v[92:93], v[130:131]
    v_sin_f32 v94, v132
    v_mul_f32 v134, 0x3fb8aa3b, v124
    v_mul_f32 v137, 0x3e22f983, v127
    v_cvt_pk_bf16_f32 v142, v84, v86
    v_mul_f32 v136, 0x3e22f983, v126
    v_pk_mul_f32 v[94:95], v[94:95], v[130:131]
    v_fract_f32 v137, v137
    v_pk_mul_f32 v[130:131], v[86:87], v[78:79]
    v_fract_f32 v136, v136
    v_sin_f32 v50, v136
    v_exp_f32 v135, v135
    buffer_load_dwordx4 v4, s[8:11], s60 offen offset:2048 lds
    v_cos_f32 v49, v137
    v_cos_f32 v48, v136
    v_pk_mul_f32 v[132:133], v[84:85], v[78:79]
    v_exp_f32 v134, v134
    v_cvt_pk_bf16_f32 v143, v85, v87
    v_sin_f32 v51, v137
    v_cvt_pk_bf16_f32 v149, v93, v95
    v_pk_fma_f32 v[88:89], v[84:85], v[76:77], v[130:131] neg_lo:[0,0,1] neg_hi:[0,0,1]
    v_pk_fma_f32 v[90:91], v[86:87], v[76:77], v[132:133]
    v_pk_mul_f32 v[48:49], v[48:49], v[134:135]
    v_pk_mul_f32 v[50:51], v[50:51], v[134:135]
    v_pk_mul_f32 v[134:135], v[94:95], v[82:83]
    s_add_u32 m0, s61, 0x3000
    ds_write_b64 v108, v[142:143] offset:0
    buffer_load_dwordx4 v2, s[12:15], s60 offen offset:0 lds
    v_pk_mul_f32 v[140:141], v[48:49], v[50:51]
    v_cvt_pk_bf16_f32 v144, v88, v90
    v_pk_fma_f32 v[54:55], v[50:51], v[48:49], v[140:141]
    v_pk_mul_f32 v[138:139], v[50:51], v[50:51]
    v_cvt_pk_bf16_f32 v145, v89, v91
    v_pk_mul_f32 v[130:131], v[90:91], v[78:79]
    v_pk_fma_f32 v[96:97], v[92:93], v[80:81], v[134:135] neg_lo:[0,0,1] neg_hi:[0,0,1]
    v_cvt_pk_bf16_f32 v148, v92, v94
    ds_write_b64 v108, v[144:145] offset:544
    buffer_load_dwordx4 v3, s[12:15], s60 offen offset:1024 lds
    v_pk_mul_f32 v[136:137], v[92:93], v[82:83]
    v_pk_mul_f32 v[132:133], v[88:89], v[78:79]
    v_pk_fma_f32 v[98:99], v[94:95], v[80:81], v[136:137]
    v_pk_fma_f32 v[84:85], v[88:89], v[76:77], v[130:131] neg_lo:[0,0,1] neg_hi:[0,0,1]
    v_pk_mul_f32 v[136:137], v[96:97], v[82:83]
    v_pk_fma_f32 v[52:53], v[48:49], v[48:49], v[138:139] neg_lo:[0,0,1] neg_hi:[0,0,1]
    v_pk_fma_f32 v[86:87], v[90:91], v[76:77], v[132:133]
    v_pk_mul_f32 v[134:135], v[98:99], v[82:83]
    v_pk_mul_f32 v[132:133], v[84:85], v[78:79]
    v_cvt_pk_bf16_f32 v143, v85, v87
    v_pk_mul_f32 v[138:139], v[54:55], v[50:51]
    v_cvt_pk_bf16_f32 v142, v84, v86
    buffer_load_dwordx4 v4, s[12:15], s60 offen offset:2048 lds
    ds_write_b64 v108, v[142:143] offset:1088
    v_cvt_pk_bf16_f32 v151, v97, v99
    v_pk_fma_f32 v[90:91], v[86:87], v[76:77], v[132:133]
    v_pk_mul_f32 v[140:141], v[52:53], v[50:51]
    v_pk_fma_f32 v[92:93], v[96:97], v[80:81], v[134:135] neg_lo:[0,0,1] neg_hi:[0,0,1]
    v_pk_mul_f32 v[130:131], v[86:87], v[78:79]
    v_pk_fma_f32 v[88:89], v[84:85], v[76:77], v[130:131] neg_lo:[0,0,1] neg_hi:[0,0,1]
    v_cvt_pk_bf16_f32 v145, v89, v91
    v_cvt_pk_bf16_f32 v150, v96, v98
    v_pk_fma_f32 v[58:59], v[54:55], v[48:49], v[140:141]
    v_pk_fma_f32 v[94:95], v[98:99], v[80:81], v[136:137]
    v_cvt_pk_bf16_f32 v144, v88, v90
    v_pk_mul_f32 v[130:131], v[90:91], v[78:79]
    v_pk_mul_f32 v[136:137], v[92:93], v[82:83]
    s_add_u32 m0, s63, 0x1f00
    ds_write_b64 v108, v[144:145] offset:1632
    buffer_load_dwordx4 v228, s[4:7], s101 offen offset:256 lds
    v_pk_fma_f32 v[84:85], v[88:89], v[76:77], v[130:131] neg_lo:[0,0,1] neg_hi:[0,0,1]
    v_cvt_pk_bf16_f32 v152, v92, v94
    v_pk_mul_f32 v[132:133], v[88:89], v[78:79]
    v_pk_fma_f32 v[86:87], v[90:91], v[76:77], v[132:133]
    v_cvt_pk_bf16_f32 v153, v93, v95
    v_pk_mul_f32 v[132:133], v[84:85], v[78:79]
    v_cvt_pk_bf16_f32 v142, v84, v86
    v_cvt_pk_bf16_f32 v143, v85, v87
    buffer_load_dwordx4 v229, s[4:7], s101 offen offset:1280 lds
    buffer_load_dwordx4 v230, s[4:7], s101 offen offset:2304 lds
    ds_write_b64 v108, v[142:143] offset:2176
    v_pk_mul_f32 v[134:135], v[94:95], v[82:83]
    v_pk_mul_f32 v[130:131], v[86:87], v[78:79]
    v_pk_fma_f32 v[98:99], v[94:95], v[80:81], v[136:137]
    v_pk_fma_f32 v[88:89], v[84:85], v[76:77], v[130:131] neg_lo:[0,0,1] neg_hi:[0,0,1]
    v_pk_fma_f32 v[90:91], v[86:87], v[76:77], v[132:133]
    v_cvt_pk_bf16_f32 v145, v89, v91
    v_cvt_pk_bf16_f32 v144, v88, v90
    v_pk_fma_f32 v[56:57], v[52:53], v[48:49], v[138:139] neg_lo:[0,0,1] neg_hi:[0,0,1]
    v_pk_mul_f32 v[132:133], v[88:89], v[78:79]
    v_pk_fma_f32 v[96:97], v[92:93], v[80:81], v[134:135] neg_lo:[0,0,1] neg_hi:[0,0,1]
    v_pk_mul_f32 v[130:131], v[90:91], v[78:79]
    v_cvt_pk_bf16_f32 v154, v96, v98
    s_add_u32 s60, s58, 0xd8000
    ds_write_b64 v108, v[144:145] offset:2720
    buffer_load_dwordx4 v231, s[4:7], s101 offen offset:3328 lds
    v_pk_mul_f32 v[136:137], v[96:97], v[82:83]
    v_pk_fma_f32 v[86:87], v[90:91], v[76:77], v[132:133]
    v_pk_mul_f32 v[134:135], v[98:99], v[82:83]
    v_pk_fma_f32 v[84:85], v[88:89], v[76:77], v[130:131] neg_lo:[0,0,1] neg_hi:[0,0,1]
    v_pk_mul_f32 v[132:133], v[84:85], v[78:79]
    v_pk_mul_f32 v[130:131], v[86:87], v[78:79]
    v_cvt_pk_bf16_f32 v143, v85, v87
    v_cvt_pk_bf16_f32 v142, v84, v86
    v_pk_fma_f32 v[94:95], v[98:99], v[80:81], v[136:137]
    v_pk_mul_f32 v[140:141], v[52:53], v[54:55]
    v_pk_fma_f32 v[88:89], v[84:85], v[76:77], v[130:131] neg_lo:[0,0,1] neg_hi:[0,0,1]
    v_pk_fma_f32 v[90:91], v[86:87], v[76:77], v[132:133]
    v_pk_mul_f32 v[138:139], v[54:55], v[54:55]
    v_pk_fma_f32 v[92:93], v[96:97], v[80:81], v[134:135] neg_lo:[0,0,1] neg_hi:[0,0,1]
    v_cvt_pk_bf16_f32 v155, v97, v99
    v_cvt_pk_bf16_f32 v145, v89, v91
    v_pk_fma_f32 v[60:61], v[52:53], v[52:53], v[138:139] neg_lo:[0,0,1] neg_hi:[0,0,1]
    v_cvt_pk_bf16_f32 v156, v92, v94
    v_pk_mul_f32 v[132:133], v[88:89], v[78:79]
    v_cvt_pk_bf16_f32 v144, v88, v90
    v_pk_mul_f32 v[130:131], v[90:91], v[78:79]
    v_pk_fma_f32 v[62:63], v[54:55], v[52:53], v[140:141]
    v_cvt_pk_bf16_f32 v157, v93, v95
    v_pk_fma_f32 v[86:87], v[90:91], v[76:77], v[132:133]
    s_add_u32 m0, s61, 0x6000
    ds_write_b64 v108, v[142:143] offset:3264
    buffer_load_dwordx4 v2, s[8:11], s60 offen offset:0 lds
    ds_write_b64 v108, v[144:145] offset:3808
    v_pk_mul_f32 v[134:135], v[94:95], v[82:83]
    v_pk_fma_f32 v[84:85], v[88:89], v[76:77], v[130:131] neg_lo:[0,0,1] neg_hi:[0,0,1]
    v_cvt_pk_bf16_f32 v143, v85, v87
    v_cvt_pk_bf16_f32 v142, v84, v86
    v_pk_mul_f32 v[140:141], v[60:61], v[50:51]
    v_pk_mul_f32 v[132:133], v[84:85], v[78:79]
    v_pk_mul_f32 v[136:137], v[92:93], v[82:83]
    ds_write_b64 v108, v[142:143] offset:4352
    buffer_load_dwordx4 v3, s[8:11], s60 offen offset:1024 lds
    buffer_load_dwordx4 v4, s[8:11], s60 offen offset:2048 lds
    v_pk_mul_f32 v[138:139], v[62:63], v[50:51]
    v_pk_fma_f32 v[64:65], v[60:61], v[48:49], v[138:139] neg_lo:[0,0,1] neg_hi:[0,0,1]
    v_pk_fma_f32 v[96:97], v[92:93], v[80:81], v[134:135] neg_lo:[0,0,1] neg_hi:[0,0,1]
    v_pk_fma_f32 v[90:91], v[86:87], v[76:77], v[132:133]
    v_pk_mul_f32 v[130:131], v[86:87], v[78:79]
    v_pk_fma_f32 v[88:89], v[84:85], v[76:77], v[130:131] neg_lo:[0,0,1] neg_hi:[0,0,1]
    v_pk_fma_f32 v[98:99], v[94:95], v[80:81], v[136:137]
    v_cvt_pk_bf16_f32 v145, v89, v91
    v_pk_mul_f32 v[136:137], v[96:97], v[82:83]
    v_pk_fma_f32 v[66:67], v[62:63], v[48:49], v[140:141]
    v_pk_mul_f32 v[132:133], v[88:89], v[78:79]
    v_pk_mul_f32 v[130:131], v[90:91], v[78:79]
    v_pk_mul_f32 v[140:141], v[60:61], v[54:55]
    v_pk_fma_f32 v[84:85], v[88:89], v[76:77], v[130:131] neg_lo:[0,0,1] neg_hi:[0,0,1]
    v_pk_fma_f32 v[86:87], v[90:91], v[76:77], v[132:133]
    v_cvt_pk_bf16_f32 v144, v88, v90
    v_cvt_pk_bf16_f32 v158, v96, v98
    v_cvt_pk_bf16_f32 v143, v85, v87
    v_cvt_pk_bf16_f32 v142, v84, v86
    v_pk_mul_f32 v[134:135], v[98:99], v[82:83]
    v_pk_mul_f32 v[130:131], v[86:87], v[78:79]
    s_add_u32 m0, s61, 0x9000
    ds_write_b64 v108, v[144:145] offset:4896
    buffer_load_dwordx4 v2, s[12:15], s60 offen offset:0 lds
    ds_write_b64 v108, v[142:143] offset:5440
    buffer_load_dwordx4 v3, s[12:15], s60 offen offset:1024 lds
    v_cvt_pk_bf16_f32 v159, v97, v99
    v_pk_mul_f32 v[132:133], v[84:85], v[78:79]
    v_pk_fma_f32 v[90:91], v[86:87], v[76:77], v[132:133]
    v_pk_fma_f32 v[94:95], v[98:99], v[80:81], v[136:137]
    v_pk_fma_f32 v[88:89], v[84:85], v[76:77], v[130:131] neg_lo:[0,0,1] neg_hi:[0,0,1]
    v_pk_mul_f32 v[130:131], v[90:91], v[78:79]
    v_pk_mul_f32 v[138:139], v[62:63], v[54:55]
    v_pk_fma_f32 v[92:93], v[96:97], v[80:81], v[134:135] neg_lo:[0,0,1] neg_hi:[0,0,1]
    v_cvt_pk_bf16_f32 v144, v88, v90
    v_cvt_pk_bf16_f32 v145, v89, v91
    v_cvt_pk_bf16_f32 v160, v92, v94
    ds_write_b64 v109, v[144:145] offset:0
    buffer_load_dwordx4 v4, s[12:15], s60 offen offset:2048 lds
    v_cvt_pk_bf16_f32 v161, v93, v95
    v_pk_mul_f32 v[136:137], v[92:93], v[82:83]
    v_pk_mul_f32 v[134:135], v[94:95], v[82:83]
    v_pk_fma_f32 v[70:71], v[62:63], v[52:53], v[140:141]
    v_pk_mul_f32 v[132:133], v[88:89], v[78:79]
    v_pk_fma_f32 v[68:69], v[60:61], v[52:53], v[138:139] neg_lo:[0,0,1] neg_hi:[0,0,1]
    v_pk_fma_f32 v[86:87], v[90:91], v[76:77], v[132:133]
    v_pk_fma_f32 v[84:85], v[88:89], v[76:77], v[130:131] neg_lo:[0,0,1] neg_hi:[0,0,1]
    v_cvt_pk_bf16_f32 v142, v84, v86
    v_cvt_pk_bf16_f32 v143, v85, v87
    s_waitcnt vmcnt(23)
    ds_write_b64 v109, v[142:143] offset:544
    ds_read_b128 a[0:3], v232 offset:0
    v_pk_mul_f32 v[130:131], v[86:87], v[78:79]
    v_pk_mul_f32 v[132:133], v[84:85], v[78:79]
    v_pk_fma_f32 v[96:97], v[92:93], v[80:81], v[134:135] neg_lo:[0,0,1] neg_hi:[0,0,1]
    v_pk_fma_f32 v[98:99], v[94:95], v[80:81], v[136:137]
    v_pk_fma_f32 v[88:89], v[84:85], v[76:77], v[130:131] neg_lo:[0,0,1] neg_hi:[0,0,1]
    v_pk_fma_f32 v[90:91], v[86:87], v[76:77], v[132:133]
    v_cvt_pk_bf16_f32 v162, v96, v98
    v_pk_mul_f32 v[132:133], v[88:89], v[78:79]
    v_cvt_pk_bf16_f32 v145, v89, v91
    v_pk_fma_f32 v[86:87], v[90:91], v[76:77], v[132:133]
    v_cvt_pk_bf16_f32 v144, v88, v90
    ds_write_b64 v109, v[144:145] offset:1088
    ds_read_b128 a[4:7], v232 offset:2048
    ds_read_b128 a[8:11], v233 offset:0
    v_pk_mul_f32 v[130:131], v[90:91], v[78:79]
    v_pk_mul_f32 v[134:135], v[98:99], v[82:83]
    v_pk_fma_f32 v[84:85], v[88:89], v[76:77], v[130:131] neg_lo:[0,0,1] neg_hi:[0,0,1]
    v_pk_mul_f32 v[136:137], v[96:97], v[82:83]
    v_pk_fma_f32 v[94:95], v[98:99], v[80:81], v[136:137]
    v_pk_mul_f32 v[130:131], v[86:87], v[78:79]
    v_cvt_pk_bf16_f32 v143, v85, v87
    v_pk_fma_f32 v[88:89], v[84:85], v[76:77], v[130:131] neg_lo:[0,0,1] neg_hi:[0,0,1]
    v_cvt_pk_bf16_f32 v142, v84, v86
    v_pk_mul_f32 v[138:139], v[62:63], v[58:59]
    v_pk_mul_f32 v[132:133], v[84:85], v[78:79]
    v_pk_fma_f32 v[92:93], v[96:97], v[80:81], v[134:135] neg_lo:[0,0,1] neg_hi:[0,0,1]
    v_pk_mul_f32 v[140:141], v[60:61], v[58:59]
    v_pk_fma_f32 v[72:73], v[60:61], v[56:57], v[138:139] neg_lo:[0,0,1] neg_hi:[0,0,1]
    v_cvt_pk_bf16_f32 v163, v97, v99
    v_pk_fma_f32 v[74:75], v[62:63], v[56:57], v[140:141]
    v_cvt_pk_bf16_f32 v164, v92, v94
    v_cvt_pk_bf16_f32 v165, v93, v95
    v_pk_fma_f32 v[90:91], v[86:87], v[76:77], v[132:133]
    v_cvt_pk_bf16_f32 v144, v88, v90
    v_cvt_pk_bf16_f32 v145, v89, v91
    ds_write_b64 v109, v[142:143] offset:1632
    ds_read_b128 a[12:15], v233 offset:2048
    ds_write_b64 v109, v[144:145] offset:2176
    ds_read_b128 a[192:195], v110 offset:0
    ds_read_b128 a[196:199], v110 offset:64
    ds_read_b128 a[200:203], v110 offset:128
    s_waitcnt vmcnt(16)
    ds_read_b128 a[204:207], v110 offset:192
    ds_read_b128 a[208:211], v110 offset:256
    ds_read_b128 a[212:215], v110 offset:320
    ds_read_b128 a[216:219], v110 offset:384
    ds_read_b128 a[220:223], v110 offset:448
    ds_write_b64 v108, v[148:149] offset:0
    ds_write_b64 v108, v[150:151] offset:544
    ds_write_b64 v108, v[152:153] offset:1088
    ds_read_b128 a[16:19], v232 offset:4096
    ds_write_b64 v108, v[154:155] offset:1632
    ds_write_b64 v108, v[156:157] offset:2176
    ds_write_b64 v108, v[158:159] offset:2720
    ds_write_b64 v108, v[160:161] offset:3264
    ds_write_b64 v108, v[162:163] offset:3808
    ds_write_b64 v108, v[164:165] offset:4352
    ds_read_b128 a[224:227], v110 offset:0
    ds_read_b128 a[228:231], v110 offset:64
    ds_read_b128 a[20:23], v232 offset:6144
    ds_read_b128 a[232:235], v110 offset:128
    ds_read_b128 a[236:239], v110 offset:192
    ds_read_b128 a[240:243], v110 offset:256
    ds_read_b128 a[244:247], v110 offset:320
    ds_read_b128 a[248:251], v110 offset:384
    ds_read_b128 a[252:255], v110 offset:448
    v_pk_mul_f32 v[136:137], v[80:81], v[82:83]
    v_pk_mul_f32 v[134:135], v[82:83], v[82:83]
    v_cvt_pk_bf16_f32 v144, v52, v54
    v_pk_fma_f32 v[92:93], v[80:81], v[80:81], v[134:135] neg_lo:[0,0,1] neg_hi:[0,0,1]
    v_cvt_pk_bf16_f32 v142, v48, v50
    v_cvt_pk_bf16_f32 v143, v49, v51
    v_pk_mul_f32 v[140:141], v[92:93], v[54:55]
    v_pk_fma_f32 v[94:95], v[82:83], v[80:81], v[136:137]
    v_pk_mul_f32 v[138:139], v[94:95], v[54:55]
    v_mov_b32 v146, 0x3f80
    v_mov_b32 v147, 0x3f80
    v_pk_fma_f32 v[84:85], v[92:93], v[52:53], v[138:139] neg_lo:[0,0,1] neg_hi:[0,0,1]
    v_cvt_pk_bf16_f32 v166, v92, v94
    ds_read_b128 a[24:27], v233 offset:4096
    ds_write_b64 v108, v[146:147] offset:0
    ds_read_b128 a[28:31], v233 offset:6144
    ds_write_b64 v108, v[142:143] offset:544
    v_cvt_pk_bf16_f32 v167, v93, v95
    v_cvt_pk_bf16_f32 v145, v53, v55
    s_waitcnt lgkmcnt(15)
    ds_write_b64 v108, v[144:145] offset:1088
    v_pk_fma_f32 v[86:87], v[94:95], v[52:53], v[140:141]
    v_cvt_pk_bf16_f32 v169, v85, v87
    v_cvt_pk_bf16_f32 v168, v84, v86
    v_pk_mul_f32 v[138:139], v[94:95], v[62:63]
    v_cvt_pk_bf16_f32 v143, v57, v59
    v_cvt_pk_bf16_f32 v142, v56, v58
    s_waitcnt lgkmcnt(9)
    v_pk_mul_f32 v[140:141], v[92:93], v[62:63]
    v_pk_fma_f32 v[90:91], v[94:95], v[60:61], v[140:141]
    v_pk_fma_f32 v[88:89], v[92:93], v[60:61], v[138:139] neg_lo:[0,0,1] neg_hi:[0,0,1]
    v_cvt_pk_bf16_f32 v145, v61, v63
    v_mfma_f32_16x16x32_bf16 v[242:245], a[224:227], a[192:195], 0
    s_add_u32 m0, s63, 0xfffffe80
    ds_write_b64 v108, v[142:143] offset:1632
    v_cvt_pk_bf16_f32 v144, v60, v62
    v_mfma_f32_16x16x32_bf16 v[242:245], a[228:231], a[196:199], v[242:245]
    v_cvt_pk_bf16_f32 v171, v89, v91
    v_cvt_pk_bf16_f32 v142, v64, v66
    v_mfma_f32_16x16x32_bf16 v[242:245], a[232:235], a[200:203], v[242:245]
    ds_write_b64 v108, v[144:145] offset:2176
    buffer_load_dwordx4 v228, s[4:7], s101 offen offset:384 lds
    v_cvt_pk_bf16_f32 v170, v88, v90
    v_pk_mul_f32 v[138:139], v[94:95], v[70:71]
    v_pk_mul_f32 v[140:141], v[92:93], v[70:71]
    v_pk_fma_f32 v[84:85], v[92:93], v[68:69], v[138:139] neg_lo:[0,0,1] neg_hi:[0,0,1]
    v_cvt_pk_bf16_f32 v143, v65, v67
    v_mfma_f32_16x16x32_bf16 v[242:245], a[236:239], a[204:207], v[242:245]
    buffer_load_dwordx4 v229, s[4:7], s101 offen offset:1408 lds
    ds_write_b64 v108, v[142:143] offset:2720
    v_cvt_pk_bf16_f32 v144, v68, v70
    v_pk_fma_f32 v[86:87], v[94:95], v[68:69], v[140:141]
    v_cvt_pk_bf16_f32 v172, v84, v86
    s_waitcnt lgkmcnt(8)
    v_pk_mul_f32 v[134:135], v[94:95], v[82:83]
    v_cvt_pk_bf16_f32 v145, v69, v71
    v_mfma_f32_16x16x32_bf16 v[242:245], a[240:243], a[208:211], v[242:245]
    buffer_load_dwordx4 v230, s[4:7], s101 offen offset:2432 lds
    ds_write_b64 v108, v[144:145] offset:3264
    v_cvt_pk_bf16_f32 v142, v72, v74
    v_pk_mul_f32 v[136:137], v[92:93], v[82:83]
    v_pk_fma_f32 v[98:99], v[94:95], v[80:81], v[136:137]
    v_pk_fma_f32 v[96:97], v[92:93], v[80:81], v[134:135] neg_lo:[0,0,1] neg_hi:[0,0,1]
    v_cvt_pk_bf16_f32 v173, v85, v87
    v_cvt_pk_bf16_f32 v143, v73, v75
    v_mfma_f32_16x16x32_bf16 v[242:245], a[244:247], a[212:215], v[242:245]
    buffer_load_dwordx4 v231, s[4:7], s101 offen offset:3456 lds
    ds_write_b64 v108, v[142:143] offset:3808
    v_cvt_pk_bf16_f32 v174, v96, v98
    v_mfma_f32_16x16x32_bf16 v[242:245], a[248:251], a[216:219], v[242:245]
    v_cvt_pk_bf16_f32 v175, v97, v99
    v_cvt_pk_bf16_f32 v144, v80, v82
    s_waitcnt lgkmcnt(7)
    v_cvt_pk_bf16_f32 v145, v81, v83
    v_mfma_f32_16x16x32_bf16 v[242:245], a[252:255], a[220:223], v[242:245]
    s_add_u32 m0, s63, 0xe00
    ds_write_b64 v108, v[144:145] offset:4352
    buffer_load_dwordx4 v228, s[4:7], s101 offen offset:512 lds
    v_pk_mul_f32 v[138:139], v[98:99], v[54:55]
    v_pk_mul_f32 v[140:141], v[96:97], v[54:55]
    v_pk_fma_f32 v[88:89], v[96:97], v[52:53], v[138:139] neg_lo:[0,0,1] neg_hi:[0,0,1]
    v_pk_mul_f32 v[130:131], v[50:51], v[82:83]
    v_pk_fma_f32 v[104:105], v[48:49], v[80:81], v[130:131] neg_lo:[0,0,1] neg_hi:[0,0,1]
    v_pk_mul_f32 v[132:133], v[48:49], v[82:83]
    v_pk_fma_f32 v[106:107], v[50:51], v[80:81], v[132:133]
    v_pk_fma_f32 v[90:91], v[98:99], v[52:53], v[140:141]
    v_pk_mul_f32 v[140:141], v[96:97], v[62:63]
    v_pk_mul_f32 v[138:139], v[98:99], v[62:63]
    v_pk_fma_f32 v[84:85], v[96:97], v[60:61], v[138:139] neg_lo:[0,0,1] neg_hi:[0,0,1]
    v_pk_fma_f32 v[86:87], v[98:99], v[60:61], v[140:141]
    v_pk_mul_f32 v[136:137], v[96:97], v[82:83]
    v_cvt_pk_bf16_f32 v176, v88, v90
    v_pk_mul_f32 v[138:139], v[98:99], v[70:71]
    v_cvt_pk_bf16_f32 v143, v105, v107
    v_cvt_pk_bf16_f32 v177, v89, v91
    v_cvt_pk_bf16_f32 v142, v104, v106
    ds_write_b64 v108, v[142:143] offset:4896
    buffer_load_dwordx4 v229, s[4:7], s101 offen offset:1536 lds
    buffer_load_dwordx4 v230, s[4:7], s101 offen offset:2560 lds
    v_pk_mul_f32 v[140:141], v[96:97], v[70:71]
    v_pk_mul_f32 v[132:133], v[52:53], v[82:83]
    v_pk_fma_f32 v[102:103], v[54:55], v[80:81], v[132:133]
    v_cvt_pk_bf16_f32 v178, v84, v86
    v_pk_mul_f32 v[130:131], v[54:55], v[82:83]
    v_pk_mul_f32 v[134:135], v[98:99], v[82:83]
    v_pk_fma_f32 v[100:101], v[52:53], v[80:81], v[130:131] neg_lo:[0,0,1] neg_hi:[0,0,1]
    v_pk_mul_f32 v[132:133], v[56:57], v[82:83]
    v_cvt_pk_bf16_f32 v145, v101, v103
    v_cvt_pk_bf16_f32 v144, v100, v102
    v_pk_fma_f32 v[90:91], v[98:99], v[68:69], v[140:141]
    v_cvt_pk_bf16_f32 v179, v85, v87
    v_pk_fma_f32 v[92:93], v[96:97], v[80:81], v[134:135] neg_lo:[0,0,1] neg_hi:[0,0,1]
    v_pk_fma_f32 v[88:89], v[96:97], v[68:69], v[138:139] neg_lo:[0,0,1] neg_hi:[0,0,1]
    v_pk_mul_f32 v[130:131], v[58:59], v[82:83]
    v_pk_fma_f32 v[94:95], v[98:99], v[80:81], v[136:137]
    v_cvt_pk_bf16_f32 v181, v89, v91
    s_add_u32 s60, s58, 0x1b0000
    ds_write_b64 v108, v[144:145] offset:5440
    buffer_load_dwordx4 v231, s[4:7], s101 offen offset:3584 lds
    v_pk_mul_f32 v[140:141], v[92:93], v[62:63]
    v_pk_fma_f32 v[104:105], v[56:57], v[80:81], v[130:131] neg_lo:[0,0,1] neg_hi:[0,0,1]
    v_pk_mul_f32 v[130:131], v[62:63], v[82:83]
    v_pk_mul_f32 v[136:137], v[92:93], v[82:83]
    v_pk_fma_f32 v[86:87], v[94:95], v[60:61], v[140:141]
    v_pk_fma_f32 v[106:107], v[58:59], v[80:81], v[132:133]
    v_pk_mul_f32 v[138:139], v[94:95], v[62:63]
    v_pk_fma_f32 v[100:101], v[60:61], v[80:81], v[130:131] neg_lo:[0,0,1] neg_hi:[0,0,1]
    v_cvt_pk_bf16_f32 v180, v88, v90
    v_cvt_pk_bf16_f32 v142, v104, v106
    v_cvt_pk_bf16_f32 v143, v105, v107
    v_pk_fma_f32 v[84:85], v[92:93], v[60:61], v[138:139] neg_lo:[0,0,1] neg_hi:[0,0,1]
    v_cvt_pk_bf16_f32 v183, v93, v95
    v_cvt_pk_bf16_f32 v182, v92, v94
    v_pk_mul_f32 v[134:135], v[94:95], v[82:83]
    v_pk_mul_f32 v[132:133], v[60:61], v[82:83]
    v_pk_fma_f32 v[96:97], v[92:93], v[80:81], v[134:135] neg_lo:[0,0,1] neg_hi:[0,0,1]
    v_cvt_pk_bf16_f32 v184, v84, v86
    v_cvt_pk_bf16_f32 v185, v85, v87
    s_add_u32 m0, s61, 0xc000
    ds_write_b64 v109, v[142:143] offset:0
    buffer_load_dwordx4 v2, s[8:11], s60 offen offset:0 lds
    v_pk_fma_f32 v[98:99], v[94:95], v[80:81], v[136:137]
    v_pk_fma_f32 v[102:103], v[62:63], v[80:81], v[132:133]
    v_pk_mul_f32 v[138:139], v[98:99], v[62:63]
    v_pk_fma_f32 v[88:89], v[96:97], v[60:61], v[138:139] neg_lo:[0,0,1] neg_hi:[0,0,1]
    v_cvt_pk_bf16_f32 v187, v97, v99
    v_pk_mul_f32 v[140:141], v[96:97], v[62:63]
    v_pk_mul_f32 v[136:137], v[96:97], v[82:83]
    v_cvt_pk_bf16_f32 v186, v96, v98
    v_pk_fma_f32 v[90:91], v[98:99], v[60:61], v[140:141]
    v_cvt_pk_bf16_f32 v144, v100, v102
    v_cvt_pk_bf16_f32 v145, v101, v103
    v_pk_mul_f32 v[132:133], v[64:65], v[82:83]
    v_pk_fma_f32 v[94:95], v[98:99], v[80:81], v[136:137]
    v_pk_mul_f32 v[130:131], v[66:67], v[82:83]
    v_pk_fma_f32 v[104:105], v[64:65], v[80:81], v[130:131] neg_lo:[0,0,1] neg_hi:[0,0,1]
    ds_write_b64 v109, v[144:145] offset:544
    buffer_load_dwordx4 v3, s[8:11], s60 offen offset:1024 lds
    buffer_load_dwordx4 v4, s[8:11], s60 offen offset:2048 lds
    v_pk_mul_f32 v[138:139], v[94:95], v[62:63]
    v_pk_mul_f32 v[134:135], v[98:99], v[82:83]
    v_pk_fma_f32 v[106:107], v[66:67], v[80:81], v[132:133]
    v_cvt_pk_bf16_f32 v189, v89, v91
    v_pk_fma_f32 v[92:93], v[96:97], v[80:81], v[134:135] neg_lo:[0,0,1] neg_hi:[0,0,1]
    v_pk_mul_f32 v[140:141], v[92:93], v[62:63]
    v_pk_mul_f32 v[130:131], v[70:71], v[82:83]
    v_cvt_pk_bf16_f32 v143, v105, v107
    v_pk_mul_f32 v[132:133], v[68:69], v[82:83]
    v_pk_mul_f32 v[134:135], v[94:95], v[82:83]
    v_cvt_pk_bf16_f32 v142, v104, v106
    v_pk_fma_f32 v[102:103], v[70:71], v[80:81], v[132:133]
    v_pk_fma_f32 v[86:87], v[94:95], v[60:61], v[140:141]
    v_pk_fma_f32 v[84:85], v[92:93], v[60:61], v[138:139] neg_lo:[0,0,1] neg_hi:[0,0,1]
    v_cvt_pk_bf16_f32 v190, v92, v94
    v_pk_mul_f32 v[136:137], v[92:93], v[82:83]
    v_cvt_pk_bf16_f32 v191, v93, v95
    v_cvt_pk_bf16_f32 v188, v88, v90
    v_pk_fma_f32 v[100:101], v[68:69], v[80:81], v[130:131] neg_lo:[0,0,1] neg_hi:[0,0,1]
    s_add_u32 m0, s61, 0xf000
    s_nop 0
    buffer_load_dwordx4 v2, s[12:15], s60 offen offset:0 lds
    ds_write_b64 v109, v[142:143] offset:1088
    v_pk_mul_f32 v[132:133], v[72:73], v[82:83]
    v_pk_fma_f32 v[96:97], v[92:93], v[80:81], v[134:135] neg_lo:[0,0,1] neg_hi:[0,0,1]
    v_pk_fma_f32 v[98:99], v[94:95], v[80:81], v[136:137]
    v_pk_mul_f32 v[130:131], v[74:75], v[82:83]
    v_cvt_pk_bf16_f32 v193, v85, v87
    v_pk_mul_f32 v[140:141], v[96:97], v[62:63]
    v_cvt_pk_bf16_f32 v192, v84, v86
    v_pk_fma_f32 v[90:91], v[98:99], v[60:61], v[140:141]
    v_cvt_pk_bf16_f32 v144, v100, v102
    v_cvt_pk_bf16_f32 v195, v97, v99
    v_pk_fma_f32 v[106:107], v[74:75], v[80:81], v[132:133]
    v_cvt_pk_bf16_f32 v145, v101, v103
    buffer_load_dwordx4 v3, s[12:15], s60 offen offset:1024 lds
    buffer_load_dwordx4 v4, s[12:15], s60 offen offset:2048 lds
    ds_write_b64 v109, v[144:145] offset:1632
    v_pk_fma_f32 v[104:105], v[72:73], v[80:81], v[130:131] neg_lo:[0,0,1] neg_hi:[0,0,1]
    v_cvt_pk_bf16_f32 v194, v96, v98
    v_pk_mul_f32 v[138:139], v[98:99], v[62:63]
    v_cvt_pk_bf16_f32 v143, v105, v107
    v_pk_fma_f32 v[88:89], v[96:97], v[60:61], v[138:139] neg_lo:[0,0,1] neg_hi:[0,0,1]
    v_cvt_pk_bf16_f32 v142, v104, v106
    v_cvt_pk_bf16_f32 v197, v89, v91
    v_cvt_pk_bf16_f32 v196, v88, v90
    ds_write_b64 v109, v[142:143] offset:2176
    ds_read_b128 a[224:227], v110 offset:0
    ds_read_b128 a[228:231], v110 offset:64
    ds_read_b128 a[232:235], v110 offset:128
    ds_read_b128 a[236:239], v110 offset:192
    ds_read_b128 a[240:243], v110 offset:256
    ds_read_b128 a[244:247], v110 offset:320
    ds_read_b128 a[248:251], v110 offset:384
    ds_read_b128 a[252:255], v110 offset:448
    ds_write_b64 v108, v[166:167] offset:0
    ds_write_b64 v108, v[168:169] offset:544
    ds_write_b64 v108, v[170:171] offset:1088
    ds_write_b64 v108, v[172:173] offset:1632
    ds_write_b64 v108, v[174:175] offset:2176
    ds_write_b64 v108, v[176:177] offset:2720
    ds_write_b64 v108, v[178:179] offset:3264
    ds_write_b64 v108, v[180:181] offset:3808
    ds_write_b64 v108, v[182:183] offset:4352
    ds_write_b64 v108, v[184:185] offset:4896
    ds_write_b64 v108, v[186:187] offset:5440
    ds_write_b64 v109, v[188:189] offset:0
    ds_write_b64 v109, v[190:191] offset:544
    ds_write_b64 v109, v[192:193] offset:1088
    ds_write_b64 v109, v[194:195] offset:1632
    ds_write_b64 v109, v[196:197] offset:2176
    ds_read_b128 v[48:51], v110 offset:0
    ds_read_b128 v[52:55], v110 offset:64
    ds_read_b128 v[56:59], v110 offset:128
    ds_read_b128 v[60:63], v110 offset:192
    ds_read_b128 v[64:67], v110 offset:256
    ds_read_b128 v[68:71], v110 offset:320
    ds_read_b128 v[72:75], v110 offset:384
    ds_read_b128 v[76:79], v110 offset:448
    s_waitcnt lgkmcnt(15)
    v_mfma_f32_16x16x32_bf16 v[234:237], a[224:227], a[192:195], 0
    v_mfma_f32_16x16x32_bf16 v[234:237], a[228:231], a[196:199], v[234:237]
    v_mfma_f32_16x16x32_bf16 v[234:237], a[232:235], a[200:203], v[234:237]
    v_mfma_f32_16x16x32_bf16 v[234:237], a[236:239], a[204:207], v[234:237]
    v_mfma_f32_16x16x32_bf16 v[234:237], a[240:243], a[208:211], v[234:237]
    v_mfma_f32_16x16x32_bf16 v[234:237], a[244:247], a[212:215], v[234:237]
    v_mfma_f32_16x16x32_bf16 v[234:237], a[248:251], a[216:219], v[234:237]
    v_mfma_f32_16x16x32_bf16 v[234:237], a[252:255], a[220:223], v[234:237]
    s_waitcnt lgkmcnt(4)
    v_mfma_f32_16x16x32_bf16 v[238:241], v[48:51], a[192:195], 0
    v_mfma_f32_16x16x32_bf16 v[238:241], v[52:55], a[196:199], v[238:241]
    v_mfma_f32_16x16x32_bf16 v[238:241], v[56:59], a[200:203], v[238:241]
    v_mfma_f32_16x16x32_bf16 v[238:241], v[60:63], a[204:207], v[238:241]
    s_waitcnt lgkmcnt(0)
    v_mfma_f32_16x16x32_bf16 v[238:241], v[64:67], a[208:211], v[238:241]
    v_mfma_f32_16x16x32_bf16 v[238:241], v[68:71], a[212:215], v[238:241]
    s_mul_i32 s55, s50, 6144
    v_mfma_f32_16x16x32_bf16 v[238:241], v[72:75], a[216:219], v[238:241]
    s_add_u32 s55, s55, 0x12000
    v_mfma_f32_16x16x32_bf16 v[238:241], v[76:79], a[220:223], v[238:241]
    s_mov_b64 exec, 1
    v_add_f32 v234, v234, v255
    s_mov_b64 exec, -1
    v_and_b32 v81, 15, v1
    v_lshrrev_b32 v82, 4, v1
    v_and_b32 v88, 1, v1
    v_lshlrev_b32 v112, 4, v1
    v_mov_b32 v86, 0
    v_lshl_add_u32 v80, v1, 4, s55
    v_lshrrev_b32 v83, 1, v81
    v_mov_b32 v84, 0
    v_mov_b32 v85, 0
    v_cvt_pk_bf16_f32 v90, v240, v241
    v_lshl_add_u32 v91, v81, 4, s55
    v_and_b32 v102, 1, v82
    v_cvt_pk_bf16_f32 v89, v238, v239
    v_mov_b32 v87, 0
    s_movk_i32 s57, 196
    ds_write_b128 v80, v[84:87] offset:0
    s_add_u32 s56, s55, 3104
    ds_write_b128 v80, v[84:87] offset:1024
    ds_write_b128 v80, v[84:87] offset:2048
    v_add_u32 v104, 1, v81
    v_lshl_add_u32 v102, v102, 3, v91
    v_lshrrev_b32 v104, 1, v104
    v_lshlrev_b32 v83, 2, v83
    v_lshl_add_u32 v83, v82, 6, v83
    v_mad_u32_u24 v83, v88, s57, v83
    v_cvt_pk_bf16_f32 v106, v244, v245
    v_cvt_pk_bf16_f32 v100, v234, v235
    v_sub_u32 v83, s56, v83
    v_cvt_pk_bf16_f32 v107, v242, v242
    s_add_u32 s56, s55, 2528
    v_lshl_add_u32 v91, v82, 8, v91
    v_lshlrev_b32 v104, 2, v104
    v_lshrrev_b32 v103, 1, v82
    v_cvt_pk_bf16_f32 v101, v236, v237
    v_lshl_add_u32 v104, v82, 7, v104
    v_lshl_add_u32 v105, v88, 1, s56
    v_lshl_add_u32 v102, v103, 8, v102
    v_sub_u32 v104, v105, v104
    v_cvt_pk_bf16_f32 v103, v235, v236
    v_cvt_pk_bf16_f32 v105, v242, v243
    s_mov_b32 exec_lo, 0
    ds_write_b32 v83, v90
    s_mov_b32 exec_hi, -2
    ds_write_b32 v83, v89 offset:32
    s_mov_b32 exec_hi, 1
    v_mov_b32 v241, 0
    v_mov_b32 v240, v239
    v_mov_b32 v239, v238
    s_mov_b32 exec_lo, -2
    ds_write_b16 v104, v105 offset:96
    s_mov_b32 exec_lo, -1
    v_cvt_pk_bf16_f32 v98, v240, v241
    v_cvt_pk_bf16_f32 v94, v240, v240
    v_cvt_pk_bf16_f32 v93, v239, v240
    v_cvt_pk_bf16_f32 v96, v238, v239
    v_cvt_pk_bf16_f32 v92, v238, v238
    v_cvt_pk_bf16_f32 v97, v240, v240
    ds_write_b16 v91, v92 offset:542
    ds_write_b96 v91, v[92:94] offset:544
    ds_write_b16_d16_hi v91, v98 offset:556
    ds_write_b32 v91, v92 offset:1724
    ds_write_b96 v91, v[96:98] offset:1728
    s_mov_b32 exec_hi, 0
    ds_write_b16_d16_hi v104, v105 offset:64
    ds_write_b16 v104, v106 offset:32
    ds_write_b16_d16_hi v104, v106
    s_mov_b32 exec_lo, 1
    ds_write_b16 v80, v107 offset:2880
    ds_write_b16 v80, v107 offset:1126
    ds_write_b16 v80, v107 offset:1128
    ds_write_b32 v80, v107 offset:2308
    s_mov_b64 exec, -1
    ds_write_b64 v102, v[100:101] offset:32
    ds_write_b16 v102, v100 offset:1214
    ds_write_b32 v102, v103 offset:1216
    ds_write_b16_d16_hi v102, v101 offset:1220
    ds_read_b128 v[48:51], v80 offset:0
    ds_read_b128 v[52:55], v80 offset:1024
    ds_read_b128 v[56:59], v80 offset:2048
    s_waitcnt lgkmcnt(2)
    buffer_store_dwordx4 v[48:51], v112, s[24:27], s35 offen offset:0 sc1
    s_waitcnt lgkmcnt(1)
    buffer_store_dwordx4 v[52:55], v112, s[24:27], s35 offen offset:1024 sc1
    s_waitcnt lgkmcnt(0)
    buffer_store_dwordx4 v[56:59], v112, s[24:27], s35 offen offset:2048 sc1
    s_waitcnt vmcnt(27)
    s_waitcnt lgkmcnt(0)
    s_branch MERGE
PATHB1:
    s_add_u32 m0, s63, 0xf80
    s_add_u32 s60, s58, 0x0
    buffer_load_dwordx4 v228, s[4:7], s101 offen offset:128 lds
    buffer_load_dwordx4 v229, s[4:7], s101 offen offset:1152 lds
    buffer_load_dwordx4 v230, s[4:7], s101 offen offset:2176 lds
    buffer_load_dwordx4 v231, s[4:7], s101 offen offset:3200 lds
    s_add_u32 m0, s61, 0x0
    s_nop 0
    buffer_load_dwordx4 v2, s[8:11], s60 offen offset:0 lds
    buffer_load_dwordx4 v3, s[8:11], s60 offen offset:1024 lds
    buffer_load_dwordx4 v4, s[8:11], s60 offen offset:2048 lds
    s_add_u32 m0, s61, 0x3000
    s_nop 0
    buffer_load_dwordx4 v2, s[12:15], s60 offen offset:0 lds
    buffer_load_dwordx4 v3, s[12:15], s60 offen offset:1024 lds
    buffer_load_dwordx4 v4, s[12:15], s60 offen offset:2048 lds
    s_add_u32 m0, s63, 0x1f00
    s_add_u32 s60, s58, 0xd8000
    buffer_load_dwordx4 v228, s[4:7], s101 offen offset:256 lds
    buffer_load_dwordx4 v229, s[4:7], s101 offen offset:1280 lds
    buffer_load_dwordx4 v230, s[4:7], s101 offen offset:2304 lds
    buffer_load_dwordx4 v231, s[4:7], s101 offen offset:3328 lds
    s_add_u32 m0, s61, 0x6000
    s_nop 0
    buffer_load_dwordx4 v2, s[8:11], s60 offen offset:0 lds
    buffer_load_dwordx4 v3, s[8:11], s60 offen offset:1024 lds
    buffer_load_dwordx4 v4, s[8:11], s60 offen offset:2048 lds
    s_add_u32 m0, s61, 0x9000
    s_nop 0
    buffer_load_dwordx4 v2, s[12:15], s60 offen offset:0 lds
    buffer_load_dwordx4 v3, s[12:15], s60 offen offset:1024 lds
    buffer_load_dwordx4 v4, s[12:15], s60 offen offset:2048 lds
    s_waitcnt vmcnt(23)
    ds_read_b128 a[0:3], v232 offset:0
    ds_read_b128 a[4:7], v232 offset:2048
    ds_read_b128 a[8:11], v233 offset:0
    ds_read_b128 a[12:15], v233 offset:2048
    s_waitcnt vmcnt(16)
    ds_read_b128 a[16:19], v232 offset:4096
    ds_read_b128 a[20:23], v232 offset:6144
    ds_read_b128 a[24:27], v233 offset:4096
    ds_read_b128 a[28:31], v233 offset:6144
    s_waitcnt lgkmcnt(4)
    s_add_u32 m0, s63, 0xfffffe80
    s_nop 0
    buffer_load_dwordx4 v228, s[4:7], s101 offen offset:384 lds
    buffer_load_dwordx4 v229, s[4:7], s101 offen offset:1408 lds
    buffer_load_dwordx4 v230, s[4:7], s101 offen offset:2432 lds
    buffer_load_dwordx4 v231, s[4:7], s101 offen offset:3456 lds
    s_waitcnt lgkmcnt(0)
    s_add_u32 m0, s63, 0xe00
    s_nop 0
    buffer_load_dwordx4 v228, s[4:7], s101 offen offset:512 lds
    buffer_load_dwordx4 v229, s[4:7], s101 offen offset:1536 lds
    buffer_load_dwordx4 v230, s[4:7], s101 offen offset:2560 lds
    buffer_load_dwordx4 v231, s[4:7], s101 offen offset:3584 lds
    s_add_u32 s60, s58, 0x1b0000
    s_add_u32 m0, s61, 0xc000
    s_nop 0
    buffer_load_dwordx4 v2, s[8:11], s60 offen offset:0 lds
    buffer_load_dwordx4 v3, s[8:11], s60 offen offset:1024 lds
    buffer_load_dwordx4 v4, s[8:11], s60 offen offset:2048 lds
    s_add_u32 m0, s61, 0xf000
    s_nop 0
    buffer_load_dwordx4 v2, s[12:15], s60 offen offset:0 lds
    buffer_load_dwordx4 v3, s[12:15], s60 offen offset:1024 lds
    buffer_load_dwordx4 v4, s[12:15], s60 offen offset:2048 lds
    s_waitcnt vmcnt(24)
    s_waitcnt lgkmcnt(0)
    s_branch MERGE
SLOW0:
    s_mov_b32 s79, 20000
SLOWL0:
    buffer_load_dword v43, off, s[28:31], 0 sc1
    s_waitcnt vmcnt(0)
    v_cmp_eq_u32 vcc, 0, v43
    s_cbranch_vccz BACK0
    s_sub_u32 s79, s79, 1
    s_cmp_lg_u32 s79, 0
    s_cbranch_scc1 SLOWL0
    s_branch BACK0
SLOW1:
    s_mov_b32 s79, 20000
SLOWL1:
    buffer_load_dword v46, v246, s[24:27], 0 offen sc1
    s_waitcnt vmcnt(0)
    v_cmp_ne_u32 vcc, v46, v43
    s_cbranch_vccz BACK1
    s_sub_u32 s79, s79, 1
    s_cmp_lg_u32 s79, 0
    s_cbranch_scc1 SLOWL1
    s_branch BACK1
SLOW2:
    s_mov_b32 s79, 20000
SLOWL2:
    buffer_load_dword v240, off, s[24:27], s44 sc1
    s_waitcnt vmcnt(0)
    v_cmp_ne_u32 vcc, v240, v43
    s_cbranch_vccz BACK2
    s_sub_u32 s79, s79, 1
    s_cmp_lg_u32 s79, 0
    s_cbranch_scc1 SLOWL2
    s_branch BACK2
SLOW3:
    s_mov_b32 s79, 20000
SLOWL3:
    buffer_load_dword v46, off, s[24:27], s39 sc1
    s_waitcnt vmcnt(0)
    v_cmp_ne_u32 vcc, v46, v43
    s_cbranch_vccz BACK3
    s_sub_u32 s79, s79, 1
    s_cmp_lg_u32 s79, 0
    s_cbranch_scc1 SLOWL3
    s_branch BACK3
SLOW4:
    s_mov_b32 s79, 20000
SLOWL4:
    buffer_load_dword v46, off, s[24:27], s39 sc1
    s_waitcnt vmcnt(0)
    v_cmp_ne_u32 vcc, v46, v43
    s_cbranch_vccz BACK4
    s_sub_u32 s79, s79, 1
    s_cmp_lg_u32 s79, 0
    s_cbranch_scc1 SLOWL4
    s_branch BACK4
SLOW5:
    s_mov_b32 s79, 20000
SLOWL5:
    buffer_load_dword v46, v0, s[24:27], 0 offen sc1
    s_waitcnt vmcnt(0)
    v_cmp_ne_u32 vcc, v46, v43
    s_cbranch_vccz BACK5
    s_sub_u32 s79, s79, 1
    s_cmp_lg_u32 s79, 0
    s_cbranch_scc1 SLOWL5
    s_branch BACK5
SLOW6:
    s_mov_b32 s79, 20000
SLOWL6:
    buffer_load_dword v46, v18, s[24:27], 0 offen offset:0 sc1
    s_waitcnt vmcnt(0)
    v_cmp_ne_u32 vcc, v46, v43
    s_cbranch_vccz BACK6
    s_sub_u32 s79, s79, 1
    s_cmp_lg_u32 s79, 0
    s_cbranch_scc1 SLOWL6
    s_branch BACK6
SLOW7:
    s_mov_b32 s79, 20000
SLOWL7:
    buffer_load_dword v46, v18, s[24:27], 0 offen offset:512 sc1
    s_waitcnt vmcnt(0)
    v_cmp_ne_u32 vcc, v46, v43
    s_cbranch_vccz BACK7
    s_sub_u32 s79, s79, 1
    s_cmp_lg_u32 s79, 0
    s_cbranch_scc1 SLOWL7
    s_branch BACK7
SLOW8:
    s_mov_b32 s79, 20000
SLOWL8:
    buffer_load_dwordx4 v[80:83], v19, s[24:27], s44 offen offset:0 sc1
    buffer_load_dwordx4 v[84:87], v19, s[24:27], s44 offen offset:1024 sc1
    buffer_load_dwordx4 v[88:91], v19, s[24:27], s45 offen offset:0 sc1
    buffer_load_dwordx4 v[92:95], v19, s[24:27], s45 offen offset:1024 sc1
    s_waitcnt vmcnt(0)
    v_max3_u32 v104, v80, v81, v82
    v_max3_u32 v105, v83, v84, v85
    v_max3_u32 v106, v86, v87, v88
    v_max3_u32 v107, v89, v90, v91
    v_max3_u32 v104, v104, v92, v93
    v_max3_u32 v105, v105, v94, v95
    v_max3_u32 v104, v104, v105, v106
    v_max_u32 v104, v104, v107
    v_cmp_eq_u32 vcc, -1, v104
    s_cbranch_vccz BACK8
    s_sub_u32 s79, s79, 1
    s_cmp_lg_u32 s79, 0
    s_cbranch_scc1 SLOWL8
    s_branch BACK8
SLOW9:
    s_mov_b32 s79, 20000
SLOWL9:
    buffer_load_dwordx4 v[96:99], v19, s[24:27], s46 offen offset:0 sc1
    buffer_load_dwordx4 v[100:103], v19, s[24:27], s46 offen offset:1024 sc1
    s_waitcnt vmcnt(0)
    v_max3_u32 v104, v96, v97, v98
    v_max3_u32 v105, v99, v100, v101
    v_max3_u32 v104, v104, v102, v103
    v_max_u32 v104, v104, v105
    v_cmp_eq_u32 vcc, -1, v104
    s_cbranch_vccz BACK9
    s_sub_u32 s79, s79, 1
    s_cmp_lg_u32 s79, 0
    s_cbranch_scc1 SLOWL9
    s_branch BACK9
END:
    s_endpgm
.section .rodata,"a"
.p2align 6
.amdhsa_kernel gated_mix__ssm_conv_s4__glu_gated_swiglu__prompt_kernel
  .amdhsa_next_free_vgpr 512
  .amdhsa_next_free_sgpr 102
  .amdhsa_accum_offset 256
  .amdhsa_group_segment_fixed_size 0
  .amdhsa_kernarg_size 136
  .amdhsa_user_sgpr_count 2
  .amdhsa_user_sgpr_kernarg_segment_ptr 1
  .amdhsa_system_sgpr_workgroup_id_x 1
.end_amdhsa_kernel
```
